```python
import torch

def _softmax(x, axis=-1):
    return torch.softmax(x, dim=axis)
def _gelu(x):
    return torch.nn.functional.gelu(x, approximate="tanh")
def _silu(x):
    return torch.nn.functional.silu(x)
def _sigmoid(x):
    return torch.sigmoid(x)
def _layernorm(x, axis=-1, eps=1e-5):
    m = x.mean(dim=axis, keepdim=True)
    v = x.var(dim=axis, keepdim=True, unbiased=False)
    return (x - m) / torch.sqrt(v + eps)
def _scatter_add(tgt, idx, src, axis=0):
    return tgt.clone().index_add_(axis, idx, src)
def _segment_sum(src, seg, n):
    out = torch.zeros((n,) + src.shape[1:], dtype=src.dtype)
    return out.index_add_(0, seg, src)
def _pad(x, pw):
    flat = tuple(v for pair in reversed(pw) for v in pair)
    return torch.nn.functional.pad(x, flat)

kernel_name = 'concat_heads__mha_block_cached__mha_block_cached__near_ridge'

def setup_inputs():

    _w = (lambda a: (lambda t: t.to(torch.bfloat16) if t.is_floating_point() else t)(torch.as_tensor(a)))
    def _A_setup():
        B, Sq, D = 16, 96, 512
        H, Sk, Dh = 32, 96, 128
        return {
            "x": _w((lambda *s: torch.randn(*s, dtype=torch.bfloat16) * 0.8)(B, Sq, D)),
            "k_cache": _w((lambda *s: torch.randn(*s, dtype=torch.bfloat16) * 0.8)(B, H, Sk, Dh)),
            "v_cache": _w((lambda *s: torch.randn(*s, dtype=torch.bfloat16) * 0.05)(B, H, Sk, Dh)),
            "wq": _w((lambda *s: torch.randn(*s, dtype=torch.bfloat16) * 0.8)(D, H * Dh) * (D ** -0.5)),
            "wo": _w((lambda *s: torch.randn(*s, dtype=torch.bfloat16) * 0.05)(H * Dh, D) * ((H * Dh) ** -0.5)),
        }
    _A_in = _A_setup()

    def _B_setup():
        B, Sq, D = 16, 96, 512
        H, Sk, Dh = 32, 96, 128
        return {
            "x": _w((lambda *s: torch.randn(*s, dtype=torch.bfloat16) * 0.8)(B, Sq, D)),
            "k_cache": _w((lambda *s: torch.randn(*s, dtype=torch.bfloat16) * 0.8)(B, H, Sk, Dh)),
            "v_cache": _w((lambda *s: torch.randn(*s, dtype=torch.bfloat16) * 0.05)(B, H, Sk, Dh)),
            "wq": _w((lambda *s: torch.randn(*s, dtype=torch.bfloat16) * 0.8)(D, H * Dh) * (D ** -0.5)),
            "wo": _w((lambda *s: torch.randn(*s, dtype=torch.bfloat16) * 0.05)(H * Dh, D) * ((H * Dh) ** -0.5)),
        }
    _B_in = _B_setup()

    return {
        "A_x": _A_in["x"],
        "A_k_cache": _A_in["k_cache"],
        "A_v_cache": _A_in["v_cache"],
        "A_wq": _A_in["wq"],
        "A_wo": _A_in["wo"],
        "B_x": _B_in["x"],
        "B_k_cache": _B_in["k_cache"],
        "B_v_cache": _B_in["v_cache"],
        "B_wq": _B_in["wq"],
        "B_wo": _B_in["wo"],
    }

def reference(A_x, A_k_cache, A_v_cache, A_wq, A_wo, B_x, B_k_cache, B_v_cache, B_wq, B_wo):
    def _A_ref(x, k_cache, v_cache, wq, wo):
        B, Sq, D = x.shape
        H, Dh = 32, 128
        q = (lambda x, *d: x.permute(*d))((x @ wq).reshape(B, Sq, H, Dh), 0, 2, 1, 3)
        scores = torch.einsum("bhqd,bhkd->bhqk", q, k_cache) * (Dh ** -0.5)
        p = _softmax(scores, axis=-1)
        o = torch.einsum("bhqk,bhkd->bhqd", p, v_cache)
        return (lambda x, *d: x.permute(*d))(o, 0, 2, 1, 3).reshape(B, Sq, H * Dh) @ wo

    def _B_ref(x, k_cache, v_cache, wq, wo):
        B, Sq, D = x.shape
        H, Dh = 32, 128
        q = (lambda x, *d: x.permute(*d))((x @ wq).reshape(B, Sq, H, Dh), 0, 2, 1, 3)
        scores = torch.einsum("bhqd,bhkd->bhqk", q, k_cache) * (Dh ** -0.5)
        p = _softmax(scores, axis=-1)
        o = torch.einsum("bhqk,bhkd->bhqd", p, v_cache)
        return (lambda x, *d: x.permute(*d))(o, 0, 2, 1, 3).reshape(B, Sq, H * Dh) @ wo

    a = _A_ref(A_x, A_k_cache, A_v_cache, A_wq, A_wo)
    b = _B_ref(B_x, B_k_cache, B_v_cache, B_wq, B_wo)
    return torch.concatenate([a, b], axis=-1)
```

```asm
; @launch grid=(256,1,1) block=(256,1,1) lds=163840
.amdgcn_target "amdgcn-amd-amdhsa--gfx950"
.text
.globl concat_heads__mha_block_cached__mha_block_cached__near_ridge_kernel
.p2align 8
.type concat_heads__mha_block_cached__mha_block_cached__near_ridge_kernel,@function
concat_heads__mha_block_cached__mha_block_cached__near_ridge_kernel:
    s_cmp_ge_u32 s2, 256
    s_cbranch_scc1 L_main_end
    s_load_dwordx16 s[32:47], s[0:1], 0
    s_lshr_b32 s74, s2, 3
    s_cmp_ge_u32 s74, 8
    s_cbranch_scc1 L_pf_skip
    v_cmp_gt_u32 vcc, 64, v0
    s_and_saveexec_b64 s[72:73], vcc
    s_cbranch_execz L_pf_rest
    s_getpc_b64 s[70:71]
L_pc_early:
    s_sub_u32 s70, s70, L_pc_early-concat_heads__mha_block_cached__mha_block_cached__near_ridge_kernel
    s_subb_u32 s71, s71, 0
    s_lshl_b32 s74, s74, 13
    v_lshlrev_b32 v30, 7, v0
    v_add_u32 v30, s74, v30
    v_min_u32 v30, CODE_BYTES-4, v30
    global_load_dword v63, v30, s[70:71]
L_pf_rest:
    s_mov_b64 exec, s[72:73]
L_pf_skip:
    s_load_dwordx4 s[48:51], s[0:1], 64
    s_load_dwordx2 s[52:53], s[0:1], 96
    s_load_dwordx4 s[4:7], s[0:1], 80
    v_and_b32 v1, 63, v0
    v_lshrrev_b32 v29, 6, v0
    s_and_b32 s3, s2, 7
    s_lshr_b32 s63, s2, 3
    v_readfirstlane_b32 s54, v29
    s_lshr_b32 s55, s3, 2
    s_and_b32 s64, s3, 3
    s_lshr_b32 s56, s63, 1
    s_and_b32 s63, s63, 1
    s_lshl_b32 s64, s64, 1
    s_add_u32 s57, s64, s63
    s_lshl_b32 s58, s57, 2
    s_add_u32 s58, s58, s54
    s_lshl_b32 s59, s54, 15
    v_lshrrev_b32 v40, 4, v1
    v_bfe_u32 v41, v1, 2, 2
    v_and_b32 v42, 3, v1
    v_and_b32 v43, 15, v1
    s_mul_i32 s63, s56, 98304
    s_mul_i32 s64, s54, 3
    s_add_u32 s65, s64, 0
    s_and_b32 s3, s65, 1
    s_lshl_b32 s3, s3, 2
    v_add_u32 v29, s3, v40
    v_and_b32 v30, 7, v1
    v_xor_b32 v29, v29, v30
    v_lshlrev_b32 v29, 4, v29
    v_lshrrev_b32 v30, 3, v1
    s_lshl_b32 s3, s65, 3
    v_add_u32 v30, s3, v30
    v_lshl_add_u32 v29, v30, 10, v29
    s_sub_u32 s3, s63, 0
    v_add_u32 v2, s3, v29
    s_add_u32 s65, s64, 1
    s_and_b32 s3, s65, 1
    s_lshl_b32 s3, s3, 2
    v_add_u32 v29, s3, v40
    v_and_b32 v30, 7, v1
    v_xor_b32 v29, v29, v30
    v_lshlrev_b32 v29, 4, v29
    v_lshrrev_b32 v30, 3, v1
    s_lshl_b32 s3, s65, 3
    v_add_u32 v30, s3, v30
    v_lshl_add_u32 v29, v30, 10, v29
    s_sub_u32 s3, s63, 1024
    v_add_u32 v3, s3, v29
    s_add_u32 s65, s64, 2
    s_and_b32 s3, s65, 1
    s_lshl_b32 s3, s3, 2
    v_add_u32 v29, s3, v40
    v_and_b32 v30, 7, v1
    v_xor_b32 v29, v29, v30
    v_lshlrev_b32 v29, 4, v29
    v_lshrrev_b32 v30, 3, v1
    s_lshl_b32 s3, s65, 3
    v_add_u32 v30, s3, v30
    v_lshl_add_u32 v29, v30, 10, v29
    s_sub_u32 s3, s63, 2048
    v_add_u32 v4, s3, v29
    s_mul_i32 s66, s54, 3072
    s_add_u32 s66, s66, 131072
    s_and_b32 s63, s57, 1
    s_lshl_b32 s63, s63, 2
    s_add_u32 s63, s63, s56
    s_and_b32 s63, s63, 7
    s_lshl_b32 s62, s63, 7
    s_lshl_b32 s73, s63, 19
    s_mov_b32 s75, 0
    s_mov_b32 s100, 262144
    v_lshlrev_b32 v29, 2, v40
    v_xor_b32 v29, v29, v43
    v_lshlrev_b32 v29, 4, v29
    v_lshl_add_u32 v29, v40, 13, v29
    s_lshl_b32 s3, s58, 8
    v_add_u32 v5, s3, v29
    v_add_u32 v6, 31744, v5
    v_add_u32 v7, 31744, v6
    v_add_u32 v8, 31744, v7
    s_waitcnt lgkmcnt(0)
    s_cmp_eq_u32 s55, 0
    s_cselect_b32 s8, s32, s42
    s_cselect_b32 s9, s33, s43
    s_mov_b32 s10, 1572864
    s_mov_b32 s11, 0x20000
    s_cselect_b32 s20, s38, s48
    s_cselect_b32 s21, s39, s49
    s_mov_b32 s22, 4194304
    s_mov_b32 s23, 0x20000
    s_add_u32 m0, s66, 0
    s_nop 0
    buffer_load_dwordx4 v2, s[8:11], s62 offen offset:0  lds
    buffer_load_dwordx4 v3, s[8:11], s62 offen offset:1024  lds
    buffer_load_dwordx4 v4, s[8:11], s62 offen offset:2048  lds
    s_add_u32 s62, s62, 128
    s_and_b32 s62, s62, 1023
    s_add_u32 s60, s73, s75
    s_or_b32 s61, s60, 131072
    s_add_u32 m0, s59, 0
    s_nop 0
    buffer_load_dwordx4 v5, s[20:23], s60 offen offset:0  lds
    buffer_load_dwordx4 v6, s[20:23], s60 offen offset:1024  lds
    buffer_load_dwordx4 v7, s[20:23], s60 offen offset:2048  lds
    buffer_load_dwordx4 v8, s[20:23], s60 offen offset:3072  lds
    s_add_u32 m0, s59, 4096
    s_nop 0
    buffer_load_dwordx4 v5, s[20:23], s61 offen offset:0  lds
    buffer_load_dwordx4 v6, s[20:23], s61 offen offset:1024  lds
    buffer_load_dwordx4 v7, s[20:23], s61 offen offset:2048  lds
    buffer_load_dwordx4 v8, s[20:23], s61 offen offset:3072  lds
    s_add_u32 s60, s73, s100
    s_or_b32 s61, s60, 131072
    s_add_u32 m0, s59, 8192
    s_nop 0
    buffer_load_dwordx4 v5, s[20:23], s60 offen offset:0  lds
    buffer_load_dwordx4 v6, s[20:23], s60 offen offset:1024  lds
    buffer_load_dwordx4 v7, s[20:23], s60 offen offset:2048  lds
    buffer_load_dwordx4 v8, s[20:23], s60 offen offset:3072  lds
    s_add_u32 m0, s59, 12288
    s_nop 0
    buffer_load_dwordx4 v5, s[20:23], s61 offen offset:0  lds
    buffer_load_dwordx4 v6, s[20:23], s61 offen offset:1024  lds
    buffer_load_dwordx4 v7, s[20:23], s61 offen offset:2048  lds
    buffer_load_dwordx4 v8, s[20:23], s61 offen offset:3072  lds
    s_add_u32 s73, s73, 524288
    s_and_b32 s73, s73, 0x3fffff
    s_add_u32 m0, s66, 12288
    s_nop 0
    buffer_load_dwordx4 v2, s[8:11], s62 offen offset:0  lds
    buffer_load_dwordx4 v3, s[8:11], s62 offen offset:1024  lds
    buffer_load_dwordx4 v4, s[8:11], s62 offen offset:2048  lds
    s_add_u32 s62, s62, 128
    s_and_b32 s62, s62, 1023
    s_lshl_b32 s3, s56, 5
    s_add_u32 s3, s3, s58
    s_mul_i32 s65, s3, 24576
    v_xor_b32 v29, v43, v40
    v_lshlrev_b32 v29, 4, v29
    v_lshlrev_b32 v30, 8, v40
    v_add_u32 v30, s65, v30
    v_lshlrev_b32 v31, 8, v43
    v_add_u32 v31, s59, v31
    v_xor_b32 v9, 0, v29
    v_add_u32 v32, v9, v30
    v_add_u32 v36, v9, v31
    v_xor_b32 v9, 64, v29
    v_add_u32 v33, v9, v30
    v_add_u32 v37, v9, v31
    v_xor_b32 v9, 128, v29
    v_add_u32 v34, v9, v30
    v_add_u32 v38, v9, v31
    v_xor_b32 v9, 192, v29
    v_add_u32 v35, v9, v30
    v_add_u32 v39, v9, v31
    v_add_u32 v29, 0, v40
    v_lshlrev_b32 v29, 1, v29
    v_xor_b32 v29, v29, v43
    v_lshlrev_b32 v29, 4, v29
    v_lshl_add_u32 v29, v40, 8, v29
    v_add_u32 v10, s65, v29
    v_add_u32 v29, 4, v40
    v_lshlrev_b32 v29, 1, v29
    v_xor_b32 v29, v29, v43
    v_lshlrev_b32 v29, 4, v29
    v_lshl_add_u32 v29, v40, 8, v29
    v_add_u32 v11, s65, v29
    v_lshlrev_b32 v29, 3, v40
    v_add_u32 v29, v29, v41
    v_lshlrev_b32 v29, 8, v29
    v_lshl_add_u32 v29, v42, 4, v29
    v_add_u32 v29, s59, v29
    v_xor_b32 v30, 0, v41
    v_lshl_add_u32 v12, v30, 6, v29
    v_xor_b32 v30, 1, v41
    v_lshl_add_u32 v13, v30, 6, v29
    v_xor_b32 v30, 2, v41
    v_lshl_add_u32 v14, v30, 6, v29
    v_xor_b32 v30, 3, v41
    v_lshl_add_u32 v15, v30, 6, v29
    v_lshrrev_b32 v30, 1, v43
    v_add_u32 v29, 0, v40
    v_xor_b32 v29, v29, v30
    v_lshlrev_b32 v29, 4, v29
    v_lshl_add_u32 v29, v43, 7, v29
    v_add_u32 v16, 131072, v29
    v_add_u32 v29, 4, v40
    v_xor_b32 v29, v29, v30
    v_lshlrev_b32 v29, 4, v29
    v_lshl_add_u32 v29, v43, 7, v29
    v_add_u32 v17, 131072, v29
    v_lshl_add_u32 v29, v40, 2, v41
    v_and_b32 v30, 7, v29
    v_lshlrev_b32 v30, 5, v30
    v_lshl_add_u32 v30, v29, 8, v30
    v_lshl_add_u32 v30, v42, 3, v30
    v_add_u32 v18, s59, v30
    v_lshlrev_b32 v20, 4, v1
    v_add_u32 v19, s59, v20
    v_add_u32 v21, 0x10000, v20
    v_lshrrev_b32 v30, 2, v1
    v_and_b32 v29, 12, v30
    v_lshlrev_b32 v29, 1, v29
    v_and_b32 v30, 3, v30
    v_add_u32 v29, v29, v30
    v_lshlrev_b32 v29, 10, v29
    v_lshl_add_u32 v29, v42, 4, v29
    s_lshl_b32 s3, s57, 19
    s_lshl_b32 s63, s54, 6
    s_add_u32 s3, s3, s63
    v_add_u32 v22, s3, v29
    v_add_u32 v23, 4096, v22
    s_lshl_b32 s67, s54, 13
    s_add_u32 s67, s67, 131072
    v_lshrrev_b32 v29, 1, v40
    v_lshl_add_u32 v29, v29, 2, v41
    v_lshlrev_b32 v29, 6, v29
    v_lshl_add_u32 v29, v42, 4, v29
    s_add_u32 s3, s59, 24584
    v_mov_b32 v30, s3
    v_mov_b32 v31, s67
    v_and_b32 v24, 1, v40
    v_cmp_eq_u32 vcc, 1, v24
    s_nop 1
    v_cndmask_b32 v30, v30, v31, vcc
    v_add_u32 v24, v29, v30
    s_add_u32 s3, s59, 12296
    v_mov_b32 v30, s3
    v_mov_b32 v31, s59
    v_cndmask_b32 v30, v30, v31, vcc
    v_add_u32 v0, v29, v30
    s_lshl_b32 s74, s55, 4
    s_add_u32 s74, s74, s56
    s_lshl_b32 s3, s74, 3
    s_add_u32 s3, s3, s57
    s_mul_i32 s3, s3, 98304
    s_mul_i32 s63, s54, 6144
    s_add_u32 s3, s3, s63
    v_add_u32 v28, s3, v20
    s_lshl_b32 s3, s74, 4
    s_add_u32 s63, s3, s54
    s_lshl_b32 s63, s63, 7
    s_lshl_b32 s64, s57, 2
    s_add_u32 s63, s63, s64
    s_add_u32 s63, s63, 33554432
    v_mov_b32 v25, s63
    s_lshr_b32 s63, s57, 1
    s_add_u32 s63, s63, s3
    s_lshl_b32 s63, s63, 7
    s_add_u32 s63, s63, 33554432
    v_bfe_u32 v29, v1, 3, 2
    v_lshlrev_b32 v29, 9, v29
    v_and_b32 v30, 7, v1
    v_lshl_add_u32 v29, v30, 2, v29
    v_add_u32 v26, s63, v29
    s_mul_i32 s3, s74, 786432
    s_mul_i32 s63, s57, 3072
    s_add_u32 s3, s3, s63
    s_mul_i32 s63, s54, 768
    s_add_u32 s3, s3, s63
    v_min_u32 v29, 47, v1
    v_lshlrev_b32 v29, 4, v29
    v_add_u32 v27, s3, v29
    s_and_b32 s72, s56, 3
    s_mov_b32 s71, 0x3e0293ee
    s_cmp_eq_u32 s55, 0
    s_cselect_b32 s12, s34, s44
    s_cselect_b32 s13, s35, s45
    s_mov_b32 s14, 12582912
    s_mov_b32 s15, 0x20000
    s_cselect_b32 s16, s36, s46
    s_cselect_b32 s17, s37, s47
    s_mov_b32 s18, 12582912
    s_mov_b32 s19, 0x20000
    s_cselect_b32 s24, s40, s50
    s_cselect_b32 s25, s41, s51
    s_mov_b32 s26, 4194304
    s_mov_b32 s27, 0x20000
    s_mov_b32 s28, s52
    s_mov_b32 s29, s53
    s_mov_b32 s30, 0x10000000
    s_mov_b32 s31, 0x20000
    s_mov_b32 s32, s4
    s_mov_b32 s33, s5
    s_mov_b32 s34, 3145728
    s_mov_b32 s35, 0x20000
    s_mov_b32 s36, s6
    s_mov_b32 s37, s7
    s_mov_b32 s38, 256
    s_mov_b32 s39, 0x20000
    s_mov_b32 s41, s74
    v_mov_b32 v29, 0
    buffer_store_dword v29, v26, s[28:31], 0 offen sc1
    s_waitcnt vmcnt(12)
    s_barrier
    ds_read_b64_tr_b16 a[0:1], v12 offset:0
    ds_read_b64_tr_b16 a[2:3], v12 offset:1024
    ds_read_b64_tr_b16 a[4:5], v12 offset:8
    ds_read_b64_tr_b16 a[6:7], v12 offset:1032
    ds_read_b64_tr_b16 a[8:9], v13 offset:0
    ds_read_b64_tr_b16 a[10:11], v13 offset:1024
    ds_read_b64_tr_b16 a[12:13], v13 offset:8
    ds_read_b64_tr_b16 a[14:15], v13 offset:1032
    ds_read_b64_tr_b16 a[16:17], v14 offset:0
    ds_read_b64_tr_b16 a[18:19], v14 offset:1024
    ds_read_b64_tr_b16 a[20:21], v14 offset:8
    ds_read_b64_tr_b16 a[22:23], v14 offset:1032
    ds_read_b64_tr_b16 a[24:25], v15 offset:0
    ds_read_b64_tr_b16 a[26:27], v15 offset:1024
    ds_read_b64_tr_b16 a[28:29], v15 offset:8
    ds_read_b64_tr_b16 a[30:31], v15 offset:1032
    ds_read_b128 a[64:67], v16 offset:0
    ds_read_b128 a[68:71], v16 offset:2048
    ds_read_b128 a[72:75], v16 offset:4096
    ds_read_b128 a[76:79], v16 offset:6144
    ds_read_b128 a[80:83], v16 offset:8192
    ds_read_b128 a[84:87], v16 offset:10240
    s_waitcnt lgkmcnt(0)
    s_lshr_b32 s3, s2, 3
    s_mul_hi_u32 s63, s3, 1431655766
    s_mul_i32 s63, s63, 3
    s_sub_u32 s3, s3, s63
    s_cmp_eq_u32 s3, 1
    s_cbranch_scc1 L_p1_1
    s_cmp_eq_u32 s3, 2
    s_cbranch_scc1 L_p1_2
L_p1_0:
    v_mfma_f32_16x16x32_bf16 v[64:67], a[0:3], a[64:67], 0
    ds_read_b128 a[88:91], v17 offset:0
    v_mfma_f32_16x16x32_bf16 v[68:71], a[0:3], a[68:71], 0
    ds_read_b128 a[92:95], v17 offset:2048
    v_mfma_f32_16x16x32_bf16 v[72:75], a[0:3], a[72:75], 0
    ds_read_b128 a[96:99], v17 offset:4096
    v_mfma_f32_16x16x32_bf16 v[76:79], a[0:3], a[76:79], 0
    ds_read_b128 a[100:103], v17 offset:6144
    v_mfma_f32_16x16x32_bf16 v[80:83], a[0:3], a[80:83], 0
    ds_read_b128 a[104:107], v17 offset:8192
    v_mfma_f32_16x16x32_bf16 v[84:87], a[0:3], a[84:87], 0
    ds_read_b128 a[108:111], v17 offset:10240
    v_mfma_f32_16x16x32_bf16 v[108:111], a[4:7], a[84:87], 0
    v_mfma_f32_16x16x32_bf16 v[104:107], a[4:7], a[80:83], 0
    v_mfma_f32_16x16x32_bf16 v[100:103], a[4:7], a[76:79], 0
    v_mfma_f32_16x16x32_bf16 v[96:99], a[4:7], a[72:75], 0
    v_mfma_f32_16x16x32_bf16 v[92:95], a[4:7], a[68:71], 0
    v_mfma_f32_16x16x32_bf16 v[88:91], a[4:7], a[64:67], 0
    v_mfma_f32_16x16x32_bf16 v[112:115], a[8:11], a[64:67], 0
    v_mfma_f32_16x16x32_bf16 v[116:119], a[8:11], a[68:71], 0
    v_mfma_f32_16x16x32_bf16 v[120:123], a[8:11], a[72:75], 0
    v_mfma_f32_16x16x32_bf16 v[124:127], a[8:11], a[76:79], 0
    v_mfma_f32_16x16x32_bf16 v[128:131], a[8:11], a[80:83], 0
    v_mfma_f32_16x16x32_bf16 v[132:135], a[8:11], a[84:87], 0
    v_mfma_f32_16x16x32_bf16 v[156:159], a[12:15], a[84:87], 0
    v_mfma_f32_16x16x32_bf16 v[152:155], a[12:15], a[80:83], 0
    v_mfma_f32_16x16x32_bf16 v[148:151], a[12:15], a[76:79], 0
    v_mfma_f32_16x16x32_bf16 v[144:147], a[12:15], a[72:75], 0
    v_mfma_f32_16x16x32_bf16 v[140:143], a[12:15], a[68:71], 0
    s_waitcnt vmcnt(4)
    ds_read_b64_tr_b16 a[32:33], v12 offset:8192
    v_mfma_f32_16x16x32_bf16 v[136:139], a[12:15], a[64:67], 0
    ds_read_b64_tr_b16 a[34:35], v12 offset:9216
    v_mfma_f32_16x16x32_bf16 v[160:163], a[16:19], a[64:67], 0
    ds_read_b64_tr_b16 a[36:37], v12 offset:8200
    s_add_u32 s60, s73, s75
    s_or_b32 s61, s60, 131072
    s_add_u32 m0, s59, 16384
    s_nop 0
    buffer_load_dwordx4 v5, s[20:23], s60 offen offset:0  lds
    v_mfma_f32_16x16x32_bf16 v[164:167], a[16:19], a[68:71], 0
    ds_read_b64_tr_b16 a[38:39], v12 offset:9224
    v_mfma_f32_16x16x32_bf16 v[168:171], a[16:19], a[72:75], 0
    ds_read_b64_tr_b16 a[40:41], v13 offset:8192
    v_mfma_f32_16x16x32_bf16 v[172:175], a[16:19], a[76:79], 0
    ds_read_b64_tr_b16 a[42:43], v13 offset:9216
    buffer_load_dwordx4 v6, s[20:23], s60 offen offset:1024  lds
    v_mfma_f32_16x16x32_bf16 v[176:179], a[16:19], a[80:83], 0
    ds_read_b64_tr_b16 a[44:45], v13 offset:8200
    v_mfma_f32_16x16x32_bf16 v[180:183], a[16:19], a[84:87], 0
    ds_read_b64_tr_b16 a[46:47], v13 offset:9224
    v_mfma_f32_16x16x32_bf16 v[204:207], a[20:23], a[84:87], 0
    ds_read_b64_tr_b16 a[48:49], v14 offset:8192
    buffer_load_dwordx4 v7, s[20:23], s60 offen offset:2048  lds
    v_mfma_f32_16x16x32_bf16 v[200:203], a[20:23], a[80:83], 0
    ds_read_b64_tr_b16 a[50:51], v14 offset:9216
    v_mfma_f32_16x16x32_bf16 v[196:199], a[20:23], a[76:79], 0
    ds_read_b64_tr_b16 a[52:53], v14 offset:8200
    v_mfma_f32_16x16x32_bf16 v[192:195], a[20:23], a[72:75], 0
    ds_read_b64_tr_b16 a[54:55], v14 offset:9224
    buffer_load_dwordx4 v8, s[20:23], s60 offen offset:3072  lds
    v_mfma_f32_16x16x32_bf16 v[188:191], a[20:23], a[68:71], 0
    ds_read_b64_tr_b16 a[56:57], v15 offset:8192
    v_mfma_f32_16x16x32_bf16 v[184:187], a[20:23], a[64:67], 0
    ds_read_b64_tr_b16 a[58:59], v15 offset:9216
    v_mfma_f32_16x16x32_bf16 v[208:211], a[24:27], a[64:67], 0
    ds_read_b64_tr_b16 a[60:61], v15 offset:8200
    s_add_u32 m0, s59, 20480
    s_nop 0
    buffer_load_dwordx4 v5, s[20:23], s61 offen offset:0  lds
    v_mfma_f32_16x16x32_bf16 v[212:215], a[24:27], a[68:71], 0
    ds_read_b64_tr_b16 a[62:63], v15 offset:9224
    v_mfma_f32_16x16x32_bf16 v[216:219], a[24:27], a[72:75], 0
    v_mfma_f32_16x16x32_bf16 v[220:223], a[24:27], a[76:79], 0
    buffer_load_dwordx4 v6, s[20:23], s61 offen offset:1024  lds
    v_mfma_f32_16x16x32_bf16 v[224:227], a[24:27], a[80:83], 0
    v_mfma_f32_16x16x32_bf16 v[228:231], a[24:27], a[84:87], 0
    v_mfma_f32_16x16x32_bf16 v[252:255], a[28:31], a[84:87], 0
    buffer_load_dwordx4 v7, s[20:23], s61 offen offset:2048  lds
    v_mfma_f32_16x16x32_bf16 v[248:251], a[28:31], a[80:83], 0
    v_mfma_f32_16x16x32_bf16 v[244:247], a[28:31], a[76:79], 0
    v_mfma_f32_16x16x32_bf16 v[240:243], a[28:31], a[72:75], 0
    v_mfma_f32_16x16x32_bf16 v[236:239], a[28:31], a[68:71], 0
    buffer_load_dwordx4 v8, s[20:23], s61 offen offset:3072  lds
    v_mfma_f32_16x16x32_bf16 v[232:235], a[28:31], a[64:67], 0
    s_waitcnt vmcnt(9) lgkmcnt(0)
    s_barrier
    v_mfma_f32_16x16x32_bf16 v[64:67], a[32:35], a[88:91], v[64:67]
    ds_read_b128 a[64:67], v16 offset:12288
    v_mfma_f32_16x16x32_bf16 v[68:71], a[32:35], a[92:95], v[68:71]
    ds_read_b128 a[68:71], v16 offset:14336
    v_mfma_f32_16x16x32_bf16 v[72:75], a[32:35], a[96:99], v[72:75]
    ds_read_b128 a[72:75], v16 offset:16384
    v_mfma_f32_16x16x32_bf16 v[76:79], a[32:35], a[100:103], v[76:79]
    ds_read_b128 a[76:79], v16 offset:18432
    v_mfma_f32_16x16x32_bf16 v[80:83], a[32:35], a[104:107], v[80:83]
    ds_read_b128 a[80:83], v16 offset:20480
    v_mfma_f32_16x16x32_bf16 v[84:87], a[32:35], a[108:111], v[84:87]
    ds_read_b128 a[84:87], v16 offset:22528
    v_mfma_f32_16x16x32_bf16 v[108:111], a[36:39], a[108:111], v[108:111]
    v_mfma_f32_16x16x32_bf16 v[104:107], a[36:39], a[104:107], v[104:107]
    v_mfma_f32_16x16x32_bf16 v[100:103], a[36:39], a[100:103], v[100:103]
    v_mfma_f32_16x16x32_bf16 v[96:99], a[36:39], a[96:99], v[96:99]
    v_mfma_f32_16x16x32_bf16 v[92:95], a[36:39], a[92:95], v[92:95]
    v_mfma_f32_16x16x32_bf16 v[88:91], a[36:39], a[88:91], v[88:91]
    v_mfma_f32_16x16x32_bf16 v[112:115], a[40:43], a[88:91], v[112:115]
    v_mfma_f32_16x16x32_bf16 v[116:119], a[40:43], a[92:95], v[116:119]
    v_mfma_f32_16x16x32_bf16 v[120:123], a[40:43], a[96:99], v[120:123]
    v_mfma_f32_16x16x32_bf16 v[124:127], a[40:43], a[100:103], v[124:127]
    v_mfma_f32_16x16x32_bf16 v[128:131], a[40:43], a[104:107], v[128:131]
    v_mfma_f32_16x16x32_bf16 v[132:135], a[40:43], a[108:111], v[132:135]
    v_mfma_f32_16x16x32_bf16 v[156:159], a[44:47], a[108:111], v[156:159]
    v_mfma_f32_16x16x32_bf16 v[152:155], a[44:47], a[104:107], v[152:155]
    v_mfma_f32_16x16x32_bf16 v[148:151], a[44:47], a[100:103], v[148:151]
    v_mfma_f32_16x16x32_bf16 v[144:147], a[44:47], a[96:99], v[144:147]
    v_mfma_f32_16x16x32_bf16 v[140:143], a[44:47], a[92:95], v[140:143]
    s_waitcnt vmcnt(0)
    ds_read_b64_tr_b16 a[0:1], v12 offset:16384
    v_mfma_f32_16x16x32_bf16 v[136:139], a[44:47], a[88:91], v[136:139]
    ds_read_b64_tr_b16 a[2:3], v12 offset:17408
    v_mfma_f32_16x16x32_bf16 v[160:163], a[48:51], a[88:91], v[160:163]
    ds_read_b64_tr_b16 a[4:5], v12 offset:16392
    s_add_u32 s60, s73, s100
    s_or_b32 s61, s60, 131072
    s_add_u32 m0, s59, 24576
    s_nop 0
    buffer_load_dwordx4 v5, s[20:23], s60 offen offset:0  lds
    v_mfma_f32_16x16x32_bf16 v[164:167], a[48:51], a[92:95], v[164:167]
    ds_read_b64_tr_b16 a[6:7], v12 offset:17416
    v_mfma_f32_16x16x32_bf16 v[168:171], a[48:51], a[96:99], v[168:171]
    ds_read_b64_tr_b16 a[8:9], v13 offset:16384
    v_mfma_f32_16x16x32_bf16 v[172:175], a[48:51], a[100:103], v[172:175]
    ds_read_b64_tr_b16 a[10:11], v13 offset:17408
    buffer_load_dwordx4 v6, s[20:23], s60 offen offset:1024  lds
    v_mfma_f32_16x16x32_bf16 v[176:179], a[48:51], a[104:107], v[176:179]
    ds_read_b64_tr_b16 a[12:13], v13 offset:16392
    v_mfma_f32_16x16x32_bf16 v[180:183], a[48:51], a[108:111], v[180:183]
    ds_read_b64_tr_b16 a[14:15], v13 offset:17416
    v_mfma_f32_16x16x32_bf16 v[204:207], a[52:55], a[108:111], v[204:207]
    ds_read_b64_tr_b16 a[16:17], v14 offset:16384
    buffer_load_dwordx4 v7, s[20:23], s60 offen offset:2048  lds
    v_mfma_f32_16x16x32_bf16 v[200:203], a[52:55], a[104:107], v[200:203]
    ds_read_b64_tr_b16 a[18:19], v14 offset:17408
    v_mfma_f32_16x16x32_bf16 v[196:199], a[52:55], a[100:103], v[196:199]
    ds_read_b64_tr_b16 a[20:21], v14 offset:16392
    v_mfma_f32_16x16x32_bf16 v[192:195], a[52:55], a[96:99], v[192:195]
    ds_read_b64_tr_b16 a[22:23], v14 offset:17416
    buffer_load_dwordx4 v8, s[20:23], s60 offen offset:3072  lds
    v_mfma_f32_16x16x32_bf16 v[188:191], a[52:55], a[92:95], v[188:191]
    ds_read_b64_tr_b16 a[24:25], v15 offset:16384
    v_mfma_f32_16x16x32_bf16 v[184:187], a[52:55], a[88:91], v[184:187]
    ds_read_b64_tr_b16 a[26:27], v15 offset:17408
    v_mfma_f32_16x16x32_bf16 v[208:211], a[56:59], a[88:91], v[208:211]
    ds_read_b64_tr_b16 a[28:29], v15 offset:16392
    s_add_u32 m0, s59, 28672
    s_nop 0
    buffer_load_dwordx4 v5, s[20:23], s61 offen offset:0  lds
    v_mfma_f32_16x16x32_bf16 v[212:215], a[56:59], a[92:95], v[212:215]
    ds_read_b64_tr_b16 a[30:31], v15 offset:17416
    v_mfma_f32_16x16x32_bf16 v[216:219], a[56:59], a[96:99], v[216:219]
    v_mfma_f32_16x16x32_bf16 v[220:223], a[56:59], a[100:103], v[220:223]
    buffer_load_dwordx4 v6, s[20:23], s61 offen offset:1024  lds
    v_mfma_f32_16x16x32_bf16 v[224:227], a[56:59], a[104:107], v[224:227]
    v_mfma_f32_16x16x32_bf16 v[228:231], a[56:59], a[108:111], v[228:231]
    v_mfma_f32_16x16x32_bf16 v[252:255], a[60:63], a[108:111], v[252:255]
    buffer_load_dwordx4 v7, s[20:23], s61 offen offset:2048  lds
    s_add_u32 m0, s66, 0
    s_nop 0
    buffer_load_dwordx4 v2, s[8:11], s62 offen offset:0  lds
    v_mfma_f32_16x16x32_bf16 v[248:251], a[60:63], a[104:107], v[248:251]
    v_mfma_f32_16x16x32_bf16 v[244:247], a[60:63], a[100:103], v[244:247]
    buffer_load_dwordx4 v3, s[8:11], s62 offen offset:1024  lds
    v_mfma_f32_16x16x32_bf16 v[240:243], a[60:63], a[96:99], v[240:243]
    s_add_u32 m0, s59, 28672
    v_mfma_f32_16x16x32_bf16 v[236:239], a[60:63], a[92:95], v[236:239]
    buffer_load_dwordx4 v8, s[20:23], s61 offen offset:3072  lds
    s_add_u32 s73, s73, 524288
    s_and_b32 s73, s73, 0x3fffff
    s_add_u32 m0, s66, 0
    s_nop 0
    buffer_load_dwordx4 v4, s[8:11], s62 offen offset:2048  lds
    s_add_u32 s62, s62, 128
    s_and_b32 s62, s62, 1023
    v_mfma_f32_16x16x32_bf16 v[232:235], a[60:63], a[88:91], v[232:235]
    s_waitcnt lgkmcnt(0)
    v_mfma_f32_16x16x32_bf16 v[64:67], a[0:3], a[64:67], v[64:67]
    ds_read_b128 a[88:91], v17 offset:12288
    v_mfma_f32_16x16x32_bf16 v[68:71], a[0:3], a[68:71], v[68:71]
    ds_read_b128 a[92:95], v17 offset:14336
    s_add_u32 s60, s73, s75
    s_or_b32 s61, s60, 131072
    s_add_u32 m0, s59, 0
    s_nop 0
    buffer_load_dwordx4 v5, s[20:23], s60 offen offset:0  lds
    v_mfma_f32_16x16x32_bf16 v[72:75], a[0:3], a[72:75], v[72:75]
    ds_read_b128 a[96:99], v17 offset:16384
    v_mfma_f32_16x16x32_bf16 v[76:79], a[0:3], a[76:79], v[76:79]
    ds_read_b128 a[100:103], v17 offset:18432
    buffer_load_dwordx4 v6, s[20:23], s60 offen offset:1024  lds
    v_mfma_f32_16x16x32_bf16 v[80:83], a[0:3], a[80:83], v[80:83]
    ds_read_b128 a[104:107], v17 offset:20480
    v_mfma_f32_16x16x32_bf16 v[84:87], a[0:3], a[84:87], v[84:87]
    ds_read_b128 a[108:111], v17 offset:22528
    v_mfma_f32_16x16x32_bf16 v[108:111], a[4:7], a[84:87], v[108:111]
    buffer_load_dwordx4 v7, s[20:23], s60 offen offset:2048  lds
    v_mfma_f32_16x16x32_bf16 v[104:107], a[4:7], a[80:83], v[104:107]
    v_mfma_f32_16x16x32_bf16 v[100:103], a[4:7], a[76:79], v[100:103]
    v_mfma_f32_16x16x32_bf16 v[96:99], a[4:7], a[72:75], v[96:99]
    buffer_load_dwordx4 v8, s[20:23], s60 offen offset:3072  lds
    v_mfma_f32_16x16x32_bf16 v[92:95], a[4:7], a[68:71], v[92:95]
    v_mfma_f32_16x16x32_bf16 v[88:91], a[4:7], a[64:67], v[88:91]
    s_add_u32 m0, s59, 4096
    v_mfma_f32_16x16x32_bf16 v[112:115], a[8:11], a[64:67], v[112:115]
    buffer_load_dwordx4 v5, s[20:23], s61 offen offset:0  lds
    v_mfma_f32_16x16x32_bf16 v[116:119], a[8:11], a[68:71], v[116:119]
    v_mfma_f32_16x16x32_bf16 v[120:123], a[8:11], a[72:75], v[120:123]
    v_mfma_f32_16x16x32_bf16 v[124:127], a[8:11], a[76:79], v[124:127]
    buffer_load_dwordx4 v6, s[20:23], s61 offen offset:1024  lds
    v_mfma_f32_16x16x32_bf16 v[128:131], a[8:11], a[80:83], v[128:131]
    v_mfma_f32_16x16x32_bf16 v[132:135], a[8:11], a[84:87], v[132:135]
    v_mfma_f32_16x16x32_bf16 v[156:159], a[12:15], a[84:87], v[156:159]
    buffer_load_dwordx4 v7, s[20:23], s61 offen offset:2048  lds
    v_mfma_f32_16x16x32_bf16 v[152:155], a[12:15], a[80:83], v[152:155]
    v_mfma_f32_16x16x32_bf16 v[148:151], a[12:15], a[76:79], v[148:151]
    v_mfma_f32_16x16x32_bf16 v[144:147], a[12:15], a[72:75], v[144:147]
    buffer_load_dwordx4 v8, s[20:23], s61 offen offset:3072  lds
    v_mfma_f32_16x16x32_bf16 v[140:143], a[12:15], a[68:71], v[140:143]
    s_waitcnt vmcnt(9)
    ds_read_b64_tr_b16 a[32:33], v12 offset:24576
    v_mfma_f32_16x16x32_bf16 v[136:139], a[12:15], a[64:67], v[136:139]
    ds_read_b64_tr_b16 a[34:35], v12 offset:25600
    v_mfma_f32_16x16x32_bf16 v[160:163], a[16:19], a[64:67], v[160:163]
    ds_read_b64_tr_b16 a[36:37], v12 offset:24584
    s_add_u32 s60, s73, s100
    s_or_b32 s61, s60, 131072
    s_add_u32 m0, s59, 8192
    s_nop 0
    buffer_load_dwordx4 v5, s[20:23], s60 offen offset:0  lds
    v_mfma_f32_16x16x32_bf16 v[164:167], a[16:19], a[68:71], v[164:167]
    ds_read_b64_tr_b16 a[38:39], v12 offset:25608
    v_mfma_f32_16x16x32_bf16 v[168:171], a[16:19], a[72:75], v[168:171]
    ds_read_b64_tr_b16 a[40:41], v13 offset:24576
    v_mfma_f32_16x16x32_bf16 v[172:175], a[16:19], a[76:79], v[172:175]
    ds_read_b64_tr_b16 a[42:43], v13 offset:25600
    buffer_load_dwordx4 v6, s[20:23], s60 offen offset:1024  lds
    v_mfma_f32_16x16x32_bf16 v[176:179], a[16:19], a[80:83], v[176:179]
    ds_read_b64_tr_b16 a[44:45], v13 offset:24584
    v_mfma_f32_16x16x32_bf16 v[180:183], a[16:19], a[84:87], v[180:183]
    ds_read_b64_tr_b16 a[46:47], v13 offset:25608
    v_mfma_f32_16x16x32_bf16 v[204:207], a[20:23], a[84:87], v[204:207]
    ds_read_b64_tr_b16 a[48:49], v14 offset:24576
    buffer_load_dwordx4 v7, s[20:23], s60 offen offset:2048  lds
    v_mfma_f32_16x16x32_bf16 v[200:203], a[20:23], a[80:83], v[200:203]
    ds_read_b64_tr_b16 a[50:51], v14 offset:25600
    v_mfma_f32_16x16x32_bf16 v[196:199], a[20:23], a[76:79], v[196:199]
    ds_read_b64_tr_b16 a[52:53], v14 offset:24584
    v_mfma_f32_16x16x32_bf16 v[192:195], a[20:23], a[72:75], v[192:195]
    ds_read_b64_tr_b16 a[54:55], v14 offset:25608
    buffer_load_dwordx4 v8, s[20:23], s60 offen offset:3072  lds
    v_mfma_f32_16x16x32_bf16 v[188:191], a[20:23], a[68:71], v[188:191]
    ds_read_b64_tr_b16 a[56:57], v15 offset:24576
    v_mfma_f32_16x16x32_bf16 v[184:187], a[20:23], a[64:67], v[184:187]
    ds_read_b64_tr_b16 a[58:59], v15 offset:25600
    v_mfma_f32_16x16x32_bf16 v[208:211], a[24:27], a[64:67], v[208:211]
    ds_read_b64_tr_b16 a[60:61], v15 offset:24584
    s_add_u32 m0, s59, 12288
    s_nop 0
    buffer_load_dwordx4 v5, s[20:23], s61 offen offset:0  lds
    v_mfma_f32_16x16x32_bf16 v[212:215], a[24:27], a[68:71], v[212:215]
    ds_read_b64_tr_b16 a[62:63], v15 offset:25608
    v_mfma_f32_16x16x32_bf16 v[216:219], a[24:27], a[72:75], v[216:219]
    v_mfma_f32_16x16x32_bf16 v[220:223], a[24:27], a[76:79], v[220:223]
    buffer_load_dwordx4 v6, s[20:23], s61 offen offset:1024  lds
    v_mfma_f32_16x16x32_bf16 v[224:227], a[24:27], a[80:83], v[224:227]
    v_mfma_f32_16x16x32_bf16 v[228:231], a[24:27], a[84:87], v[228:231]
    v_mfma_f32_16x16x32_bf16 v[252:255], a[28:31], a[84:87], v[252:255]
    buffer_load_dwordx4 v7, s[20:23], s61 offen offset:2048  lds
    v_mfma_f32_16x16x32_bf16 v[248:251], a[28:31], a[80:83], v[248:251]
    v_mfma_f32_16x16x32_bf16 v[244:247], a[28:31], a[76:79], v[244:247]
    v_mfma_f32_16x16x32_bf16 v[240:243], a[28:31], a[72:75], v[240:243]
    v_mfma_f32_16x16x32_bf16 v[236:239], a[28:31], a[68:71], v[236:239]
    buffer_load_dwordx4 v8, s[20:23], s61 offen offset:3072  lds
    s_add_u32 s73, s73, 524288
    s_and_b32 s73, s73, 0x3fffff
    v_mfma_f32_16x16x32_bf16 v[232:235], a[28:31], a[64:67], v[232:235]
    s_waitcnt vmcnt(16) lgkmcnt(0)
    s_barrier
    s_waitcnt vmcnt(8)
    v_mfma_f32_16x16x32_bf16 v[64:67], a[32:35], a[88:91], v[64:67]
    ds_read_b64_tr_b16 a[0:1], v12 offset:0
    s_add_u32 s60, s73, s75
    s_or_b32 s61, s60, 131072
    s_add_u32 m0, s59, 16384
    s_nop 0
    buffer_load_dwordx4 v5, s[20:23], s60 offen offset:0  lds
    v_mfma_f32_16x16x32_bf16 v[68:71], a[32:35], a[92:95], v[68:71]
    ds_read_b64_tr_b16 a[2:3], v12 offset:1024
    v_mfma_f32_16x16x32_bf16 v[72:75], a[32:35], a[96:99], v[72:75]
    ds_read_b64_tr_b16 a[4:5], v12 offset:8
    buffer_load_dwordx4 v6, s[20:23], s60 offen offset:1024  lds
    v_mfma_f32_16x16x32_bf16 v[76:79], a[32:35], a[100:103], v[76:79]
    ds_read_b64_tr_b16 a[6:7], v12 offset:1032
    v_mfma_f32_16x16x32_bf16 v[80:83], a[32:35], a[104:107], v[80:83]
    ds_read_b64_tr_b16 a[8:9], v13 offset:0
    buffer_load_dwordx4 v7, s[20:23], s60 offen offset:2048  lds
    v_mfma_f32_16x16x32_bf16 v[84:87], a[32:35], a[108:111], v[84:87]
    ds_read_b64_tr_b16 a[10:11], v13 offset:1024
    v_mfma_f32_16x16x32_bf16 v[108:111], a[36:39], a[108:111], v[108:111]
    ds_read_b64_tr_b16 a[12:13], v13 offset:8
    buffer_load_dwordx4 v8, s[20:23], s60 offen offset:3072  lds
    v_mfma_f32_16x16x32_bf16 v[104:107], a[36:39], a[104:107], v[104:107]
    ds_read_b64_tr_b16 a[14:15], v13 offset:1032
    v_mfma_f32_16x16x32_bf16 v[100:103], a[36:39], a[100:103], v[100:103]
    ds_read_b64_tr_b16 a[16:17], v14 offset:0
    s_add_u32 m0, s59, 20480
    s_nop 0
    buffer_load_dwordx4 v5, s[20:23], s61 offen offset:0  lds
    v_mfma_f32_16x16x32_bf16 v[96:99], a[36:39], a[96:99], v[96:99]
    ds_read_b64_tr_b16 a[18:19], v14 offset:1024
    v_mfma_f32_16x16x32_bf16 v[92:95], a[36:39], a[92:95], v[92:95]
    ds_read_b64_tr_b16 a[20:21], v14 offset:8
    buffer_load_dwordx4 v6, s[20:23], s61 offen offset:1024  lds
    v_mfma_f32_16x16x32_bf16 v[88:91], a[36:39], a[88:91], v[88:91]
    ds_read_b64_tr_b16 a[22:23], v14 offset:1032
    v_mfma_f32_16x16x32_bf16 v[112:115], a[40:43], a[88:91], v[112:115]
    ds_read_b64_tr_b16 a[24:25], v15 offset:0
    buffer_load_dwordx4 v7, s[20:23], s61 offen offset:2048  lds
    v_mfma_f32_16x16x32_bf16 v[116:119], a[40:43], a[92:95], v[116:119]
    ds_read_b64_tr_b16 a[26:27], v15 offset:1024
    v_mfma_f32_16x16x32_bf16 v[120:123], a[40:43], a[96:99], v[120:123]
    ds_read_b64_tr_b16 a[28:29], v15 offset:8
    buffer_load_dwordx4 v8, s[20:23], s61 offen offset:3072  lds
    v_mfma_f32_16x16x32_bf16 v[124:127], a[40:43], a[100:103], v[124:127]
    ds_read_b64_tr_b16 a[30:31], v15 offset:1032
    v_mfma_f32_16x16x32_bf16 v[128:131], a[40:43], a[104:107], v[128:131]
    ds_read_b128 a[64:67], v16 offset:0
    s_mov_b32 s64, 0
    s_add_u32 m0, s59, 24576
    s_nop 0
    buffer_load_dwordx4 v32, s[12:15], s64 offen offset:0 nt lds
    v_mfma_f32_16x16x32_bf16 v[132:135], a[40:43], a[108:111], v[132:135]
    ds_read_b128 a[68:71], v16 offset:2048
    v_mfma_f32_16x16x32_bf16 v[156:159], a[44:47], a[108:111], v[156:159]
    ds_read_b128 a[72:75], v16 offset:4096
    buffer_load_dwordx4 v33, s[12:15], s64 offen offset:1024 nt lds
    v_mfma_f32_16x16x32_bf16 v[152:155], a[44:47], a[104:107], v[152:155]
    ds_read_b128 a[76:79], v16 offset:6144
    v_mfma_f32_16x16x32_bf16 v[148:151], a[44:47], a[100:103], v[148:151]
    ds_read_b128 a[80:83], v16 offset:8192
    buffer_load_dwordx4 v34, s[12:15], s64 offen offset:2048 nt lds
    v_mfma_f32_16x16x32_bf16 v[144:147], a[44:47], a[96:99], v[144:147]
    ds_read_b128 a[84:87], v16 offset:10240
    v_mfma_f32_16x16x32_bf16 v[140:143], a[44:47], a[92:95], v[140:143]
    buffer_load_dwordx4 v35, s[12:15], s64 offen offset:3072 nt lds
    v_mfma_f32_16x16x32_bf16 v[136:139], a[44:47], a[88:91], v[136:139]
    v_mfma_f32_16x16x32_bf16 v[160:163], a[48:51], a[88:91], v[160:163]
    s_mov_b32 s64, 4096
    s_add_u32 m0, s59, 28672
    s_nop 0
    buffer_load_dwordx4 v32, s[12:15], s64 offen offset:0 nt lds
    v_mfma_f32_16x16x32_bf16 v[164:167], a[48:51], a[92:95], v[164:167]
    v_mfma_f32_16x16x32_bf16 v[168:171], a[48:51], a[96:99], v[168:171]
    buffer_load_dwordx4 v33, s[12:15], s64 offen offset:1024 nt lds
    v_mfma_f32_16x16x32_bf16 v[172:175], a[48:51], a[100:103], v[172:175]
    v_mfma_f32_16x16x32_bf16 v[176:179], a[48:51], a[104:107], v[176:179]
    buffer_load_dwordx4 v34, s[12:15], s64 offen offset:2048 nt lds
    v_mfma_f32_16x16x32_bf16 v[180:183], a[48:51], a[108:111], v[180:183]
    v_mfma_f32_16x16x32_bf16 v[204:207], a[52:55], a[108:111], v[204:207]
    buffer_load_dwordx4 v35, s[12:15], s64 offen offset:3072 nt lds
    v_mfma_f32_16x16x32_bf16 v[200:203], a[52:55], a[104:107], v[200:203]
    v_mfma_f32_16x16x32_bf16 v[196:199], a[52:55], a[100:103], v[196:199]
    v_mfma_f32_16x16x32_bf16 v[192:195], a[52:55], a[96:99], v[192:195]
    v_mfma_f32_16x16x32_bf16 v[188:191], a[52:55], a[92:95], v[188:191]
    v_mfma_f32_16x16x32_bf16 v[184:187], a[52:55], a[88:91], v[184:187]
    v_mfma_f32_16x16x32_bf16 v[208:211], a[56:59], a[88:91], v[208:211]
    v_mfma_f32_16x16x32_bf16 v[212:215], a[56:59], a[92:95], v[212:215]
    v_mfma_f32_16x16x32_bf16 v[216:219], a[56:59], a[96:99], v[216:219]
    v_mfma_f32_16x16x32_bf16 v[220:223], a[56:59], a[100:103], v[220:223]
    v_mfma_f32_16x16x32_bf16 v[224:227], a[56:59], a[104:107], v[224:227]
    v_mfma_f32_16x16x32_bf16 v[228:231], a[56:59], a[108:111], v[228:231]
    s_add_u32 m0, s66, 12288
    v_mfma_f32_16x16x32_bf16 v[252:255], a[60:63], a[108:111], v[252:255]
    buffer_load_dwordx4 v2, s[8:11], s62 offen offset:0  lds
    v_mfma_f32_16x16x32_bf16 v[248:251], a[60:63], a[104:107], v[248:251]
    v_mfma_f32_16x16x32_bf16 v[244:247], a[60:63], a[100:103], v[244:247]
    buffer_load_dwordx4 v3, s[8:11], s62 offen offset:1024  lds
    v_mfma_f32_16x16x32_bf16 v[240:243], a[60:63], a[96:99], v[240:243]
    v_mfma_f32_16x16x32_bf16 v[236:239], a[60:63], a[92:95], v[236:239]
    buffer_load_dwordx4 v4, s[8:11], s62 offen offset:2048  lds
    s_add_u32 s62, s62, 128
    s_and_b32 s62, s62, 1023
    v_mfma_f32_16x16x32_bf16 v[232:235], a[60:63], a[88:91], v[232:235]
    s_waitcnt lgkmcnt(0)
    s_waitcnt vmcnt(19)
    v_mfma_f32_16x16x32_bf16 v[64:67], a[0:3], a[64:67], v[64:67]
    ds_read_b64_tr_b16 a[32:33], v12 offset:8192
    v_mfma_f32_16x16x32_bf16 v[68:71], a[0:3], a[68:71], v[68:71]
    ds_read_b64_tr_b16 a[34:35], v12 offset:9216
    v_mfma_f32_16x16x32_bf16 v[72:75], a[0:3], a[72:75], v[72:75]
    ds_read_b64_tr_b16 a[36:37], v12 offset:8200
    v_mfma_f32_16x16x32_bf16 v[76:79], a[0:3], a[76:79], v[76:79]
    ds_read_b64_tr_b16 a[38:39], v12 offset:9224
    v_mfma_f32_16x16x32_bf16 v[80:83], a[0:3], a[80:83], v[80:83]
    ds_read_b64_tr_b16 a[40:41], v13 offset:8192
    v_mfma_f32_16x16x32_bf16 v[84:87], a[0:3], a[84:87], v[84:87]
    ds_read_b64_tr_b16 a[42:43], v13 offset:9216
    v_mfma_f32_16x16x32_bf16 v[108:111], a[4:7], a[84:87], v[108:111]
    ds_read_b64_tr_b16 a[44:45], v13 offset:8200
    v_mfma_f32_16x16x32_bf16 v[104:107], a[4:7], a[80:83], v[104:107]
    ds_read_b64_tr_b16 a[46:47], v13 offset:9224
    v_mfma_f32_16x16x32_bf16 v[100:103], a[4:7], a[76:79], v[100:103]
    ds_read_b64_tr_b16 a[48:49], v14 offset:8192
    v_mfma_f32_16x16x32_bf16 v[96:99], a[4:7], a[72:75], v[96:99]
    ds_read_b64_tr_b16 a[50:51], v14 offset:9216
    v_mfma_f32_16x16x32_bf16 v[92:95], a[4:7], a[68:71], v[92:95]
    ds_read_b64_tr_b16 a[52:53], v14 offset:8200
    v_mfma_f32_16x16x32_bf16 v[88:91], a[4:7], a[64:67], v[88:91]
    ds_read_b64_tr_b16 a[54:55], v14 offset:9224
    v_mfma_f32_16x16x32_bf16 v[112:115], a[8:11], a[64:67], v[112:115]
    ds_read_b64_tr_b16 a[56:57], v15 offset:8192
    v_mfma_f32_16x16x32_bf16 v[116:119], a[8:11], a[68:71], v[116:119]
    ds_read_b64_tr_b16 a[58:59], v15 offset:9216
    v_mfma_f32_16x16x32_bf16 v[120:123], a[8:11], a[72:75], v[120:123]
    ds_read_b64_tr_b16 a[60:61], v15 offset:8200
    v_mfma_f32_16x16x32_bf16 v[124:127], a[8:11], a[76:79], v[124:127]
    ds_read_b64_tr_b16 a[62:63], v15 offset:9224
    v_mfma_f32_16x16x32_bf16 v[128:131], a[8:11], a[80:83], v[128:131]
    ds_read_b128 a[88:91], v17 offset:0
    v_mfma_f32_16x16x32_bf16 v[132:135], a[8:11], a[84:87], v[132:135]
    ds_read_b128 a[92:95], v17 offset:2048
    v_mfma_f32_16x16x32_bf16 v[156:159], a[12:15], a[84:87], v[156:159]
    ds_read_b128 a[96:99], v17 offset:4096
    v_mfma_f32_16x16x32_bf16 v[152:155], a[12:15], a[80:83], v[152:155]
    ds_read_b128 a[100:103], v17 offset:6144
    v_mfma_f32_16x16x32_bf16 v[148:151], a[12:15], a[76:79], v[148:151]
    ds_read_b128 a[104:107], v17 offset:8192
    v_mfma_f32_16x16x32_bf16 v[144:147], a[12:15], a[72:75], v[144:147]
    ds_read_b128 a[108:111], v17 offset:10240
    v_mfma_f32_16x16x32_bf16 v[140:143], a[12:15], a[68:71], v[140:143]
    s_waitcnt vmcnt(3)
    ds_read_b128 a[112:115], v36 offset:24576
    v_mfma_f32_16x16x32_bf16 v[136:139], a[12:15], a[64:67], v[136:139]
    ds_read_b128 a[116:119], v37 offset:24576
    v_mfma_f32_16x16x32_bf16 v[160:163], a[16:19], a[64:67], v[160:163]
    ds_read_b128 a[120:123], v38 offset:24576
    v_mfma_f32_16x16x32_bf16 v[164:167], a[16:19], a[68:71], v[164:167]
    ds_read_b128 a[124:127], v39 offset:24576
    v_mfma_f32_16x16x32_bf16 v[168:171], a[16:19], a[72:75], v[168:171]
    ds_read_b128 a[128:131], v36 offset:28672
    v_mfma_f32_16x16x32_bf16 v[172:175], a[16:19], a[76:79], v[172:175]
    ds_read_b128 a[132:135], v37 offset:28672
    v_mfma_f32_16x16x32_bf16 v[176:179], a[16:19], a[80:83], v[176:179]
    ds_read_b128 a[136:139], v38 offset:28672
    v_mfma_f32_16x16x32_bf16 v[180:183], a[16:19], a[84:87], v[180:183]
    ds_read_b128 a[140:143], v39 offset:28672
    v_mfma_f32_16x16x32_bf16 v[204:207], a[20:23], a[84:87], v[204:207]
    v_mfma_f32_16x16x32_bf16 v[200:203], a[20:23], a[80:83], v[200:203]
    v_mfma_f32_16x16x32_bf16 v[196:199], a[20:23], a[76:79], v[196:199]
    v_mfma_f32_16x16x32_bf16 v[192:195], a[20:23], a[72:75], v[192:195]
    s_waitcnt lgkmcnt(0)
    v_mfma_f32_16x16x32_bf16 v[188:191], a[20:23], a[68:71], v[188:191]
    s_add_u32 s60, s73, s100
    s_or_b32 s61, s60, 131072
    s_add_u32 m0, s59, 24576
    s_nop 0
    buffer_load_dwordx4 v5, s[20:23], s60 offen offset:0  lds
    v_mfma_f32_16x16x32_bf16 v[184:187], a[20:23], a[64:67], v[184:187]
    buffer_load_dwordx4 v6, s[20:23], s60 offen offset:1024  lds
    v_mfma_f32_16x16x32_bf16 v[208:211], a[24:27], a[64:67], v[208:211]
    v_mfma_f32_16x16x32_bf16 v[212:215], a[24:27], a[68:71], v[212:215]
    buffer_load_dwordx4 v7, s[20:23], s60 offen offset:2048  lds
    v_mfma_f32_16x16x32_bf16 v[216:219], a[24:27], a[72:75], v[216:219]
    v_mfma_f32_16x16x32_bf16 v[220:223], a[24:27], a[76:79], v[220:223]
    buffer_load_dwordx4 v8, s[20:23], s60 offen offset:3072  lds
    v_mfma_f32_16x16x32_bf16 v[224:227], a[24:27], a[80:83], v[224:227]
    s_add_u32 m0, s59, 28672
    v_mfma_f32_16x16x32_bf16 v[228:231], a[24:27], a[84:87], v[228:231]
    buffer_load_dwordx4 v5, s[20:23], s61 offen offset:0  lds
    v_mfma_f32_16x16x32_bf16 v[252:255], a[28:31], a[84:87], v[252:255]
    v_mfma_f32_16x16x32_bf16 v[248:251], a[28:31], a[80:83], v[248:251]
    buffer_load_dwordx4 v6, s[20:23], s61 offen offset:1024  lds
    v_mfma_f32_16x16x32_bf16 v[244:247], a[28:31], a[76:79], v[244:247]
    v_mfma_f32_16x16x32_bf16 v[240:243], a[28:31], a[72:75], v[240:243]
    buffer_load_dwordx4 v7, s[20:23], s61 offen offset:2048  lds
    v_mfma_f32_16x16x32_bf16 v[236:239], a[28:31], a[68:71], v[236:239]
    v_mfma_f32_16x16x32_bf16 v[232:235], a[28:31], a[64:67], v[232:235]
    buffer_load_dwordx4 v8, s[20:23], s61 offen offset:3072  lds
    s_add_u32 s73, s73, 524288
    s_and_b32 s73, s73, 0x3fffff
    s_waitcnt vmcnt(8)
    s_barrier
    v_mfma_f32_16x16x32_bf16 v[64:67], a[32:35], a[88:91], v[64:67]
    ds_read_b64_tr_b16 a[0:1], v12 offset:16384
    v_mfma_f32_16x16x32_bf16 v[68:71], a[32:35], a[92:95], v[68:71]
    ds_read_b64_tr_b16 a[2:3], v12 offset:17408
    v_mfma_f32_16x16x32_bf16 v[72:75], a[32:35], a[96:99], v[72:75]
    ds_read_b64_tr_b16 a[4:5], v12 offset:16392
    s_add_u32 s60, s73, s75
    s_or_b32 s61, s60, 131072
    s_add_u32 m0, s59, 0
    s_nop 0
    buffer_load_dwordx4 v5, s[20:23], s60 offen offset:0  lds
    v_mfma_f32_16x16x32_bf16 v[76:79], a[32:35], a[100:103], v[76:79]
    ds_read_b64_tr_b16 a[6:7], v12 offset:17416
    v_mfma_f32_16x16x32_bf16 v[80:83], a[32:35], a[104:107], v[80:83]
    ds_read_b64_tr_b16 a[8:9], v13 offset:16384
    v_mfma_f32_16x16x32_bf16 v[84:87], a[32:35], a[108:111], v[84:87]
    ds_read_b64_tr_b16 a[10:11], v13 offset:17408
    v_mfma_f32_16x16x32_bf16 v[108:111], a[36:39], a[108:111], v[108:111]
    ds_read_b64_tr_b16 a[12:13], v13 offset:16392
    v_mfma_f32_16x16x32_bf16 v[104:107], a[36:39], a[104:107], v[104:107]
    ds_read_b64_tr_b16 a[14:15], v13 offset:17416
    buffer_load_dwordx4 v6, s[20:23], s60 offen offset:1024  lds
    v_mfma_f32_16x16x32_bf16 v[100:103], a[36:39], a[100:103], v[100:103]
    ds_read_b64_tr_b16 a[16:17], v14 offset:16384
    v_mfma_f32_16x16x32_bf16 v[96:99], a[36:39], a[96:99], v[96:99]
    ds_read_b64_tr_b16 a[18:19], v14 offset:17408
    v_mfma_f32_16x16x32_bf16 v[92:95], a[36:39], a[92:95], v[92:95]
    ds_read_b64_tr_b16 a[20:21], v14 offset:16392
    v_mfma_f32_16x16x32_bf16 v[88:91], a[36:39], a[88:91], v[88:91]
    ds_read_b64_tr_b16 a[22:23], v14 offset:17416
    v_mfma_f32_16x16x32_bf16 v[112:115], a[40:43], a[88:91], v[112:115]
    ds_read_b64_tr_b16 a[24:25], v15 offset:16384
    buffer_load_dwordx4 v7, s[20:23], s60 offen offset:2048  lds
    v_mfma_f32_16x16x32_bf16 v[116:119], a[40:43], a[92:95], v[116:119]
    ds_read_b64_tr_b16 a[26:27], v15 offset:17408
    v_mfma_f32_16x16x32_bf16 v[120:123], a[40:43], a[96:99], v[120:123]
    ds_read_b64_tr_b16 a[28:29], v15 offset:16392
    v_mfma_f32_16x16x32_bf16 v[124:127], a[40:43], a[100:103], v[124:127]
    ds_read_b64_tr_b16 a[30:31], v15 offset:17416
    v_mfma_f32_16x16x32_bf16 v[128:131], a[40:43], a[104:107], v[128:131]
    ds_read_b128 a[64:67], v16 offset:12288
    v_mfma_f32_16x16x32_bf16 v[132:135], a[40:43], a[108:111], v[132:135]
    ds_read_b128 a[68:71], v16 offset:14336
    v_mfma_f32_16x16x32_bf16 v[156:159], a[44:47], a[108:111], v[156:159]
    ds_read_b128 a[72:75], v16 offset:16384
    buffer_load_dwordx4 v8, s[20:23], s60 offen offset:3072  lds
    v_mfma_f32_16x16x32_bf16 v[152:155], a[44:47], a[104:107], v[152:155]
    ds_read_b128 a[76:79], v16 offset:18432
    v_mfma_f32_16x16x32_bf16 v[148:151], a[44:47], a[100:103], v[148:151]
    ds_read_b128 a[80:83], v16 offset:20480
    v_mfma_f32_16x16x32_bf16 v[144:147], a[44:47], a[96:99], v[144:147]
    ds_read_b128 a[84:87], v16 offset:22528
    v_mfma_f32_16x16x32_bf16 v[140:143], a[44:47], a[92:95], v[140:143]
    s_add_u32 m0, s59, 4096
    v_mfma_f32_16x16x32_bf16 v[136:139], a[44:47], a[88:91], v[136:139]
    buffer_load_dwordx4 v5, s[20:23], s61 offen offset:0  lds
    v_mfma_f32_16x16x32_bf16 v[160:163], a[48:51], a[88:91], v[160:163]
    v_mfma_f32_16x16x32_bf16 v[164:167], a[48:51], a[92:95], v[164:167]
    v_mfma_f32_16x16x32_bf16 v[168:171], a[48:51], a[96:99], v[168:171]
    v_mfma_f32_16x16x32_bf16 v[172:175], a[48:51], a[100:103], v[172:175]
    v_mfma_f32_16x16x32_bf16 v[176:179], a[48:51], a[104:107], v[176:179]
    v_mfma_f32_16x16x32_bf16 v[180:183], a[48:51], a[108:111], v[180:183]
    buffer_load_dwordx4 v6, s[20:23], s61 offen offset:1024  lds
    v_mfma_f32_16x16x32_bf16 v[204:207], a[52:55], a[108:111], v[204:207]
    v_mfma_f32_16x16x32_bf16 v[200:203], a[52:55], a[104:107], v[200:203]
    v_mfma_f32_16x16x32_bf16 v[196:199], a[52:55], a[100:103], v[196:199]
    v_mfma_f32_16x16x32_bf16 v[192:195], a[52:55], a[96:99], v[192:195]
    v_mfma_f32_16x16x32_bf16 v[188:191], a[52:55], a[92:95], v[188:191]
    buffer_load_dwordx4 v7, s[20:23], s61 offen offset:2048  lds
    v_mfma_f32_16x16x32_bf16 v[184:187], a[52:55], a[88:91], v[184:187]
    v_mfma_f32_16x16x32_bf16 v[208:211], a[56:59], a[88:91], v[208:211]
    v_mfma_f32_16x16x32_bf16 v[212:215], a[56:59], a[92:95], v[212:215]
    v_mfma_f32_16x16x32_bf16 v[216:219], a[56:59], a[96:99], v[216:219]
    v_mfma_f32_16x16x32_bf16 v[220:223], a[56:59], a[100:103], v[220:223]
    v_mfma_f32_16x16x32_bf16 v[224:227], a[56:59], a[104:107], v[224:227]
    buffer_load_dwordx4 v8, s[20:23], s61 offen offset:3072  lds
    v_mfma_f32_16x16x32_bf16 v[228:231], a[56:59], a[108:111], v[228:231]
    s_add_u32 m0, s66, 0
    v_mfma_f32_16x16x32_bf16 v[252:255], a[60:63], a[108:111], v[252:255]
    buffer_load_dwordx4 v2, s[8:11], s62 offen offset:0  lds
    v_mfma_f32_16x16x32_bf16 v[248:251], a[60:63], a[104:107], v[248:251]
    v_mfma_f32_16x16x32_bf16 v[244:247], a[60:63], a[100:103], v[244:247]
    buffer_load_dwordx4 v3, s[8:11], s62 offen offset:1024  lds
    v_mfma_f32_16x16x32_bf16 v[240:243], a[60:63], a[96:99], v[240:243]
    v_mfma_f32_16x16x32_bf16 v[236:239], a[60:63], a[92:95], v[236:239]
    buffer_load_dwordx4 v4, s[8:11], s62 offen offset:2048  lds
    s_add_u32 s62, s62, 128
    s_and_b32 s62, s62, 1023
    v_mfma_f32_16x16x32_bf16 v[232:235], a[60:63], a[88:91], v[232:235]
    s_waitcnt lgkmcnt(0)
    s_waitcnt vmcnt(11)
    v_mfma_f32_16x16x32_bf16 v[64:67], a[0:3], a[64:67], v[64:67]
    ds_read_b64_tr_b16 a[32:33], v12 offset:24576
    s_add_u32 s60, s73, s100
    s_or_b32 s61, s60, 131072
    s_add_u32 m0, s59, 8192
    s_nop 0
    buffer_load_dwordx4 v5, s[20:23], s60 offen offset:0  lds
    v_mfma_f32_16x16x32_bf16 v[68:71], a[0:3], a[68:71], v[68:71]
    ds_read_b64_tr_b16 a[34:35], v12 offset:25600
    v_mfma_f32_16x16x32_bf16 v[72:75], a[0:3], a[72:75], v[72:75]
    ds_read_b64_tr_b16 a[36:37], v12 offset:24584
    buffer_load_dwordx4 v6, s[20:23], s60 offen offset:1024  lds
    v_mfma_f32_16x16x32_bf16 v[76:79], a[0:3], a[76:79], v[76:79]
    ds_read_b64_tr_b16 a[38:39], v12 offset:25608
    v_mfma_f32_16x16x32_bf16 v[80:83], a[0:3], a[80:83], v[80:83]
    ds_read_b64_tr_b16 a[40:41], v13 offset:24576
    buffer_load_dwordx4 v7, s[20:23], s60 offen offset:2048  lds
    v_mfma_f32_16x16x32_bf16 v[84:87], a[0:3], a[84:87], v[84:87]
    ds_read_b64_tr_b16 a[42:43], v13 offset:25600
    v_mfma_f32_16x16x32_bf16 v[108:111], a[4:7], a[84:87], v[108:111]
    ds_read_b64_tr_b16 a[44:45], v13 offset:24584
    buffer_load_dwordx4 v8, s[20:23], s60 offen offset:3072  lds
    v_mfma_f32_16x16x32_bf16 v[104:107], a[4:7], a[80:83], v[104:107]
    ds_read_b64_tr_b16 a[46:47], v13 offset:25608
    v_mfma_f32_16x16x32_bf16 v[100:103], a[4:7], a[76:79], v[100:103]
    ds_read_b64_tr_b16 a[48:49], v14 offset:24576
    s_add_u32 m0, s59, 12288
    s_nop 0
    buffer_load_dwordx4 v5, s[20:23], s61 offen offset:0  lds
    v_mfma_f32_16x16x32_bf16 v[96:99], a[4:7], a[72:75], v[96:99]
    ds_read_b64_tr_b16 a[50:51], v14 offset:25600
    v_mfma_f32_16x16x32_bf16 v[92:95], a[4:7], a[68:71], v[92:95]
    ds_read_b64_tr_b16 a[52:53], v14 offset:24584
    buffer_load_dwordx4 v6, s[20:23], s61 offen offset:1024  lds
    v_mfma_f32_16x16x32_bf16 v[88:91], a[4:7], a[64:67], v[88:91]
    ds_read_b64_tr_b16 a[54:55], v14 offset:25608
    v_mfma_f32_16x16x32_bf16 v[112:115], a[8:11], a[64:67], v[112:115]
    ds_read_b64_tr_b16 a[56:57], v15 offset:24576
    buffer_load_dwordx4 v7, s[20:23], s61 offen offset:2048  lds
    v_mfma_f32_16x16x32_bf16 v[116:119], a[8:11], a[68:71], v[116:119]
    ds_read_b64_tr_b16 a[58:59], v15 offset:25600
    v_mfma_f32_16x16x32_bf16 v[120:123], a[8:11], a[72:75], v[120:123]
    ds_read_b64_tr_b16 a[60:61], v15 offset:24584
    buffer_load_dwordx4 v8, s[20:23], s61 offen offset:3072  lds
    s_add_u32 s73, s73, 524288
    s_and_b32 s73, s73, 0x3fffff
    v_mfma_f32_16x16x32_bf16 v[124:127], a[8:11], a[76:79], v[124:127]
    ds_read_b64_tr_b16 a[62:63], v15 offset:25608
    v_mfma_f32_16x16x32_bf16 v[128:131], a[8:11], a[80:83], v[128:131]
    ds_read_b128 a[88:91], v17 offset:12288
    s_mov_b32 s64, 8192
    s_add_u32 m0, s59, 16384
    s_nop 0
    buffer_load_dwordx4 v32, s[12:15], s64 offen offset:0 nt lds
    v_mfma_f32_16x16x32_bf16 v[132:135], a[8:11], a[84:87], v[132:135]
    ds_read_b128 a[92:95], v17 offset:14336
    v_mfma_f32_16x16x32_bf16 v[156:159], a[12:15], a[84:87], v[156:159]
    ds_read_b128 a[96:99], v17 offset:16384
    buffer_load_dwordx4 v33, s[12:15], s64 offen offset:1024 nt lds
    v_mfma_f32_16x16x32_bf16 v[152:155], a[12:15], a[80:83], v[152:155]
    ds_read_b128 a[100:103], v17 offset:18432
    v_mfma_f32_16x16x32_bf16 v[148:151], a[12:15], a[76:79], v[148:151]
    ds_read_b128 a[104:107], v17 offset:20480
    buffer_load_dwordx4 v34, s[12:15], s64 offen offset:2048 nt lds
    v_mfma_f32_16x16x32_bf16 v[144:147], a[12:15], a[72:75], v[144:147]
    ds_read_b128 a[108:111], v17 offset:22528
    v_mfma_f32_16x16x32_bf16 v[140:143], a[12:15], a[68:71], v[140:143]
    buffer_load_dwordx4 v35, s[12:15], s64 offen offset:3072 nt lds
    v_mfma_f32_16x16x32_bf16 v[136:139], a[12:15], a[64:67], v[136:139]
    v_mfma_f32_16x16x32_bf16 v[160:163], a[16:19], a[64:67], v[160:163]
    s_mov_b32 s64, 12288
    s_add_u32 m0, s59, 20480
    s_nop 0
    buffer_load_dwordx4 v32, s[12:15], s64 offen offset:0 nt lds
    v_mfma_f32_16x16x32_bf16 v[164:167], a[16:19], a[68:71], v[164:167]
    v_mfma_f32_16x16x32_bf16 v[168:171], a[16:19], a[72:75], v[168:171]
    buffer_load_dwordx4 v33, s[12:15], s64 offen offset:1024 nt lds
    v_mfma_f32_16x16x32_bf16 v[172:175], a[16:19], a[76:79], v[172:175]
    v_mfma_f32_16x16x32_bf16 v[176:179], a[16:19], a[80:83], v[176:179]
    buffer_load_dwordx4 v34, s[12:15], s64 offen offset:2048 nt lds
    v_mfma_f32_16x16x32_bf16 v[180:183], a[16:19], a[84:87], v[180:183]
    v_mfma_f32_16x16x32_bf16 v[204:207], a[20:23], a[84:87], v[204:207]
    buffer_load_dwordx4 v35, s[12:15], s64 offen offset:3072 nt lds
    v_mfma_f32_16x16x32_bf16 v[200:203], a[20:23], a[80:83], v[200:203]
    v_mfma_f32_16x16x32_bf16 v[196:199], a[20:23], a[76:79], v[196:199]
    v_mfma_f32_16x16x32_bf16 v[192:195], a[20:23], a[72:75], v[192:195]
    v_mfma_f32_16x16x32_bf16 v[188:191], a[20:23], a[68:71], v[188:191]
    v_mfma_f32_16x16x32_bf16 v[184:187], a[20:23], a[64:67], v[184:187]
    v_mfma_f32_16x16x32_bf16 v[208:211], a[24:27], a[64:67], v[208:211]
    v_mfma_f32_16x16x32_bf16 v[212:215], a[24:27], a[68:71], v[212:215]
    v_mfma_f32_16x16x32_bf16 v[216:219], a[24:27], a[72:75], v[216:219]
    v_mfma_f32_16x16x32_bf16 v[220:223], a[24:27], a[76:79], v[220:223]
    v_mfma_f32_16x16x32_bf16 v[224:227], a[24:27], a[80:83], v[224:227]
    v_mfma_f32_16x16x32_bf16 v[228:231], a[24:27], a[84:87], v[228:231]
    v_mfma_f32_16x16x32_bf16 v[252:255], a[28:31], a[84:87], v[252:255]
    v_mfma_f32_16x16x32_bf16 v[248:251], a[28:31], a[80:83], v[248:251]
    v_mfma_f32_16x16x32_bf16 v[244:247], a[28:31], a[76:79], v[244:247]
    v_mfma_f32_16x16x32_bf16 v[240:243], a[28:31], a[72:75], v[240:243]
    v_mfma_f32_16x16x32_bf16 v[236:239], a[28:31], a[68:71], v[236:239]
    v_mfma_f32_16x16x32_bf16 v[232:235], a[28:31], a[64:67], v[232:235]
    s_waitcnt vmcnt(16) lgkmcnt(0)
    s_barrier
    v_mfma_f32_16x16x32_bf16 v[64:67], a[32:35], a[88:91], v[64:67]
    ds_read_b64_tr_b16 a[0:1], v12 offset:0
    v_mfma_f32_16x16x32_bf16 v[68:71], a[32:35], a[92:95], v[68:71]
    ds_read_b64_tr_b16 a[2:3], v12 offset:1024
    v_mfma_f32_16x16x32_bf16 v[72:75], a[32:35], a[96:99], v[72:75]
    ds_read_b64_tr_b16 a[4:5], v12 offset:8
    v_mfma_f32_16x16x32_bf16 v[76:79], a[32:35], a[100:103], v[76:79]
    ds_read_b64_tr_b16 a[6:7], v12 offset:1032
    v_mfma_f32_16x16x32_bf16 v[80:83], a[32:35], a[104:107], v[80:83]
    ds_read_b64_tr_b16 a[8:9], v13 offset:0
    v_mfma_f32_16x16x32_bf16 v[84:87], a[32:35], a[108:111], v[84:87]
    ds_read_b64_tr_b16 a[10:11], v13 offset:1024
    v_mfma_f32_16x16x32_bf16 v[108:111], a[36:39], a[108:111], v[108:111]
    ds_read_b64_tr_b16 a[12:13], v13 offset:8
    v_mfma_f32_16x16x32_bf16 v[104:107], a[36:39], a[104:107], v[104:107]
    ds_read_b64_tr_b16 a[14:15], v13 offset:1032
    v_mfma_f32_16x16x32_bf16 v[100:103], a[36:39], a[100:103], v[100:103]
    ds_read_b64_tr_b16 a[16:17], v14 offset:0
    v_mfma_f32_16x16x32_bf16 v[96:99], a[36:39], a[96:99], v[96:99]
    ds_read_b64_tr_b16 a[18:19], v14 offset:1024
    v_mfma_f32_16x16x32_bf16 v[92:95], a[36:39], a[92:95], v[92:95]
    ds_read_b64_tr_b16 a[20:21], v14 offset:8
    v_mfma_f32_16x16x32_bf16 v[88:91], a[36:39], a[88:91], v[88:91]
    ds_read_b64_tr_b16 a[22:23], v14 offset:1032
    v_mfma_f32_16x16x32_bf16 v[112:115], a[40:43], a[88:91], v[112:115]
    ds_read_b64_tr_b16 a[24:25], v15 offset:0
    v_mfma_f32_16x16x32_bf16 v[116:119], a[40:43], a[92:95], v[116:119]
    ds_read_b64_tr_b16 a[26:27], v15 offset:1024
    v_mfma_f32_16x16x32_bf16 v[120:123], a[40:43], a[96:99], v[120:123]
    ds_read_b64_tr_b16 a[28:29], v15 offset:8
    v_mfma_f32_16x16x32_bf16 v[124:127], a[40:43], a[100:103], v[124:127]
    ds_read_b64_tr_b16 a[30:31], v15 offset:1032
    v_mfma_f32_16x16x32_bf16 v[128:131], a[40:43], a[104:107], v[128:131]
    ds_read_b128 a[64:67], v16 offset:0
    v_mfma_f32_16x16x32_bf16 v[132:135], a[40:43], a[108:111], v[132:135]
    ds_read_b128 a[68:71], v16 offset:2048
    v_mfma_f32_16x16x32_bf16 v[156:159], a[44:47], a[108:111], v[156:159]
    ds_read_b128 a[72:75], v16 offset:4096
    v_mfma_f32_16x16x32_bf16 v[152:155], a[44:47], a[104:107], v[152:155]
    ds_read_b128 a[76:79], v16 offset:6144
    v_mfma_f32_16x16x32_bf16 v[148:151], a[44:47], a[100:103], v[148:151]
    ds_read_b128 a[80:83], v16 offset:8192
    v_mfma_f32_16x16x32_bf16 v[144:147], a[44:47], a[96:99], v[144:147]
    ds_read_b128 a[84:87], v16 offset:10240
    v_mfma_f32_16x16x32_bf16 v[140:143], a[44:47], a[92:95], v[140:143]
    s_waitcnt vmcnt(0)
    ds_read_b128 a[144:147], v36 offset:16384
    v_mfma_f32_16x16x32_bf16 v[136:139], a[44:47], a[88:91], v[136:139]
    ds_read_b128 a[148:151], v37 offset:16384
    v_mfma_f32_16x16x32_bf16 v[160:163], a[48:51], a[88:91], v[160:163]
    ds_read_b128 a[152:155], v38 offset:16384
    s_add_u32 m0, s66, 12288
    s_nop 0
    buffer_load_dwordx4 v2, s[8:11], s62 offen offset:0  lds
    v_mfma_f32_16x16x32_bf16 v[164:167], a[48:51], a[92:95], v[164:167]
    ds_read_b128 a[156:159], v39 offset:16384
    v_mfma_f32_16x16x32_bf16 v[168:171], a[48:51], a[96:99], v[168:171]
    ds_read_b128 a[160:163], v36 offset:20480
    buffer_load_dwordx4 v3, s[8:11], s62 offen offset:1024  lds
    v_mfma_f32_16x16x32_bf16 v[172:175], a[48:51], a[100:103], v[172:175]
    ds_read_b128 a[164:167], v37 offset:20480
    v_mfma_f32_16x16x32_bf16 v[176:179], a[48:51], a[104:107], v[176:179]
    ds_read_b128 a[168:171], v38 offset:20480
    buffer_load_dwordx4 v4, s[8:11], s62 offen offset:2048  lds
    s_add_u32 s62, s62, 128
    s_and_b32 s62, s62, 1023
    v_mfma_f32_16x16x32_bf16 v[180:183], a[48:51], a[108:111], v[180:183]
    ds_read_b128 a[172:175], v39 offset:20480
    v_mfma_f32_16x16x32_bf16 v[204:207], a[52:55], a[108:111], v[204:207]
    v_mfma_f32_16x16x32_bf16 v[200:203], a[52:55], a[104:107], v[200:203]
    v_mfma_f32_16x16x32_bf16 v[196:199], a[52:55], a[100:103], v[196:199]
    v_mfma_f32_16x16x32_bf16 v[192:195], a[52:55], a[96:99], v[192:195]
    s_waitcnt lgkmcnt(0)
    v_mfma_f32_16x16x32_bf16 v[188:191], a[52:55], a[92:95], v[188:191]
    s_add_u32 s60, s73, s75
    s_or_b32 s61, s60, 131072
    s_add_u32 m0, s59, 16384
    s_nop 0
    buffer_load_dwordx4 v5, s[20:23], s60 offen offset:0  lds
    v_mfma_f32_16x16x32_bf16 v[184:187], a[52:55], a[88:91], v[184:187]
    buffer_load_dwordx4 v6, s[20:23], s60 offen offset:1024  lds
    v_mfma_f32_16x16x32_bf16 v[208:211], a[56:59], a[88:91], v[208:211]
    v_mfma_f32_16x16x32_bf16 v[212:215], a[56:59], a[92:95], v[212:215]
    buffer_load_dwordx4 v7, s[20:23], s60 offen offset:2048  lds
    v_mfma_f32_16x16x32_bf16 v[216:219], a[56:59], a[96:99], v[216:219]
    v_mfma_f32_16x16x32_bf16 v[220:223], a[56:59], a[100:103], v[220:223]
    buffer_load_dwordx4 v8, s[20:23], s60 offen offset:3072  lds
    v_mfma_f32_16x16x32_bf16 v[224:227], a[56:59], a[104:107], v[224:227]
    s_add_u32 m0, s59, 20480
    v_mfma_f32_16x16x32_bf16 v[228:231], a[56:59], a[108:111], v[228:231]
    buffer_load_dwordx4 v5, s[20:23], s61 offen offset:0  lds
    v_mfma_f32_16x16x32_bf16 v[252:255], a[60:63], a[108:111], v[252:255]
    v_mfma_f32_16x16x32_bf16 v[248:251], a[60:63], a[104:107], v[248:251]
    buffer_load_dwordx4 v6, s[20:23], s61 offen offset:1024  lds
    v_mfma_f32_16x16x32_bf16 v[244:247], a[60:63], a[100:103], v[244:247]
    v_mfma_f32_16x16x32_bf16 v[240:243], a[60:63], a[96:99], v[240:243]
    buffer_load_dwordx4 v7, s[20:23], s61 offen offset:2048  lds
    v_mfma_f32_16x16x32_bf16 v[236:239], a[60:63], a[92:95], v[236:239]
    v_mfma_f32_16x16x32_bf16 v[232:235], a[60:63], a[88:91], v[232:235]
    buffer_load_dwordx4 v8, s[20:23], s61 offen offset:3072  lds
    v_mfma_f32_16x16x32_bf16 v[64:67], a[0:3], a[64:67], v[64:67]
    ds_read_b64_tr_b16 a[32:33], v12 offset:8192
    v_mfma_f32_16x16x32_bf16 v[68:71], a[0:3], a[68:71], v[68:71]
    ds_read_b64_tr_b16 a[34:35], v12 offset:9216
    v_mfma_f32_16x16x32_bf16 v[72:75], a[0:3], a[72:75], v[72:75]
    ds_read_b64_tr_b16 a[36:37], v12 offset:8200
    s_add_u32 s60, s73, s100
    s_or_b32 s61, s60, 131072
    s_add_u32 m0, s59, 24576
    s_nop 0
    buffer_load_dwordx4 v5, s[20:23], s60 offen offset:0  lds
    v_mfma_f32_16x16x32_bf16 v[76:79], a[0:3], a[76:79], v[76:79]
    ds_read_b64_tr_b16 a[38:39], v12 offset:9224
    v_mfma_f32_16x16x32_bf16 v[80:83], a[0:3], a[80:83], v[80:83]
    ds_read_b64_tr_b16 a[40:41], v13 offset:8192
    v_mfma_f32_16x16x32_bf16 v[84:87], a[0:3], a[84:87], v[84:87]
    ds_read_b64_tr_b16 a[42:43], v13 offset:9216
    v_mfma_f32_16x16x32_bf16 v[108:111], a[4:7], a[84:87], v[108:111]
    ds_read_b64_tr_b16 a[44:45], v13 offset:8200
    v_mfma_f32_16x16x32_bf16 v[104:107], a[4:7], a[80:83], v[104:107]
    ds_read_b64_tr_b16 a[46:47], v13 offset:9224
    v_mfma_f32_16x16x32_bf16 v[100:103], a[4:7], a[76:79], v[100:103]
    ds_read_b64_tr_b16 a[48:49], v14 offset:8192
    buffer_load_dwordx4 v6, s[20:23], s60 offen offset:1024  lds
    v_mfma_f32_16x16x32_bf16 v[96:99], a[4:7], a[72:75], v[96:99]
    ds_read_b64_tr_b16 a[50:51], v14 offset:9216
    v_mfma_f32_16x16x32_bf16 v[92:95], a[4:7], a[68:71], v[92:95]
    ds_read_b64_tr_b16 a[52:53], v14 offset:8200
    v_mfma_f32_16x16x32_bf16 v[88:91], a[4:7], a[64:67], v[88:91]
    ds_read_b64_tr_b16 a[54:55], v14 offset:9224
    v_mfma_f32_16x16x32_bf16 v[112:115], a[8:11], a[64:67], v[112:115]
    ds_read_b64_tr_b16 a[56:57], v15 offset:8192
    v_mfma_f32_16x16x32_bf16 v[116:119], a[8:11], a[68:71], v[116:119]
    ds_read_b64_tr_b16 a[58:59], v15 offset:9216
    v_mfma_f32_16x16x32_bf16 v[120:123], a[8:11], a[72:75], v[120:123]
    ds_read_b64_tr_b16 a[60:61], v15 offset:8200
    buffer_load_dwordx4 v7, s[20:23], s60 offen offset:2048  lds
    v_mfma_f32_16x16x32_bf16 v[124:127], a[8:11], a[76:79], v[124:127]
    ds_read_b64_tr_b16 a[62:63], v15 offset:9224
    v_mfma_f32_16x16x32_bf16 v[128:131], a[8:11], a[80:83], v[128:131]
    ds_read_b128 a[88:91], v17 offset:0
    v_mfma_f32_16x16x32_bf16 v[132:135], a[8:11], a[84:87], v[132:135]
    ds_read_b128 a[92:95], v17 offset:2048
    v_mfma_f32_16x16x32_bf16 v[156:159], a[12:15], a[84:87], v[156:159]
    ds_read_b128 a[96:99], v17 offset:4096
    v_mfma_f32_16x16x32_bf16 v[152:155], a[12:15], a[80:83], v[152:155]
    ds_read_b128 a[100:103], v17 offset:6144
    v_mfma_f32_16x16x32_bf16 v[148:151], a[12:15], a[76:79], v[148:151]
    ds_read_b128 a[104:107], v17 offset:8192
    buffer_load_dwordx4 v8, s[20:23], s60 offen offset:3072  lds
    v_mfma_f32_16x16x32_bf16 v[144:147], a[12:15], a[72:75], v[144:147]
    ds_read_b128 a[108:111], v17 offset:10240
    v_mfma_f32_16x16x32_bf16 v[140:143], a[12:15], a[68:71], v[140:143]
    v_mfma_f32_16x16x32_bf16 v[136:139], a[12:15], a[64:67], v[136:139]
    v_mfma_f32_16x16x32_bf16 v[160:163], a[16:19], a[64:67], v[160:163]
    v_mfma_f32_16x16x32_bf16 v[164:167], a[16:19], a[68:71], v[164:167]
    v_mfma_f32_16x16x32_bf16 v[168:171], a[16:19], a[72:75], v[168:171]
    s_add_u32 m0, s59, 28672
    v_mfma_f32_16x16x32_bf16 v[172:175], a[16:19], a[76:79], v[172:175]
    buffer_load_dwordx4 v5, s[20:23], s61 offen offset:0  lds
    v_mfma_f32_16x16x32_bf16 v[176:179], a[16:19], a[80:83], v[176:179]
    v_mfma_f32_16x16x32_bf16 v[180:183], a[16:19], a[84:87], v[180:183]
    v_mfma_f32_16x16x32_bf16 v[204:207], a[20:23], a[84:87], v[204:207]
    v_mfma_f32_16x16x32_bf16 v[200:203], a[20:23], a[80:83], v[200:203]
    v_mfma_f32_16x16x32_bf16 v[196:199], a[20:23], a[76:79], v[196:199]
    v_mfma_f32_16x16x32_bf16 v[192:195], a[20:23], a[72:75], v[192:195]
    buffer_load_dwordx4 v6, s[20:23], s61 offen offset:1024  lds
    v_mfma_f32_16x16x32_bf16 v[188:191], a[20:23], a[68:71], v[188:191]
    v_mfma_f32_16x16x32_bf16 v[184:187], a[20:23], a[64:67], v[184:187]
    v_mfma_f32_16x16x32_bf16 v[208:211], a[24:27], a[64:67], v[208:211]
    v_mfma_f32_16x16x32_bf16 v[212:215], a[24:27], a[68:71], v[212:215]
    v_mfma_f32_16x16x32_bf16 v[216:219], a[24:27], a[72:75], v[216:219]
    v_mfma_f32_16x16x32_bf16 v[220:223], a[24:27], a[76:79], v[220:223]
    buffer_load_dwordx4 v7, s[20:23], s61 offen offset:2048  lds
    v_mfma_f32_16x16x32_bf16 v[224:227], a[24:27], a[80:83], v[224:227]
    v_mfma_f32_16x16x32_bf16 v[228:231], a[24:27], a[84:87], v[228:231]
    v_mfma_f32_16x16x32_bf16 v[252:255], a[28:31], a[84:87], v[252:255]
    v_mfma_f32_16x16x32_bf16 v[248:251], a[28:31], a[80:83], v[248:251]
    v_mfma_f32_16x16x32_bf16 v[244:247], a[28:31], a[76:79], v[244:247]
    v_mfma_f32_16x16x32_bf16 v[240:243], a[28:31], a[72:75], v[240:243]
    v_mfma_f32_16x16x32_bf16 v[236:239], a[28:31], a[68:71], v[236:239]
    buffer_load_dwordx4 v8, s[20:23], s61 offen offset:3072  lds
    s_add_u32 s73, s73, 524288
    s_and_b32 s73, s73, 0x3fffff
    v_mfma_f32_16x16x32_bf16 v[232:235], a[28:31], a[64:67], v[232:235]
    s_waitcnt vmcnt(16) lgkmcnt(0)
    s_barrier
    s_waitcnt vmcnt(8)
    v_mfma_f32_16x16x32_bf16 v[64:67], a[32:35], a[88:91], v[64:67]
    ds_read_b64_tr_b16 a[0:1], v12 offset:16384
    s_add_u32 s60, s73, s75
    s_or_b32 s61, s60, 131072
    s_add_u32 m0, s59, 0
    s_nop 0
    buffer_load_dwordx4 v5, s[20:23], s60 offen offset:0  lds
    v_mfma_f32_16x16x32_bf16 v[68:71], a[32:35], a[92:95], v[68:71]
    ds_read_b64_tr_b16 a[2:3], v12 offset:17408
    v_mfma_f32_16x16x32_bf16 v[72:75], a[32:35], a[96:99], v[72:75]
    ds_read_b64_tr_b16 a[4:5], v12 offset:16392
    buffer_load_dwordx4 v6, s[20:23], s60 offen offset:1024  lds
    v_mfma_f32_16x16x32_bf16 v[76:79], a[32:35], a[100:103], v[76:79]
    ds_read_b64_tr_b16 a[6:7], v12 offset:17416
    v_mfma_f32_16x16x32_bf16 v[80:83], a[32:35], a[104:107], v[80:83]
    ds_read_b64_tr_b16 a[8:9], v13 offset:16384
    buffer_load_dwordx4 v7, s[20:23], s60 offen offset:2048  lds
    v_mfma_f32_16x16x32_bf16 v[84:87], a[32:35], a[108:111], v[84:87]
    ds_read_b64_tr_b16 a[10:11], v13 offset:17408
    v_mfma_f32_16x16x32_bf16 v[108:111], a[36:39], a[108:111], v[108:111]
    ds_read_b64_tr_b16 a[12:13], v13 offset:16392
    buffer_load_dwordx4 v8, s[20:23], s60 offen offset:3072  lds
    v_mfma_f32_16x16x32_bf16 v[104:107], a[36:39], a[104:107], v[104:107]
    ds_read_b64_tr_b16 a[14:15], v13 offset:17416
    v_mfma_f32_16x16x32_bf16 v[100:103], a[36:39], a[100:103], v[100:103]
    ds_read_b64_tr_b16 a[16:17], v14 offset:16384
    s_add_u32 m0, s59, 4096
    s_nop 0
    buffer_load_dwordx4 v5, s[20:23], s61 offen offset:0  lds
    v_mfma_f32_16x16x32_bf16 v[96:99], a[36:39], a[96:99], v[96:99]
    ds_read_b64_tr_b16 a[18:19], v14 offset:17408
    v_mfma_f32_16x16x32_bf16 v[92:95], a[36:39], a[92:95], v[92:95]
    ds_read_b64_tr_b16 a[20:21], v14 offset:16392
    buffer_load_dwordx4 v6, s[20:23], s61 offen offset:1024  lds
    v_mfma_f32_16x16x32_bf16 v[88:91], a[36:39], a[88:91], v[88:91]
    ds_read_b64_tr_b16 a[22:23], v14 offset:17416
    v_mfma_f32_16x16x32_bf16 v[112:115], a[40:43], a[88:91], v[112:115]
    ds_read_b64_tr_b16 a[24:25], v15 offset:16384
    buffer_load_dwordx4 v7, s[20:23], s61 offen offset:2048  lds
    v_mfma_f32_16x16x32_bf16 v[116:119], a[40:43], a[92:95], v[116:119]
    ds_read_b64_tr_b16 a[26:27], v15 offset:17408
    v_mfma_f32_16x16x32_bf16 v[120:123], a[40:43], a[96:99], v[120:123]
    ds_read_b64_tr_b16 a[28:29], v15 offset:16392
    buffer_load_dwordx4 v8, s[20:23], s61 offen offset:3072  lds
    v_mfma_f32_16x16x32_bf16 v[124:127], a[40:43], a[100:103], v[124:127]
    ds_read_b64_tr_b16 a[30:31], v15 offset:17416
    v_mfma_f32_16x16x32_bf16 v[128:131], a[40:43], a[104:107], v[128:131]
    ds_read_b128 a[64:67], v16 offset:12288
    s_mov_b32 s64, 16384
    s_add_u32 m0, s59, 8192
    s_nop 0
    buffer_load_dwordx4 v32, s[12:15], s64 offen offset:0 nt lds
    v_mfma_f32_16x16x32_bf16 v[132:135], a[40:43], a[108:111], v[132:135]
    ds_read_b128 a[68:71], v16 offset:14336
    v_mfma_f32_16x16x32_bf16 v[156:159], a[44:47], a[108:111], v[156:159]
    ds_read_b128 a[72:75], v16 offset:16384
    buffer_load_dwordx4 v33, s[12:15], s64 offen offset:1024 nt lds
    v_mfma_f32_16x16x32_bf16 v[152:155], a[44:47], a[104:107], v[152:155]
    ds_read_b128 a[76:79], v16 offset:18432
    v_mfma_f32_16x16x32_bf16 v[148:151], a[44:47], a[100:103], v[148:151]
    ds_read_b128 a[80:83], v16 offset:20480
    buffer_load_dwordx4 v34, s[12:15], s64 offen offset:2048 nt lds
    v_mfma_f32_16x16x32_bf16 v[144:147], a[44:47], a[96:99], v[144:147]
    ds_read_b128 a[84:87], v16 offset:22528
    v_mfma_f32_16x16x32_bf16 v[140:143], a[44:47], a[92:95], v[140:143]
    buffer_load_dwordx4 v35, s[12:15], s64 offen offset:3072 nt lds
    v_mfma_f32_16x16x32_bf16 v[136:139], a[44:47], a[88:91], v[136:139]
    v_mfma_f32_16x16x32_bf16 v[160:163], a[48:51], a[88:91], v[160:163]
    s_mov_b32 s64, 20480
    s_add_u32 m0, s59, 12288
    s_nop 0
    buffer_load_dwordx4 v32, s[12:15], s64 offen offset:0 nt lds
    v_mfma_f32_16x16x32_bf16 v[164:167], a[48:51], a[92:95], v[164:167]
    v_mfma_f32_16x16x32_bf16 v[168:171], a[48:51], a[96:99], v[168:171]
    buffer_load_dwordx4 v33, s[12:15], s64 offen offset:1024 nt lds
    v_mfma_f32_16x16x32_bf16 v[172:175], a[48:51], a[100:103], v[172:175]
    v_mfma_f32_16x16x32_bf16 v[176:179], a[48:51], a[104:107], v[176:179]
    buffer_load_dwordx4 v34, s[12:15], s64 offen offset:2048 nt lds
    v_mfma_f32_16x16x32_bf16 v[180:183], a[48:51], a[108:111], v[180:183]
    v_mfma_f32_16x16x32_bf16 v[204:207], a[52:55], a[108:111], v[204:207]
    buffer_load_dwordx4 v35, s[12:15], s64 offen offset:3072 nt lds
    v_mfma_f32_16x16x32_bf16 v[200:203], a[52:55], a[104:107], v[200:203]
    v_mfma_f32_16x16x32_bf16 v[196:199], a[52:55], a[100:103], v[196:199]
    v_mfma_f32_16x16x32_bf16 v[192:195], a[52:55], a[96:99], v[192:195]
    v_mfma_f32_16x16x32_bf16 v[188:191], a[52:55], a[92:95], v[188:191]
    v_mfma_f32_16x16x32_bf16 v[184:187], a[52:55], a[88:91], v[184:187]
    v_mfma_f32_16x16x32_bf16 v[208:211], a[56:59], a[88:91], v[208:211]
    v_mfma_f32_16x16x32_bf16 v[212:215], a[56:59], a[92:95], v[212:215]
    v_mfma_f32_16x16x32_bf16 v[216:219], a[56:59], a[96:99], v[216:219]
    v_mfma_f32_16x16x32_bf16 v[220:223], a[56:59], a[100:103], v[220:223]
    v_mfma_f32_16x16x32_bf16 v[224:227], a[56:59], a[104:107], v[224:227]
    v_mfma_f32_16x16x32_bf16 v[228:231], a[56:59], a[108:111], v[228:231]
    s_add_u32 m0, s66, 0
    v_mfma_f32_16x16x32_bf16 v[252:255], a[60:63], a[108:111], v[252:255]
    buffer_load_dwordx4 v2, s[8:11], s62 offen offset:0  lds
    v_mfma_f32_16x16x32_bf16 v[248:251], a[60:63], a[104:107], v[248:251]
    v_mfma_f32_16x16x32_bf16 v[244:247], a[60:63], a[100:103], v[244:247]
    buffer_load_dwordx4 v3, s[8:11], s62 offen offset:1024  lds
    v_mfma_f32_16x16x32_bf16 v[240:243], a[60:63], a[96:99], v[240:243]
    v_mfma_f32_16x16x32_bf16 v[236:239], a[60:63], a[92:95], v[236:239]
    buffer_load_dwordx4 v4, s[8:11], s62 offen offset:2048  lds
    s_add_u32 s62, s62, 128
    s_and_b32 s62, s62, 1023
    v_mfma_f32_16x16x32_bf16 v[232:235], a[60:63], a[88:91], v[232:235]
    s_waitcnt lgkmcnt(0)
    s_waitcnt vmcnt(19)
    v_mfma_f32_16x16x32_bf16 v[64:67], a[0:3], a[64:67], v[64:67]
    ds_read_b64_tr_b16 a[32:33], v12 offset:24576
    v_mfma_f32_16x16x32_bf16 v[68:71], a[0:3], a[68:71], v[68:71]
    ds_read_b64_tr_b16 a[34:35], v12 offset:25600
    v_mfma_f32_16x16x32_bf16 v[72:75], a[0:3], a[72:75], v[72:75]
    ds_read_b64_tr_b16 a[36:37], v12 offset:24584
    v_mfma_f32_16x16x32_bf16 v[76:79], a[0:3], a[76:79], v[76:79]
    ds_read_b64_tr_b16 a[38:39], v12 offset:25608
    v_mfma_f32_16x16x32_bf16 v[80:83], a[0:3], a[80:83], v[80:83]
    ds_read_b64_tr_b16 a[40:41], v13 offset:24576
    v_mfma_f32_16x16x32_bf16 v[84:87], a[0:3], a[84:87], v[84:87]
    ds_read_b64_tr_b16 a[42:43], v13 offset:25600
    v_mfma_f32_16x16x32_bf16 v[108:111], a[4:7], a[84:87], v[108:111]
    ds_read_b64_tr_b16 a[44:45], v13 offset:24584
    v_mfma_f32_16x16x32_bf16 v[104:107], a[4:7], a[80:83], v[104:107]
    ds_read_b64_tr_b16 a[46:47], v13 offset:25608
    v_mfma_f32_16x16x32_bf16 v[100:103], a[4:7], a[76:79], v[100:103]
    ds_read_b64_tr_b16 a[48:49], v14 offset:24576
    v_mfma_f32_16x16x32_bf16 v[96:99], a[4:7], a[72:75], v[96:99]
    ds_read_b64_tr_b16 a[50:51], v14 offset:25600
    v_mfma_f32_16x16x32_bf16 v[92:95], a[4:7], a[68:71], v[92:95]
    ds_read_b64_tr_b16 a[52:53], v14 offset:24584
    v_mfma_f32_16x16x32_bf16 v[88:91], a[4:7], a[64:67], v[88:91]
    ds_read_b64_tr_b16 a[54:55], v14 offset:25608
    v_mfma_f32_16x16x32_bf16 v[112:115], a[8:11], a[64:67], v[112:115]
    ds_read_b64_tr_b16 a[56:57], v15 offset:24576
    v_mfma_f32_16x16x32_bf16 v[116:119], a[8:11], a[68:71], v[116:119]
    ds_read_b64_tr_b16 a[58:59], v15 offset:25600
    v_mfma_f32_16x16x32_bf16 v[120:123], a[8:11], a[72:75], v[120:123]
    ds_read_b64_tr_b16 a[60:61], v15 offset:24584
    v_mfma_f32_16x16x32_bf16 v[124:127], a[8:11], a[76:79], v[124:127]
    ds_read_b64_tr_b16 a[62:63], v15 offset:25608
    v_mfma_f32_16x16x32_bf16 v[128:131], a[8:11], a[80:83], v[128:131]
    ds_read_b128 a[88:91], v17 offset:12288
    v_mfma_f32_16x16x32_bf16 v[132:135], a[8:11], a[84:87], v[132:135]
    ds_read_b128 a[92:95], v17 offset:14336
    v_mfma_f32_16x16x32_bf16 v[156:159], a[12:15], a[84:87], v[156:159]
    ds_read_b128 a[96:99], v17 offset:16384
    v_mfma_f32_16x16x32_bf16 v[152:155], a[12:15], a[80:83], v[152:155]
    ds_read_b128 a[100:103], v17 offset:18432
    v_mfma_f32_16x16x32_bf16 v[148:151], a[12:15], a[76:79], v[148:151]
    ds_read_b128 a[104:107], v17 offset:20480
    v_mfma_f32_16x16x32_bf16 v[144:147], a[12:15], a[72:75], v[144:147]
    ds_read_b128 a[108:111], v17 offset:22528
    v_mfma_f32_16x16x32_bf16 v[140:143], a[12:15], a[68:71], v[140:143]
    s_waitcnt vmcnt(3)
    ds_read_b128 a[176:179], v36 offset:8192
    v_mfma_f32_16x16x32_bf16 v[136:139], a[12:15], a[64:67], v[136:139]
    ds_read_b128 a[180:183], v37 offset:8192
    v_mfma_f32_16x16x32_bf16 v[160:163], a[16:19], a[64:67], v[160:163]
    ds_read_b128 a[184:187], v38 offset:8192
    v_mfma_f32_16x16x32_bf16 v[164:167], a[16:19], a[68:71], v[164:167]
    ds_read_b128 a[188:191], v39 offset:8192
    v_mfma_f32_16x16x32_bf16 v[168:171], a[16:19], a[72:75], v[168:171]
    ds_read_b128 a[192:195], v36 offset:12288
    v_mfma_f32_16x16x32_bf16 v[172:175], a[16:19], a[76:79], v[172:175]
    ds_read_b128 a[196:199], v37 offset:12288
    v_mfma_f32_16x16x32_bf16 v[176:179], a[16:19], a[80:83], v[176:179]
    ds_read_b128 a[200:203], v38 offset:12288
    v_mfma_f32_16x16x32_bf16 v[180:183], a[16:19], a[84:87], v[180:183]
    ds_read_b128 a[204:207], v39 offset:12288
    v_mfma_f32_16x16x32_bf16 v[204:207], a[20:23], a[84:87], v[204:207]
    v_mfma_f32_16x16x32_bf16 v[200:203], a[20:23], a[80:83], v[200:203]
    v_mfma_f32_16x16x32_bf16 v[196:199], a[20:23], a[76:79], v[196:199]
    v_mfma_f32_16x16x32_bf16 v[192:195], a[20:23], a[72:75], v[192:195]
    s_waitcnt lgkmcnt(0)
    v_mfma_f32_16x16x32_bf16 v[188:191], a[20:23], a[68:71], v[188:191]
    s_add_u32 s60, s73, s100
    s_or_b32 s61, s60, 131072
    s_add_u32 m0, s59, 8192
    s_nop 0
    buffer_load_dwordx4 v5, s[20:23], s60 offen offset:0  lds
    v_mfma_f32_16x16x32_bf16 v[184:187], a[20:23], a[64:67], v[184:187]
    buffer_load_dwordx4 v6, s[20:23], s60 offen offset:1024  lds
    v_mfma_f32_16x16x32_bf16 v[208:211], a[24:27], a[64:67], v[208:211]
    v_mfma_f32_16x16x32_bf16 v[212:215], a[24:27], a[68:71], v[212:215]
    buffer_load_dwordx4 v7, s[20:23], s60 offen offset:2048  lds
    v_mfma_f32_16x16x32_bf16 v[216:219], a[24:27], a[72:75], v[216:219]
    v_mfma_f32_16x16x32_bf16 v[220:223], a[24:27], a[76:79], v[220:223]
    buffer_load_dwordx4 v8, s[20:23], s60 offen offset:3072  lds
    v_mfma_f32_16x16x32_bf16 v[224:227], a[24:27], a[80:83], v[224:227]
    s_add_u32 m0, s59, 12288
    v_mfma_f32_16x16x32_bf16 v[228:231], a[24:27], a[84:87], v[228:231]
    buffer_load_dwordx4 v5, s[20:23], s61 offen offset:0  lds
    v_mfma_f32_16x16x32_bf16 v[252:255], a[28:31], a[84:87], v[252:255]
    v_mfma_f32_16x16x32_bf16 v[248:251], a[28:31], a[80:83], v[248:251]
    buffer_load_dwordx4 v6, s[20:23], s61 offen offset:1024  lds
    v_mfma_f32_16x16x32_bf16 v[244:247], a[28:31], a[76:79], v[244:247]
    v_mfma_f32_16x16x32_bf16 v[240:243], a[28:31], a[72:75], v[240:243]
    buffer_load_dwordx4 v7, s[20:23], s61 offen offset:2048  lds
    v_mfma_f32_16x16x32_bf16 v[236:239], a[28:31], a[68:71], v[236:239]
    v_mfma_f32_16x16x32_bf16 v[232:235], a[28:31], a[64:67], v[232:235]
    buffer_load_dwordx4 v8, s[20:23], s61 offen offset:3072  lds
    s_add_u32 s73, s73, 524288
    s_and_b32 s73, s73, 0x3fffff
    s_waitcnt vmcnt(8)
    s_barrier
    v_mfma_f32_16x16x32_bf16 v[64:67], a[32:35], a[88:91], v[64:67]
    ds_read_b64_tr_b16 a[0:1], v12 offset:0
    v_mfma_f32_16x16x32_bf16 v[68:71], a[32:35], a[92:95], v[68:71]
    ds_read_b64_tr_b16 a[2:3], v12 offset:1024
    v_mfma_f32_16x16x32_bf16 v[72:75], a[32:35], a[96:99], v[72:75]
    ds_read_b64_tr_b16 a[4:5], v12 offset:8
    s_add_u32 s60, s73, s75
    s_or_b32 s61, s60, 131072
    s_add_u32 m0, s59, 16384
    s_nop 0
    buffer_load_dwordx4 v5, s[20:23], s60 offen offset:0  lds
    v_mfma_f32_16x16x32_bf16 v[76:79], a[32:35], a[100:103], v[76:79]
    ds_read_b64_tr_b16 a[6:7], v12 offset:1032
    v_mfma_f32_16x16x32_bf16 v[80:83], a[32:35], a[104:107], v[80:83]
    ds_read_b64_tr_b16 a[8:9], v13 offset:0
    v_mfma_f32_16x16x32_bf16 v[84:87], a[32:35], a[108:111], v[84:87]
    ds_read_b64_tr_b16 a[10:11], v13 offset:1024
    v_mfma_f32_16x16x32_bf16 v[108:111], a[36:39], a[108:111], v[108:111]
    ds_read_b64_tr_b16 a[12:13], v13 offset:8
    v_mfma_f32_16x16x32_bf16 v[104:107], a[36:39], a[104:107], v[104:107]
    ds_read_b64_tr_b16 a[14:15], v13 offset:1032
    buffer_load_dwordx4 v6, s[20:23], s60 offen offset:1024  lds
    v_mfma_f32_16x16x32_bf16 v[100:103], a[36:39], a[100:103], v[100:103]
    ds_read_b64_tr_b16 a[16:17], v14 offset:0
    v_mfma_f32_16x16x32_bf16 v[96:99], a[36:39], a[96:99], v[96:99]
    ds_read_b64_tr_b16 a[18:19], v14 offset:1024
    v_mfma_f32_16x16x32_bf16 v[92:95], a[36:39], a[92:95], v[92:95]
    ds_read_b64_tr_b16 a[20:21], v14 offset:8
    v_mfma_f32_16x16x32_bf16 v[88:91], a[36:39], a[88:91], v[88:91]
    ds_read_b64_tr_b16 a[22:23], v14 offset:1032
    v_mfma_f32_16x16x32_bf16 v[112:115], a[40:43], a[88:91], v[112:115]
    ds_read_b64_tr_b16 a[24:25], v15 offset:0
    buffer_load_dwordx4 v7, s[20:23], s60 offen offset:2048  lds
    v_mfma_f32_16x16x32_bf16 v[116:119], a[40:43], a[92:95], v[116:119]
    ds_read_b64_tr_b16 a[26:27], v15 offset:1024
    v_mfma_f32_16x16x32_bf16 v[120:123], a[40:43], a[96:99], v[120:123]
    ds_read_b64_tr_b16 a[28:29], v15 offset:8
    v_mfma_f32_16x16x32_bf16 v[124:127], a[40:43], a[100:103], v[124:127]
    ds_read_b64_tr_b16 a[30:31], v15 offset:1032
    v_mfma_f32_16x16x32_bf16 v[128:131], a[40:43], a[104:107], v[128:131]
    ds_read_b128 a[64:67], v16 offset:0
    v_mfma_f32_16x16x32_bf16 v[132:135], a[40:43], a[108:111], v[132:135]
    ds_read_b128 a[68:71], v16 offset:2048
    v_mfma_f32_16x16x32_bf16 v[156:159], a[44:47], a[108:111], v[156:159]
    ds_read_b128 a[72:75], v16 offset:4096
    buffer_load_dwordx4 v8, s[20:23], s60 offen offset:3072  lds
    v_mfma_f32_16x16x32_bf16 v[152:155], a[44:47], a[104:107], v[152:155]
    ds_read_b128 a[76:79], v16 offset:6144
    v_mfma_f32_16x16x32_bf16 v[148:151], a[44:47], a[100:103], v[148:151]
    ds_read_b128 a[80:83], v16 offset:8192
    v_mfma_f32_16x16x32_bf16 v[144:147], a[44:47], a[96:99], v[144:147]
    ds_read_b128 a[84:87], v16 offset:10240
    v_mfma_f32_16x16x32_bf16 v[140:143], a[44:47], a[92:95], v[140:143]
    s_add_u32 m0, s59, 20480
    v_mfma_f32_16x16x32_bf16 v[136:139], a[44:47], a[88:91], v[136:139]
    buffer_load_dwordx4 v5, s[20:23], s61 offen offset:0  lds
    v_mfma_f32_16x16x32_bf16 v[160:163], a[48:51], a[88:91], v[160:163]
    v_mfma_f32_16x16x32_bf16 v[164:167], a[48:51], a[92:95], v[164:167]
    v_mfma_f32_16x16x32_bf16 v[168:171], a[48:51], a[96:99], v[168:171]
    v_mfma_f32_16x16x32_bf16 v[172:175], a[48:51], a[100:103], v[172:175]
    v_mfma_f32_16x16x32_bf16 v[176:179], a[48:51], a[104:107], v[176:179]
    v_mfma_f32_16x16x32_bf16 v[180:183], a[48:51], a[108:111], v[180:183]
    buffer_load_dwordx4 v6, s[20:23], s61 offen offset:1024  lds
    v_mfma_f32_16x16x32_bf16 v[204:207], a[52:55], a[108:111], v[204:207]
    v_mfma_f32_16x16x32_bf16 v[200:203], a[52:55], a[104:107], v[200:203]
    v_mfma_f32_16x16x32_bf16 v[196:199], a[52:55], a[100:103], v[196:199]
    v_mfma_f32_16x16x32_bf16 v[192:195], a[52:55], a[96:99], v[192:195]
    v_mfma_f32_16x16x32_bf16 v[188:191], a[52:55], a[92:95], v[188:191]
    buffer_load_dwordx4 v7, s[20:23], s61 offen offset:2048  lds
    v_mfma_f32_16x16x32_bf16 v[184:187], a[52:55], a[88:91], v[184:187]
    v_mfma_f32_16x16x32_bf16 v[208:211], a[56:59], a[88:91], v[208:211]
    v_mfma_f32_16x16x32_bf16 v[212:215], a[56:59], a[92:95], v[212:215]
    v_mfma_f32_16x16x32_bf16 v[216:219], a[56:59], a[96:99], v[216:219]
    v_mfma_f32_16x16x32_bf16 v[220:223], a[56:59], a[100:103], v[220:223]
    v_mfma_f32_16x16x32_bf16 v[224:227], a[56:59], a[104:107], v[224:227]
    buffer_load_dwordx4 v8, s[20:23], s61 offen offset:3072  lds
    v_mfma_f32_16x16x32_bf16 v[228:231], a[56:59], a[108:111], v[228:231]
    s_add_u32 m0, s66, 12288
    v_mfma_f32_16x16x32_bf16 v[252:255], a[60:63], a[108:111], v[252:255]
    buffer_load_dwordx4 v2, s[8:11], s62 offen offset:0  lds
    v_mfma_f32_16x16x32_bf16 v[248:251], a[60:63], a[104:107], v[248:251]
    v_mfma_f32_16x16x32_bf16 v[244:247], a[60:63], a[100:103], v[244:247]
    buffer_load_dwordx4 v3, s[8:11], s62 offen offset:1024  lds
    v_mfma_f32_16x16x32_bf16 v[240:243], a[60:63], a[96:99], v[240:243]
    v_mfma_f32_16x16x32_bf16 v[236:239], a[60:63], a[92:95], v[236:239]
    buffer_load_dwordx4 v4, s[8:11], s62 offen offset:2048  lds
    s_add_u32 s62, s62, 128
    s_and_b32 s62, s62, 1023
    v_mfma_f32_16x16x32_bf16 v[232:235], a[60:63], a[88:91], v[232:235]
    s_waitcnt lgkmcnt(0)
    s_waitcnt vmcnt(11)
    v_mfma_f32_16x16x32_bf16 v[64:67], a[0:3], a[64:67], v[64:67]
    ds_read_b64_tr_b16 a[32:33], v12 offset:8192
    v_mfma_f32_16x16x32_bf16 v[68:71], a[0:3], a[68:71], v[68:71]
    ds_read_b64_tr_b16 a[34:35], v12 offset:9216
    v_mfma_f32_16x16x32_bf16 v[72:75], a[0:3], a[72:75], v[72:75]
    ds_read_b64_tr_b16 a[36:37], v12 offset:8200
    s_add_u32 s60, s73, s100
    s_or_b32 s61, s60, 131072
    s_add_u32 m0, s59, 24576
    s_nop 0
    buffer_load_dwordx4 v5, s[20:23], s60 offen offset:0  lds
    v_mfma_f32_16x16x32_bf16 v[76:79], a[0:3], a[76:79], v[76:79]
    ds_read_b64_tr_b16 a[38:39], v12 offset:9224
    v_mfma_f32_16x16x32_bf16 v[80:83], a[0:3], a[80:83], v[80:83]
    ds_read_b64_tr_b16 a[40:41], v13 offset:8192
    v_mfma_f32_16x16x32_bf16 v[84:87], a[0:3], a[84:87], v[84:87]
    ds_read_b64_tr_b16 a[42:43], v13 offset:9216
    v_mfma_f32_16x16x32_bf16 v[108:111], a[4:7], a[84:87], v[108:111]
    ds_read_b64_tr_b16 a[44:45], v13 offset:8200
    v_mfma_f32_16x16x32_bf16 v[104:107], a[4:7], a[80:83], v[104:107]
    ds_read_b64_tr_b16 a[46:47], v13 offset:9224
    v_mfma_f32_16x16x32_bf16 v[100:103], a[4:7], a[76:79], v[100:103]
    ds_read_b64_tr_b16 a[48:49], v14 offset:8192
    buffer_load_dwordx4 v6, s[20:23], s60 offen offset:1024  lds
    v_mfma_f32_16x16x32_bf16 v[96:99], a[4:7], a[72:75], v[96:99]
    ds_read_b64_tr_b16 a[50:51], v14 offset:9216
    v_mfma_f32_16x16x32_bf16 v[92:95], a[4:7], a[68:71], v[92:95]
    ds_read_b64_tr_b16 a[52:53], v14 offset:8200
    v_mfma_f32_16x16x32_bf16 v[88:91], a[4:7], a[64:67], v[88:91]
    ds_read_b64_tr_b16 a[54:55], v14 offset:9224
    v_mfma_f32_16x16x32_bf16 v[112:115], a[8:11], a[64:67], v[112:115]
    ds_read_b64_tr_b16 a[56:57], v15 offset:8192
    v_mfma_f32_16x16x32_bf16 v[116:119], a[8:11], a[68:71], v[116:119]
    ds_read_b64_tr_b16 a[58:59], v15 offset:9216
    v_mfma_f32_16x16x32_bf16 v[120:123], a[8:11], a[72:75], v[120:123]
    ds_read_b64_tr_b16 a[60:61], v15 offset:8200
    buffer_load_dwordx4 v7, s[20:23], s60 offen offset:2048  lds
    v_mfma_f32_16x16x32_bf16 v[124:127], a[8:11], a[76:79], v[124:127]
    ds_read_b64_tr_b16 a[62:63], v15 offset:9224
    v_mfma_f32_16x16x32_bf16 v[128:131], a[8:11], a[80:83], v[128:131]
    ds_read_b128 a[88:91], v17 offset:0
    v_mfma_f32_16x16x32_bf16 v[132:135], a[8:11], a[84:87], v[132:135]
    ds_read_b128 a[92:95], v17 offset:2048
    v_mfma_f32_16x16x32_bf16 v[156:159], a[12:15], a[84:87], v[156:159]
    ds_read_b128 a[96:99], v17 offset:4096
    v_mfma_f32_16x16x32_bf16 v[152:155], a[12:15], a[80:83], v[152:155]
    ds_read_b128 a[100:103], v17 offset:6144
    v_mfma_f32_16x16x32_bf16 v[148:151], a[12:15], a[76:79], v[148:151]
    ds_read_b128 a[104:107], v17 offset:8192
    buffer_load_dwordx4 v8, s[20:23], s60 offen offset:3072  lds
    v_mfma_f32_16x16x32_bf16 v[144:147], a[12:15], a[72:75], v[144:147]
    ds_read_b128 a[108:111], v17 offset:10240
    v_mfma_f32_16x16x32_bf16 v[140:143], a[12:15], a[68:71], v[140:143]
    v_mfma_f32_16x16x32_bf16 v[136:139], a[12:15], a[64:67], v[136:139]
    v_mfma_f32_16x16x32_bf16 v[160:163], a[16:19], a[64:67], v[160:163]
    v_mfma_f32_16x16x32_bf16 v[164:167], a[16:19], a[68:71], v[164:167]
    v_mfma_f32_16x16x32_bf16 v[168:171], a[16:19], a[72:75], v[168:171]
    s_add_u32 m0, s59, 28672
    v_mfma_f32_16x16x32_bf16 v[172:175], a[16:19], a[76:79], v[172:175]
    buffer_load_dwordx4 v5, s[20:23], s61 offen offset:0  lds
    v_mfma_f32_16x16x32_bf16 v[176:179], a[16:19], a[80:83], v[176:179]
    v_mfma_f32_16x16x32_bf16 v[180:183], a[16:19], a[84:87], v[180:183]
    v_mfma_f32_16x16x32_bf16 v[204:207], a[20:23], a[84:87], v[204:207]
    v_mfma_f32_16x16x32_bf16 v[200:203], a[20:23], a[80:83], v[200:203]
    v_mfma_f32_16x16x32_bf16 v[196:199], a[20:23], a[76:79], v[196:199]
    v_mfma_f32_16x16x32_bf16 v[192:195], a[20:23], a[72:75], v[192:195]
    buffer_load_dwordx4 v6, s[20:23], s61 offen offset:1024  lds
    v_mfma_f32_16x16x32_bf16 v[188:191], a[20:23], a[68:71], v[188:191]
    v_mfma_f32_16x16x32_bf16 v[184:187], a[20:23], a[64:67], v[184:187]
    v_mfma_f32_16x16x32_bf16 v[208:211], a[24:27], a[64:67], v[208:211]
    v_mfma_f32_16x16x32_bf16 v[212:215], a[24:27], a[68:71], v[212:215]
    v_mfma_f32_16x16x32_bf16 v[216:219], a[24:27], a[72:75], v[216:219]
    v_mfma_f32_16x16x32_bf16 v[220:223], a[24:27], a[76:79], v[220:223]
    buffer_load_dwordx4 v7, s[20:23], s61 offen offset:2048  lds
    v_mfma_f32_16x16x32_bf16 v[224:227], a[24:27], a[80:83], v[224:227]
    v_mfma_f32_16x16x32_bf16 v[228:231], a[24:27], a[84:87], v[228:231]
    v_mfma_f32_16x16x32_bf16 v[252:255], a[28:31], a[84:87], v[252:255]
    v_mfma_f32_16x16x32_bf16 v[248:251], a[28:31], a[80:83], v[248:251]
    v_mfma_f32_16x16x32_bf16 v[244:247], a[28:31], a[76:79], v[244:247]
    v_mfma_f32_16x16x32_bf16 v[240:243], a[28:31], a[72:75], v[240:243]
    v_mfma_f32_16x16x32_bf16 v[236:239], a[28:31], a[68:71], v[236:239]
    buffer_load_dwordx4 v8, s[20:23], s61 offen offset:3072  lds
    s_add_u32 s73, s73, 524288
    s_and_b32 s73, s73, 0x3fffff
    v_mfma_f32_16x16x32_bf16 v[232:235], a[28:31], a[64:67], v[232:235]
    s_waitcnt vmcnt(8) lgkmcnt(0)
    s_barrier
    v_mfma_f32_16x16x32_bf16 v[64:67], a[32:35], a[88:91], v[64:67]
    ds_read_b64_tr_b16 a[0:1], v12 offset:16384
    v_mfma_f32_16x16x32_bf16 v[68:71], a[32:35], a[92:95], v[68:71]
    ds_read_b64_tr_b16 a[2:3], v12 offset:17408
    v_mfma_f32_16x16x32_bf16 v[72:75], a[32:35], a[96:99], v[72:75]
    ds_read_b64_tr_b16 a[4:5], v12 offset:16392
    s_mov_b32 s63, 0
    s_add_u32 m0, s59, 0
    s_nop 0
    buffer_load_dwordx4 v10, s[16:19], s63 offen offset:0 nt lds
    v_mfma_f32_16x16x32_bf16 v[76:79], a[32:35], a[100:103], v[76:79]
    ds_read_b64_tr_b16 a[6:7], v12 offset:17416
    v_mfma_f32_16x16x32_bf16 v[80:83], a[32:35], a[104:107], v[80:83]
    ds_read_b64_tr_b16 a[8:9], v13 offset:16384
    buffer_load_dwordx4 v11, s[16:19], s63 offen offset:1024 nt lds
    v_mfma_f32_16x16x32_bf16 v[84:87], a[32:35], a[108:111], v[84:87]
    ds_read_b64_tr_b16 a[10:11], v13 offset:17408
    v_mfma_f32_16x16x32_bf16 v[108:111], a[36:39], a[108:111], v[108:111]
    ds_read_b64_tr_b16 a[12:13], v13 offset:16392
    buffer_load_dwordx4 v10, s[16:19], s63 offen offset:2048 nt lds
    v_mfma_f32_16x16x32_bf16 v[104:107], a[36:39], a[104:107], v[104:107]
    ds_read_b64_tr_b16 a[14:15], v13 offset:17416
    v_mfma_f32_16x16x32_bf16 v[100:103], a[36:39], a[100:103], v[100:103]
    ds_read_b64_tr_b16 a[16:17], v14 offset:16384
    buffer_load_dwordx4 v11, s[16:19], s63 offen offset:3072 nt lds
    v_mfma_f32_16x16x32_bf16 v[96:99], a[36:39], a[96:99], v[96:99]
    ds_read_b64_tr_b16 a[18:19], v14 offset:17408
    v_mfma_f32_16x16x32_bf16 v[92:95], a[36:39], a[92:95], v[92:95]
    ds_read_b64_tr_b16 a[20:21], v14 offset:16392
    s_mov_b32 s63, 4096
    s_add_u32 m0, s59, 4096
    s_nop 0
    buffer_load_dwordx4 v10, s[16:19], s63 offen offset:0 nt lds
    v_mfma_f32_16x16x32_bf16 v[88:91], a[36:39], a[88:91], v[88:91]
    ds_read_b64_tr_b16 a[22:23], v14 offset:17416
    v_mfma_f32_16x16x32_bf16 v[112:115], a[40:43], a[88:91], v[112:115]
    ds_read_b64_tr_b16 a[24:25], v15 offset:16384
    buffer_load_dwordx4 v11, s[16:19], s63 offen offset:1024 nt lds
    v_mfma_f32_16x16x32_bf16 v[116:119], a[40:43], a[92:95], v[116:119]
    ds_read_b64_tr_b16 a[26:27], v15 offset:17408
    v_mfma_f32_16x16x32_bf16 v[120:123], a[40:43], a[96:99], v[120:123]
    ds_read_b64_tr_b16 a[28:29], v15 offset:16392
    buffer_load_dwordx4 v10, s[16:19], s63 offen offset:2048 nt lds
    v_mfma_f32_16x16x32_bf16 v[124:127], a[40:43], a[100:103], v[124:127]
    ds_read_b64_tr_b16 a[30:31], v15 offset:17416
    v_mfma_f32_16x16x32_bf16 v[128:131], a[40:43], a[104:107], v[128:131]
    ds_read_b128 a[64:67], v16 offset:12288
    buffer_load_dwordx4 v11, s[16:19], s63 offen offset:3072 nt lds
    v_mfma_f32_16x16x32_bf16 v[132:135], a[40:43], a[108:111], v[132:135]
    ds_read_b128 a[68:71], v16 offset:14336
    v_mfma_f32_16x16x32_bf16 v[156:159], a[44:47], a[108:111], v[156:159]
    ds_read_b128 a[72:75], v16 offset:16384
    v_mfma_f32_16x16x32_bf16 v[152:155], a[44:47], a[104:107], v[152:155]
    ds_read_b128 a[76:79], v16 offset:18432
    v_mfma_f32_16x16x32_bf16 v[148:151], a[44:47], a[100:103], v[148:151]
    ds_read_b128 a[80:83], v16 offset:20480
    v_mfma_f32_16x16x32_bf16 v[144:147], a[44:47], a[96:99], v[144:147]
    ds_read_b128 a[84:87], v16 offset:22528
    v_mfma_f32_16x16x32_bf16 v[140:143], a[44:47], a[92:95], v[140:143]
    v_mfma_f32_16x16x32_bf16 v[136:139], a[44:47], a[88:91], v[136:139]
    v_mfma_f32_16x16x32_bf16 v[160:163], a[48:51], a[88:91], v[160:163]
    v_mfma_f32_16x16x32_bf16 v[164:167], a[48:51], a[92:95], v[164:167]
    v_mfma_f32_16x16x32_bf16 v[168:171], a[48:51], a[96:99], v[168:171]
    v_mfma_f32_16x16x32_bf16 v[172:175], a[48:51], a[100:103], v[172:175]
    v_mfma_f32_16x16x32_bf16 v[176:179], a[48:51], a[104:107], v[176:179]
    v_mfma_f32_16x16x32_bf16 v[180:183], a[48:51], a[108:111], v[180:183]
    v_mfma_f32_16x16x32_bf16 v[204:207], a[52:55], a[108:111], v[204:207]
    v_mfma_f32_16x16x32_bf16 v[200:203], a[52:55], a[104:107], v[200:203]
    v_mfma_f32_16x16x32_bf16 v[196:199], a[52:55], a[100:103], v[196:199]
    v_mfma_f32_16x16x32_bf16 v[192:195], a[52:55], a[96:99], v[192:195]
    v_mfma_f32_16x16x32_bf16 v[188:191], a[52:55], a[92:95], v[188:191]
    v_mfma_f32_16x16x32_bf16 v[184:187], a[52:55], a[88:91], v[184:187]
    v_mfma_f32_16x16x32_bf16 v[208:211], a[56:59], a[88:91], v[208:211]
    v_mfma_f32_16x16x32_bf16 v[212:215], a[56:59], a[92:95], v[212:215]
    v_mfma_f32_16x16x32_bf16 v[216:219], a[56:59], a[96:99], v[216:219]
    v_mfma_f32_16x16x32_bf16 v[220:223], a[56:59], a[100:103], v[220:223]
    v_mfma_f32_16x16x32_bf16 v[224:227], a[56:59], a[104:107], v[224:227]
    v_mfma_f32_16x16x32_bf16 v[228:231], a[56:59], a[108:111], v[228:231]
    v_mfma_f32_16x16x32_bf16 v[252:255], a[60:63], a[108:111], v[252:255]
    v_mfma_f32_16x16x32_bf16 v[248:251], a[60:63], a[104:107], v[248:251]
    v_mfma_f32_16x16x32_bf16 v[244:247], a[60:63], a[100:103], v[244:247]
    v_mfma_f32_16x16x32_bf16 v[240:243], a[60:63], a[96:99], v[240:243]
    v_mfma_f32_16x16x32_bf16 v[236:239], a[60:63], a[92:95], v[236:239]
    v_mfma_f32_16x16x32_bf16 v[232:235], a[60:63], a[88:91], v[232:235]
    s_waitcnt lgkmcnt(0)
    s_waitcnt vmcnt(8)
    v_mfma_f32_16x16x32_bf16 v[64:67], a[0:3], a[64:67], v[64:67]
    ds_read_b64_tr_b16 a[32:33], v12 offset:24576
    v_mfma_f32_16x16x32_bf16 v[68:71], a[0:3], a[68:71], v[68:71]
    ds_read_b64_tr_b16 a[34:35], v12 offset:25600
    v_mfma_f32_16x16x32_bf16 v[72:75], a[0:3], a[72:75], v[72:75]
    ds_read_b64_tr_b16 a[36:37], v12 offset:24584
    v_mfma_f32_16x16x32_bf16 v[76:79], a[0:3], a[76:79], v[76:79]
    ds_read_b64_tr_b16 a[38:39], v12 offset:25608
    v_mfma_f32_16x16x32_bf16 v[80:83], a[0:3], a[80:83], v[80:83]
    ds_read_b64_tr_b16 a[40:41], v13 offset:24576
    v_mfma_f32_16x16x32_bf16 v[84:87], a[0:3], a[84:87], v[84:87]
    ds_read_b64_tr_b16 a[42:43], v13 offset:25600
    v_mfma_f32_16x16x32_bf16 v[108:111], a[4:7], a[84:87], v[108:111]
    ds_read_b64_tr_b16 a[44:45], v13 offset:24584
    v_mfma_f32_16x16x32_bf16 v[104:107], a[4:7], a[80:83], v[104:107]
    ds_read_b64_tr_b16 a[46:47], v13 offset:25608
    v_mfma_f32_16x16x32_bf16 v[100:103], a[4:7], a[76:79], v[100:103]
    ds_read_b64_tr_b16 a[48:49], v14 offset:24576
    v_mfma_f32_16x16x32_bf16 v[96:99], a[4:7], a[72:75], v[96:99]
    ds_read_b64_tr_b16 a[50:51], v14 offset:25600
    v_mfma_f32_16x16x32_bf16 v[92:95], a[4:7], a[68:71], v[92:95]
    ds_read_b64_tr_b16 a[52:53], v14 offset:24584
    v_mfma_f32_16x16x32_bf16 v[88:91], a[4:7], a[64:67], v[88:91]
    ds_read_b64_tr_b16 a[54:55], v14 offset:25608
    v_mfma_f32_16x16x32_bf16 v[112:115], a[8:11], a[64:67], v[112:115]
    ds_read_b64_tr_b16 a[56:57], v15 offset:24576
    v_mfma_f32_16x16x32_bf16 v[116:119], a[8:11], a[68:71], v[116:119]
    ds_read_b64_tr_b16 a[58:59], v15 offset:25600
    v_mfma_f32_16x16x32_bf16 v[120:123], a[8:11], a[72:75], v[120:123]
    ds_read_b64_tr_b16 a[60:61], v15 offset:24584
    v_mfma_f32_16x16x32_bf16 v[124:127], a[8:11], a[76:79], v[124:127]
    ds_read_b64_tr_b16 a[62:63], v15 offset:25608
    v_mfma_f32_16x16x32_bf16 v[128:131], a[8:11], a[80:83], v[128:131]
    ds_read_b128 a[88:91], v17 offset:12288
    v_mfma_f32_16x16x32_bf16 v[132:135], a[8:11], a[84:87], v[132:135]
    ds_read_b128 a[92:95], v17 offset:14336
    v_mfma_f32_16x16x32_bf16 v[156:159], a[12:15], a[84:87], v[156:159]
    ds_read_b128 a[96:99], v17 offset:16384
    v_mfma_f32_16x16x32_bf16 v[152:155], a[12:15], a[80:83], v[152:155]
    ds_read_b128 a[100:103], v17 offset:18432
    v_mfma_f32_16x16x32_bf16 v[148:151], a[12:15], a[76:79], v[148:151]
    ds_read_b128 a[104:107], v17 offset:20480
    v_mfma_f32_16x16x32_bf16 v[144:147], a[12:15], a[72:75], v[144:147]
    ds_read_b128 a[108:111], v17 offset:22528
    v_mfma_f32_16x16x32_bf16 v[140:143], a[12:15], a[68:71], v[140:143]
    v_mfma_f32_16x16x32_bf16 v[136:139], a[12:15], a[64:67], v[136:139]
    v_mfma_f32_16x16x32_bf16 v[160:163], a[16:19], a[64:67], v[160:163]
    v_mfma_f32_16x16x32_bf16 v[164:167], a[16:19], a[68:71], v[164:167]
    v_mfma_f32_16x16x32_bf16 v[168:171], a[16:19], a[72:75], v[168:171]
    v_mfma_f32_16x16x32_bf16 v[172:175], a[16:19], a[76:79], v[172:175]
    v_mfma_f32_16x16x32_bf16 v[176:179], a[16:19], a[80:83], v[176:179]
    v_mfma_f32_16x16x32_bf16 v[180:183], a[16:19], a[84:87], v[180:183]
    v_mfma_f32_16x16x32_bf16 v[204:207], a[20:23], a[84:87], v[204:207]
    v_mfma_f32_16x16x32_bf16 v[200:203], a[20:23], a[80:83], v[200:203]
    v_mfma_f32_16x16x32_bf16 v[196:199], a[20:23], a[76:79], v[196:199]
    v_mfma_f32_16x16x32_bf16 v[192:195], a[20:23], a[72:75], v[192:195]
    v_mfma_f32_16x16x32_bf16 v[188:191], a[20:23], a[68:71], v[188:191]
    v_mfma_f32_16x16x32_bf16 v[184:187], a[20:23], a[64:67], v[184:187]
    v_mfma_f32_16x16x32_bf16 v[208:211], a[24:27], a[64:67], v[208:211]
    v_mfma_f32_16x16x32_bf16 v[212:215], a[24:27], a[68:71], v[212:215]
    v_mfma_f32_16x16x32_bf16 v[216:219], a[24:27], a[72:75], v[216:219]
    v_mfma_f32_16x16x32_bf16 v[220:223], a[24:27], a[76:79], v[220:223]
    v_mfma_f32_16x16x32_bf16 v[224:227], a[24:27], a[80:83], v[224:227]
    v_mfma_f32_16x16x32_bf16 v[228:231], a[24:27], a[84:87], v[228:231]
    v_mfma_f32_16x16x32_bf16 v[252:255], a[28:31], a[84:87], v[252:255]
    v_mfma_f32_16x16x32_bf16 v[248:251], a[28:31], a[80:83], v[248:251]
    v_mfma_f32_16x16x32_bf16 v[244:247], a[28:31], a[76:79], v[244:247]
    v_mfma_f32_16x16x32_bf16 v[240:243], a[28:31], a[72:75], v[240:243]
    v_mfma_f32_16x16x32_bf16 v[236:239], a[28:31], a[68:71], v[236:239]
    v_mfma_f32_16x16x32_bf16 v[232:235], a[28:31], a[64:67], v[232:235]
    s_waitcnt lgkmcnt(0)
    s_barrier
    v_mfma_f32_16x16x32_bf16 v[64:67], a[32:35], a[88:91], v[64:67]
    v_mfma_f32_16x16x32_bf16 v[68:71], a[32:35], a[92:95], v[68:71]
    v_mfma_f32_16x16x32_bf16 v[72:75], a[32:35], a[96:99], v[72:75]
    s_mov_b32 s63, 8192
    s_add_u32 m0, s59, 8192
    s_nop 0
    buffer_load_dwordx4 v10, s[16:19], s63 offen offset:0 nt lds
    v_mfma_f32_16x16x32_bf16 v[76:79], a[32:35], a[100:103], v[76:79]
    v_mfma_f32_16x16x32_bf16 v[80:83], a[32:35], a[104:107], v[80:83]
    buffer_load_dwordx4 v11, s[16:19], s63 offen offset:1024 nt lds
    v_mfma_f32_16x16x32_bf16 v[84:87], a[32:35], a[108:111], v[84:87]
    v_mfma_f32_16x16x32_bf16 v[108:111], a[36:39], a[108:111], v[108:111]
    buffer_load_dwordx4 v10, s[16:19], s63 offen offset:2048 nt lds
    v_mfma_f32_16x16x32_bf16 v[104:107], a[36:39], a[104:107], v[104:107]
    v_mfma_f32_16x16x32_bf16 v[100:103], a[36:39], a[100:103], v[100:103]
    buffer_load_dwordx4 v11, s[16:19], s63 offen offset:3072 nt lds
    v_mfma_f32_16x16x32_bf16 v[96:99], a[36:39], a[96:99], v[96:99]
    v_mfma_f32_16x16x32_bf16 v[92:95], a[36:39], a[92:95], v[92:95]
    s_mov_b32 s63, 12288
    s_add_u32 m0, s59, 12288
    s_nop 0
    buffer_load_dwordx4 v10, s[16:19], s63 offen offset:0 nt lds
    v_mfma_f32_16x16x32_bf16 v[88:91], a[36:39], a[88:91], v[88:91]
    v_mfma_f32_16x16x32_bf16 v[112:115], a[40:43], a[88:91], v[112:115]
    buffer_load_dwordx4 v11, s[16:19], s63 offen offset:1024 nt lds
    v_mfma_f32_16x16x32_bf16 v[116:119], a[40:43], a[92:95], v[116:119]
    v_mfma_f32_16x16x32_bf16 v[120:123], a[40:43], a[96:99], v[120:123]
    buffer_load_dwordx4 v10, s[16:19], s63 offen offset:2048 nt lds
    v_cvt_pk_bf16_f32 v84, v84, v85
    v_cvt_pk_bf16_f32 v85, v86, v87
    v_mfma_f32_16x16x32_bf16 v[124:127], a[40:43], a[100:103], v[124:127]
    v_cvt_pk_bf16_f32 v86, v108, v109
    v_cvt_pk_bf16_f32 v87, v110, v111
    v_mfma_f32_16x16x32_bf16 v[128:131], a[40:43], a[104:107], v[128:131]
    buffer_load_dwordx4 v11, s[16:19], s63 offen offset:3072 nt lds
    v_cvt_pk_bf16_f32 v80, v80, v81
    v_cvt_pk_bf16_f32 v81, v82, v83
    v_mfma_f32_16x16x32_bf16 v[132:135], a[40:43], a[108:111], v[132:135]
    v_cvt_pk_bf16_f32 v82, v104, v105
    v_cvt_pk_bf16_f32 v83, v106, v107
    v_mfma_f32_16x16x32_bf16 v[156:159], a[44:47], a[108:111], v[156:159]
    v_cvt_pk_bf16_f32 v76, v76, v77
    v_cvt_pk_bf16_f32 v77, v78, v79
    v_mfma_f32_16x16x32_bf16 v[152:155], a[44:47], a[104:107], v[152:155]
    v_cvt_pk_bf16_f32 v78, v100, v101
    v_cvt_pk_bf16_f32 v79, v102, v103
    v_mfma_f32_16x16x32_bf16 v[148:151], a[44:47], a[100:103], v[148:151]
    v_cvt_pk_bf16_f32 v72, v72, v73
    v_cvt_pk_bf16_f32 v73, v74, v75
    v_mfma_f32_16x16x32_bf16 v[144:147], a[44:47], a[96:99], v[144:147]
    v_cvt_pk_bf16_f32 v74, v96, v97
    v_cvt_pk_bf16_f32 v75, v98, v99
    v_mfma_f32_16x16x32_bf16 v[140:143], a[44:47], a[92:95], v[140:143]
    v_cvt_pk_bf16_f32 v68, v68, v69
    v_cvt_pk_bf16_f32 v69, v70, v71
    v_mfma_f32_16x16x32_bf16 v[136:139], a[44:47], a[88:91], v[136:139]
    v_cvt_pk_bf16_f32 v70, v92, v93
    v_cvt_pk_bf16_f32 v71, v94, v95
    v_mfma_f32_16x16x32_bf16 v[160:163], a[48:51], a[88:91], v[160:163]
    v_cvt_pk_bf16_f32 v64, v64, v65
    v_cvt_pk_bf16_f32 v65, v66, v67
    v_mfma_f32_16x16x32_bf16 v[164:167], a[48:51], a[92:95], v[164:167]
    v_cvt_pk_bf16_f32 v66, v88, v89
    v_cvt_pk_bf16_f32 v67, v90, v91
    v_mfma_f32_16x16x32_bf16 v[168:171], a[48:51], a[96:99], v[168:171]
    v_cvt_pk_bf16_f32 v132, v132, v133
    v_cvt_pk_bf16_f32 v133, v134, v135
    v_mfma_f32_16x16x32_bf16 v[172:175], a[48:51], a[100:103], v[172:175]
    v_cvt_pk_bf16_f32 v134, v156, v157
    v_cvt_pk_bf16_f32 v135, v158, v159
    v_mfma_f32_16x16x32_bf16 v[176:179], a[48:51], a[104:107], v[176:179]
    v_cvt_pk_bf16_f32 v128, v128, v129
    v_cvt_pk_bf16_f32 v129, v130, v131
    v_mfma_f32_16x16x32_bf16 v[180:183], a[48:51], a[108:111], v[180:183]
    v_cvt_pk_bf16_f32 v130, v152, v153
    v_cvt_pk_bf16_f32 v131, v154, v155
    v_mfma_f32_16x16x32_bf16 v[204:207], a[52:55], a[108:111], v[204:207]
    v_cvt_pk_bf16_f32 v124, v124, v125
    v_cvt_pk_bf16_f32 v125, v126, v127
    v_mfma_f32_16x16x32_bf16 v[200:203], a[52:55], a[104:107], v[200:203]
    v_cvt_pk_bf16_f32 v126, v148, v149
    v_cvt_pk_bf16_f32 v127, v150, v151
    v_mfma_f32_16x16x32_bf16 v[196:199], a[52:55], a[100:103], v[196:199]
    v_cvt_pk_bf16_f32 v120, v120, v121
    v_cvt_pk_bf16_f32 v121, v122, v123
    v_mfma_f32_16x16x32_bf16 v[192:195], a[52:55], a[96:99], v[192:195]
    v_cvt_pk_bf16_f32 v122, v144, v145
    v_cvt_pk_bf16_f32 v123, v146, v147
    v_mfma_f32_16x16x32_bf16 v[188:191], a[52:55], a[92:95], v[188:191]
    v_cvt_pk_bf16_f32 v116, v116, v117
    v_cvt_pk_bf16_f32 v117, v118, v119
    v_mfma_f32_16x16x32_bf16 v[184:187], a[52:55], a[88:91], v[184:187]
    v_cvt_pk_bf16_f32 v118, v140, v141
    v_cvt_pk_bf16_f32 v119, v142, v143
    v_mfma_f32_16x16x32_bf16 v[208:211], a[56:59], a[88:91], v[208:211]
    v_cvt_pk_bf16_f32 v112, v112, v113
    v_cvt_pk_bf16_f32 v113, v114, v115
    v_mfma_f32_16x16x32_bf16 v[212:215], a[56:59], a[92:95], v[212:215]
    v_cvt_pk_bf16_f32 v114, v136, v137
    v_cvt_pk_bf16_f32 v115, v138, v139
    v_mfma_f32_16x16x32_bf16 v[216:219], a[56:59], a[96:99], v[216:219]
    v_cvt_pk_bf16_f32 v180, v180, v181
    v_cvt_pk_bf16_f32 v181, v182, v183
    v_cvt_pk_bf16_f32 v182, v204, v205
    v_mfma_f32_16x16x32_bf16 v[220:223], a[56:59], a[100:103], v[220:223]
    v_cvt_pk_bf16_f32 v183, v206, v207
    v_cvt_pk_bf16_f32 v176, v176, v177
    v_cvt_pk_bf16_f32 v177, v178, v179
    v_mfma_f32_16x16x32_bf16 v[224:227], a[56:59], a[104:107], v[224:227]
    v_cvt_pk_bf16_f32 v178, v200, v201
    v_cvt_pk_bf16_f32 v179, v202, v203
    v_mfma_f32_16x16x32_bf16 v[228:231], a[56:59], a[108:111], v[228:231]
    v_cvt_pk_bf16_f32 v172, v172, v173
    v_cvt_pk_bf16_f32 v173, v174, v175
    v_cvt_pk_bf16_f32 v174, v196, v197
    v_mfma_f32_16x16x32_bf16 v[252:255], a[60:63], a[108:111], v[252:255]
    v_cvt_pk_bf16_f32 v175, v198, v199
    v_cvt_pk_bf16_f32 v168, v168, v169
    v_cvt_pk_bf16_f32 v169, v170, v171
    v_mfma_f32_16x16x32_bf16 v[248:251], a[60:63], a[104:107], v[248:251]
    v_cvt_pk_bf16_f32 v170, v192, v193
    v_cvt_pk_bf16_f32 v171, v194, v195
    v_mfma_f32_16x16x32_bf16 v[244:247], a[60:63], a[100:103], v[244:247]
    v_cvt_pk_bf16_f32 v164, v164, v165
    v_cvt_pk_bf16_f32 v165, v166, v167
    v_cvt_pk_bf16_f32 v166, v188, v189
    v_mfma_f32_16x16x32_bf16 v[240:243], a[60:63], a[96:99], v[240:243]
    v_cvt_pk_bf16_f32 v167, v190, v191
    v_cvt_pk_bf16_f32 v160, v160, v161
    v_cvt_pk_bf16_f32 v161, v162, v163
    v_mfma_f32_16x16x32_bf16 v[236:239], a[60:63], a[92:95], v[236:239]
    v_cvt_pk_bf16_f32 v162, v184, v185
    v_cvt_pk_bf16_f32 v163, v186, v187
    v_mfma_f32_16x16x32_bf16 v[232:235], a[60:63], a[88:91], v[232:235]
    s_branch L_join
L_p1_1:
    v_mfma_f32_16x16x32_bf16 v[64:67], a[0:3], a[64:67], 0
    ds_read_b128 a[88:91], v17 offset:0
    v_mfma_f32_16x16x32_bf16 v[68:71], a[0:3], a[68:71], 0
    ds_read_b128 a[92:95], v17 offset:2048
    v_mfma_f32_16x16x32_bf16 v[72:75], a[0:3], a[72:75], 0
    ds_read_b128 a[96:99], v17 offset:4096
    v_mfma_f32_16x16x32_bf16 v[76:79], a[0:3], a[76:79], 0
    ds_read_b128 a[100:103], v17 offset:6144
    v_mfma_f32_16x16x32_bf16 v[80:83], a[0:3], a[80:83], 0
    ds_read_b128 a[104:107], v17 offset:8192
    v_mfma_f32_16x16x32_bf16 v[84:87], a[0:3], a[84:87], 0
    ds_read_b128 a[108:111], v17 offset:10240
    v_mfma_f32_16x16x32_bf16 v[108:111], a[4:7], a[84:87], 0
    v_mfma_f32_16x16x32_bf16 v[104:107], a[4:7], a[80:83], 0
    v_mfma_f32_16x16x32_bf16 v[100:103], a[4:7], a[76:79], 0
    v_mfma_f32_16x16x32_bf16 v[96:99], a[4:7], a[72:75], 0
    v_mfma_f32_16x16x32_bf16 v[92:95], a[4:7], a[68:71], 0
    v_mfma_f32_16x16x32_bf16 v[88:91], a[4:7], a[64:67], 0
    v_mfma_f32_16x16x32_bf16 v[112:115], a[8:11], a[64:67], 0
    v_mfma_f32_16x16x32_bf16 v[116:119], a[8:11], a[68:71], 0
    v_mfma_f32_16x16x32_bf16 v[120:123], a[8:11], a[72:75], 0
    v_mfma_f32_16x16x32_bf16 v[124:127], a[8:11], a[76:79], 0
    v_mfma_f32_16x16x32_bf16 v[128:131], a[8:11], a[80:83], 0
    v_mfma_f32_16x16x32_bf16 v[132:135], a[8:11], a[84:87], 0
    v_mfma_f32_16x16x32_bf16 v[156:159], a[12:15], a[84:87], 0
    v_mfma_f32_16x16x32_bf16 v[152:155], a[12:15], a[80:83], 0
    v_mfma_f32_16x16x32_bf16 v[148:151], a[12:15], a[76:79], 0
    v_mfma_f32_16x16x32_bf16 v[144:147], a[12:15], a[72:75], 0
    v_mfma_f32_16x16x32_bf16 v[140:143], a[12:15], a[68:71], 0
    s_waitcnt vmcnt(4)
    ds_read_b64_tr_b16 a[32:33], v12 offset:8192
    v_mfma_f32_16x16x32_bf16 v[136:139], a[12:15], a[64:67], 0
    ds_read_b64_tr_b16 a[34:35], v12 offset:9216
    v_mfma_f32_16x16x32_bf16 v[160:163], a[16:19], a[64:67], 0
    ds_read_b64_tr_b16 a[36:37], v12 offset:8200
    s_add_u32 s60, s73, s75
    s_or_b32 s61, s60, 131072
    s_add_u32 m0, s59, 16384
    s_nop 0
    buffer_load_dwordx4 v5, s[20:23], s60 offen offset:0  lds
    v_mfma_f32_16x16x32_bf16 v[164:167], a[16:19], a[68:71], 0
    ds_read_b64_tr_b16 a[38:39], v12 offset:9224
    v_mfma_f32_16x16x32_bf16 v[168:171], a[16:19], a[72:75], 0
    ds_read_b64_tr_b16 a[40:41], v13 offset:8192
    v_mfma_f32_16x16x32_bf16 v[172:175], a[16:19], a[76:79], 0
    ds_read_b64_tr_b16 a[42:43], v13 offset:9216
    buffer_load_dwordx4 v6, s[20:23], s60 offen offset:1024  lds
    v_mfma_f32_16x16x32_bf16 v[176:179], a[16:19], a[80:83], 0
    ds_read_b64_tr_b16 a[44:45], v13 offset:8200
    v_mfma_f32_16x16x32_bf16 v[180:183], a[16:19], a[84:87], 0
    ds_read_b64_tr_b16 a[46:47], v13 offset:9224
    v_mfma_f32_16x16x32_bf16 v[204:207], a[20:23], a[84:87], 0
    ds_read_b64_tr_b16 a[48:49], v14 offset:8192
    buffer_load_dwordx4 v7, s[20:23], s60 offen offset:2048  lds
    v_mfma_f32_16x16x32_bf16 v[200:203], a[20:23], a[80:83], 0
    ds_read_b64_tr_b16 a[50:51], v14 offset:9216
    v_mfma_f32_16x16x32_bf16 v[196:199], a[20:23], a[76:79], 0
    ds_read_b64_tr_b16 a[52:53], v14 offset:8200
    v_mfma_f32_16x16x32_bf16 v[192:195], a[20:23], a[72:75], 0
    ds_read_b64_tr_b16 a[54:55], v14 offset:9224
    buffer_load_dwordx4 v8, s[20:23], s60 offen offset:3072  lds
    v_mfma_f32_16x16x32_bf16 v[188:191], a[20:23], a[68:71], 0
    ds_read_b64_tr_b16 a[56:57], v15 offset:8192
    v_mfma_f32_16x16x32_bf16 v[184:187], a[20:23], a[64:67], 0
    ds_read_b64_tr_b16 a[58:59], v15 offset:9216
    v_mfma_f32_16x16x32_bf16 v[208:211], a[24:27], a[64:67], 0
    ds_read_b64_tr_b16 a[60:61], v15 offset:8200
    s_add_u32 m0, s59, 20480
    s_nop 0
    buffer_load_dwordx4 v5, s[20:23], s61 offen offset:0  lds
    v_mfma_f32_16x16x32_bf16 v[212:215], a[24:27], a[68:71], 0
    ds_read_b64_tr_b16 a[62:63], v15 offset:9224
    v_mfma_f32_16x16x32_bf16 v[216:219], a[24:27], a[72:75], 0
    v_mfma_f32_16x16x32_bf16 v[220:223], a[24:27], a[76:79], 0
    buffer_load_dwordx4 v6, s[20:23], s61 offen offset:1024  lds
    v_mfma_f32_16x16x32_bf16 v[224:227], a[24:27], a[80:83], 0
    v_mfma_f32_16x16x32_bf16 v[228:231], a[24:27], a[84:87], 0
    v_mfma_f32_16x16x32_bf16 v[252:255], a[28:31], a[84:87], 0
    buffer_load_dwordx4 v7, s[20:23], s61 offen offset:2048  lds
    v_mfma_f32_16x16x32_bf16 v[248:251], a[28:31], a[80:83], 0
    v_mfma_f32_16x16x32_bf16 v[244:247], a[28:31], a[76:79], 0
    v_mfma_f32_16x16x32_bf16 v[240:243], a[28:31], a[72:75], 0
    v_mfma_f32_16x16x32_bf16 v[236:239], a[28:31], a[68:71], 0
    buffer_load_dwordx4 v8, s[20:23], s61 offen offset:3072  lds
    v_mfma_f32_16x16x32_bf16 v[232:235], a[28:31], a[64:67], 0
    s_waitcnt vmcnt(9) lgkmcnt(0)
    s_barrier
    v_mfma_f32_16x16x32_bf16 v[64:67], a[32:35], a[88:91], v[64:67]
    ds_read_b128 a[64:67], v16 offset:12288
    v_mfma_f32_16x16x32_bf16 v[68:71], a[32:35], a[92:95], v[68:71]
    ds_read_b128 a[68:71], v16 offset:14336
    v_mfma_f32_16x16x32_bf16 v[72:75], a[32:35], a[96:99], v[72:75]
    ds_read_b128 a[72:75], v16 offset:16384
    v_mfma_f32_16x16x32_bf16 v[76:79], a[32:35], a[100:103], v[76:79]
    ds_read_b128 a[76:79], v16 offset:18432
    v_mfma_f32_16x16x32_bf16 v[80:83], a[32:35], a[104:107], v[80:83]
    ds_read_b128 a[80:83], v16 offset:20480
    v_mfma_f32_16x16x32_bf16 v[84:87], a[32:35], a[108:111], v[84:87]
    ds_read_b128 a[84:87], v16 offset:22528
    v_mfma_f32_16x16x32_bf16 v[108:111], a[36:39], a[108:111], v[108:111]
    v_mfma_f32_16x16x32_bf16 v[104:107], a[36:39], a[104:107], v[104:107]
    v_mfma_f32_16x16x32_bf16 v[100:103], a[36:39], a[100:103], v[100:103]
    v_mfma_f32_16x16x32_bf16 v[96:99], a[36:39], a[96:99], v[96:99]
    v_mfma_f32_16x16x32_bf16 v[92:95], a[36:39], a[92:95], v[92:95]
    v_mfma_f32_16x16x32_bf16 v[88:91], a[36:39], a[88:91], v[88:91]
    v_mfma_f32_16x16x32_bf16 v[112:115], a[40:43], a[88:91], v[112:115]
    v_mfma_f32_16x16x32_bf16 v[116:119], a[40:43], a[92:95], v[116:119]
    v_mfma_f32_16x16x32_bf16 v[120:123], a[40:43], a[96:99], v[120:123]
    v_mfma_f32_16x16x32_bf16 v[124:127], a[40:43], a[100:103], v[124:127]
    v_mfma_f32_16x16x32_bf16 v[128:131], a[40:43], a[104:107], v[128:131]
    v_mfma_f32_16x16x32_bf16 v[132:135], a[40:43], a[108:111], v[132:135]
    v_mfma_f32_16x16x32_bf16 v[156:159], a[44:47], a[108:111], v[156:159]
    v_mfma_f32_16x16x32_bf16 v[152:155], a[44:47], a[104:107], v[152:155]
    v_mfma_f32_16x16x32_bf16 v[148:151], a[44:47], a[100:103], v[148:151]
    v_mfma_f32_16x16x32_bf16 v[144:147], a[44:47], a[96:99], v[144:147]
    v_mfma_f32_16x16x32_bf16 v[140:143], a[44:47], a[92:95], v[140:143]
    s_waitcnt vmcnt(0)
    ds_read_b64_tr_b16 a[0:1], v12 offset:16384
    v_mfma_f32_16x16x32_bf16 v[136:139], a[44:47], a[88:91], v[136:139]
    ds_read_b64_tr_b16 a[2:3], v12 offset:17408
    v_mfma_f32_16x16x32_bf16 v[160:163], a[48:51], a[88:91], v[160:163]
    ds_read_b64_tr_b16 a[4:5], v12 offset:16392
    s_add_u32 s60, s73, s100
    s_or_b32 s61, s60, 131072
    s_add_u32 m0, s59, 24576
    s_nop 0
    buffer_load_dwordx4 v5, s[20:23], s60 offen offset:0  lds
    v_mfma_f32_16x16x32_bf16 v[164:167], a[48:51], a[92:95], v[164:167]
    ds_read_b64_tr_b16 a[6:7], v12 offset:17416
    v_mfma_f32_16x16x32_bf16 v[168:171], a[48:51], a[96:99], v[168:171]
    ds_read_b64_tr_b16 a[8:9], v13 offset:16384
    v_mfma_f32_16x16x32_bf16 v[172:175], a[48:51], a[100:103], v[172:175]
    ds_read_b64_tr_b16 a[10:11], v13 offset:17408
    buffer_load_dwordx4 v6, s[20:23], s60 offen offset:1024  lds
    v_mfma_f32_16x16x32_bf16 v[176:179], a[48:51], a[104:107], v[176:179]
    ds_read_b64_tr_b16 a[12:13], v13 offset:16392
    v_mfma_f32_16x16x32_bf16 v[180:183], a[48:51], a[108:111], v[180:183]
    ds_read_b64_tr_b16 a[14:15], v13 offset:17416
    v_mfma_f32_16x16x32_bf16 v[204:207], a[52:55], a[108:111], v[204:207]
    ds_read_b64_tr_b16 a[16:17], v14 offset:16384
    buffer_load_dwordx4 v7, s[20:23], s60 offen offset:2048  lds
    v_mfma_f32_16x16x32_bf16 v[200:203], a[52:55], a[104:107], v[200:203]
    ds_read_b64_tr_b16 a[18:19], v14 offset:17408
    v_mfma_f32_16x16x32_bf16 v[196:199], a[52:55], a[100:103], v[196:199]
    ds_read_b64_tr_b16 a[20:21], v14 offset:16392
    v_mfma_f32_16x16x32_bf16 v[192:195], a[52:55], a[96:99], v[192:195]
    ds_read_b64_tr_b16 a[22:23], v14 offset:17416
    buffer_load_dwordx4 v8, s[20:23], s60 offen offset:3072  lds
    v_mfma_f32_16x16x32_bf16 v[188:191], a[52:55], a[92:95], v[188:191]
    ds_read_b64_tr_b16 a[24:25], v15 offset:16384
    v_mfma_f32_16x16x32_bf16 v[184:187], a[52:55], a[88:91], v[184:187]
    ds_read_b64_tr_b16 a[26:27], v15 offset:17408
    v_mfma_f32_16x16x32_bf16 v[208:211], a[56:59], a[88:91], v[208:211]
    ds_read_b64_tr_b16 a[28:29], v15 offset:16392
    s_add_u32 m0, s59, 28672
    s_nop 0
    buffer_load_dwordx4 v5, s[20:23], s61 offen offset:0  lds
    v_mfma_f32_16x16x32_bf16 v[212:215], a[56:59], a[92:95], v[212:215]
    ds_read_b64_tr_b16 a[30:31], v15 offset:17416
    v_mfma_f32_16x16x32_bf16 v[216:219], a[56:59], a[96:99], v[216:219]
    v_mfma_f32_16x16x32_bf16 v[220:223], a[56:59], a[100:103], v[220:223]
    buffer_load_dwordx4 v6, s[20:23], s61 offen offset:1024  lds
    v_mfma_f32_16x16x32_bf16 v[224:227], a[56:59], a[104:107], v[224:227]
    v_mfma_f32_16x16x32_bf16 v[228:231], a[56:59], a[108:111], v[228:231]
    v_mfma_f32_16x16x32_bf16 v[252:255], a[60:63], a[108:111], v[252:255]
    buffer_load_dwordx4 v7, s[20:23], s61 offen offset:2048  lds
    s_add_u32 m0, s66, 0
    s_nop 0
    buffer_load_dwordx4 v2, s[8:11], s62 offen offset:0  lds
    v_mfma_f32_16x16x32_bf16 v[248:251], a[60:63], a[104:107], v[248:251]
    v_mfma_f32_16x16x32_bf16 v[244:247], a[60:63], a[100:103], v[244:247]
    buffer_load_dwordx4 v3, s[8:11], s62 offen offset:1024  lds
    v_mfma_f32_16x16x32_bf16 v[240:243], a[60:63], a[96:99], v[240:243]
    s_add_u32 m0, s59, 28672
    v_mfma_f32_16x16x32_bf16 v[236:239], a[60:63], a[92:95], v[236:239]
    buffer_load_dwordx4 v8, s[20:23], s61 offen offset:3072  lds
    s_add_u32 s73, s73, 524288
    s_and_b32 s73, s73, 0x3fffff
    s_add_u32 m0, s66, 0
    s_nop 0
    buffer_load_dwordx4 v4, s[8:11], s62 offen offset:2048  lds
    s_add_u32 s62, s62, 128
    s_and_b32 s62, s62, 1023
    v_mfma_f32_16x16x32_bf16 v[232:235], a[60:63], a[88:91], v[232:235]
    s_waitcnt lgkmcnt(0)
    v_mfma_f32_16x16x32_bf16 v[64:67], a[0:3], a[64:67], v[64:67]
    ds_read_b128 a[88:91], v17 offset:12288
    v_mfma_f32_16x16x32_bf16 v[68:71], a[0:3], a[68:71], v[68:71]
    ds_read_b128 a[92:95], v17 offset:14336
    s_add_u32 s60, s73, s75
    s_or_b32 s61, s60, 131072
    s_add_u32 m0, s59, 0
    s_nop 0
    buffer_load_dwordx4 v5, s[20:23], s60 offen offset:0  lds
    v_mfma_f32_16x16x32_bf16 v[72:75], a[0:3], a[72:75], v[72:75]
    ds_read_b128 a[96:99], v17 offset:16384
    v_mfma_f32_16x16x32_bf16 v[76:79], a[0:3], a[76:79], v[76:79]
    ds_read_b128 a[100:103], v17 offset:18432
    buffer_load_dwordx4 v6, s[20:23], s60 offen offset:1024  lds
    v_mfma_f32_16x16x32_bf16 v[80:83], a[0:3], a[80:83], v[80:83]
    ds_read_b128 a[104:107], v17 offset:20480
    v_mfma_f32_16x16x32_bf16 v[84:87], a[0:3], a[84:87], v[84:87]
    ds_read_b128 a[108:111], v17 offset:22528
    v_mfma_f32_16x16x32_bf16 v[108:111], a[4:7], a[84:87], v[108:111]
    buffer_load_dwordx4 v7, s[20:23], s60 offen offset:2048  lds
    v_mfma_f32_16x16x32_bf16 v[104:107], a[4:7], a[80:83], v[104:107]
    v_mfma_f32_16x16x32_bf16 v[100:103], a[4:7], a[76:79], v[100:103]
    v_mfma_f32_16x16x32_bf16 v[96:99], a[4:7], a[72:75], v[96:99]
    buffer_load_dwordx4 v8, s[20:23], s60 offen offset:3072  lds
    v_mfma_f32_16x16x32_bf16 v[92:95], a[4:7], a[68:71], v[92:95]
    v_mfma_f32_16x16x32_bf16 v[88:91], a[4:7], a[64:67], v[88:91]
    s_add_u32 m0, s59, 4096
    v_mfma_f32_16x16x32_bf16 v[112:115], a[8:11], a[64:67], v[112:115]
    buffer_load_dwordx4 v5, s[20:23], s61 offen offset:0  lds
    v_mfma_f32_16x16x32_bf16 v[116:119], a[8:11], a[68:71], v[116:119]
    v_mfma_f32_16x16x32_bf16 v[120:123], a[8:11], a[72:75], v[120:123]
    v_mfma_f32_16x16x32_bf16 v[124:127], a[8:11], a[76:79], v[124:127]
    buffer_load_dwordx4 v6, s[20:23], s61 offen offset:1024  lds
    v_mfma_f32_16x16x32_bf16 v[128:131], a[8:11], a[80:83], v[128:131]
    v_mfma_f32_16x16x32_bf16 v[132:135], a[8:11], a[84:87], v[132:135]
    v_mfma_f32_16x16x32_bf16 v[156:159], a[12:15], a[84:87], v[156:159]
    buffer_load_dwordx4 v7, s[20:23], s61 offen offset:2048  lds
    v_mfma_f32_16x16x32_bf16 v[152:155], a[12:15], a[80:83], v[152:155]
    v_mfma_f32_16x16x32_bf16 v[148:151], a[12:15], a[76:79], v[148:151]
    v_mfma_f32_16x16x32_bf16 v[144:147], a[12:15], a[72:75], v[144:147]
    buffer_load_dwordx4 v8, s[20:23], s61 offen offset:3072  lds
    v_mfma_f32_16x16x32_bf16 v[140:143], a[12:15], a[68:71], v[140:143]
    s_waitcnt vmcnt(9)
    ds_read_b64_tr_b16 a[32:33], v12 offset:24576
    v_mfma_f32_16x16x32_bf16 v[136:139], a[12:15], a[64:67], v[136:139]
    ds_read_b64_tr_b16 a[34:35], v12 offset:25600
    v_mfma_f32_16x16x32_bf16 v[160:163], a[16:19], a[64:67], v[160:163]
    ds_read_b64_tr_b16 a[36:37], v12 offset:24584
    s_add_u32 s60, s73, s100
    s_or_b32 s61, s60, 131072
    s_add_u32 m0, s59, 8192
    s_nop 0
    buffer_load_dwordx4 v5, s[20:23], s60 offen offset:0  lds
    v_mfma_f32_16x16x32_bf16 v[164:167], a[16:19], a[68:71], v[164:167]
    ds_read_b64_tr_b16 a[38:39], v12 offset:25608
    v_mfma_f32_16x16x32_bf16 v[168:171], a[16:19], a[72:75], v[168:171]
    ds_read_b64_tr_b16 a[40:41], v13 offset:24576
    v_mfma_f32_16x16x32_bf16 v[172:175], a[16:19], a[76:79], v[172:175]
    ds_read_b64_tr_b16 a[42:43], v13 offset:25600
    buffer_load_dwordx4 v6, s[20:23], s60 offen offset:1024  lds
    v_mfma_f32_16x16x32_bf16 v[176:179], a[16:19], a[80:83], v[176:179]
    ds_read_b64_tr_b16 a[44:45], v13 offset:24584
    v_mfma_f32_16x16x32_bf16 v[180:183], a[16:19], a[84:87], v[180:183]
    ds_read_b64_tr_b16 a[46:47], v13 offset:25608
    v_mfma_f32_16x16x32_bf16 v[204:207], a[20:23], a[84:87], v[204:207]
    ds_read_b64_tr_b16 a[48:49], v14 offset:24576
    buffer_load_dwordx4 v7, s[20:23], s60 offen offset:2048  lds
    v_mfma_f32_16x16x32_bf16 v[200:203], a[20:23], a[80:83], v[200:203]
    ds_read_b64_tr_b16 a[50:51], v14 offset:25600
    v_mfma_f32_16x16x32_bf16 v[196:199], a[20:23], a[76:79], v[196:199]
    ds_read_b64_tr_b16 a[52:53], v14 offset:24584
    v_mfma_f32_16x16x32_bf16 v[192:195], a[20:23], a[72:75], v[192:195]
    ds_read_b64_tr_b16 a[54:55], v14 offset:25608
    buffer_load_dwordx4 v8, s[20:23], s60 offen offset:3072  lds
    v_mfma_f32_16x16x32_bf16 v[188:191], a[20:23], a[68:71], v[188:191]
    ds_read_b64_tr_b16 a[56:57], v15 offset:24576
    v_mfma_f32_16x16x32_bf16 v[184:187], a[20:23], a[64:67], v[184:187]
    ds_read_b64_tr_b16 a[58:59], v15 offset:25600
    v_mfma_f32_16x16x32_bf16 v[208:211], a[24:27], a[64:67], v[208:211]
    ds_read_b64_tr_b16 a[60:61], v15 offset:24584
    s_add_u32 m0, s59, 12288
    s_nop 0
    buffer_load_dwordx4 v5, s[20:23], s61 offen offset:0  lds
    v_mfma_f32_16x16x32_bf16 v[212:215], a[24:27], a[68:71], v[212:215]
    ds_read_b64_tr_b16 a[62:63], v15 offset:25608
    v_mfma_f32_16x16x32_bf16 v[216:219], a[24:27], a[72:75], v[216:219]
    v_mfma_f32_16x16x32_bf16 v[220:223], a[24:27], a[76:79], v[220:223]
    buffer_load_dwordx4 v6, s[20:23], s61 offen offset:1024  lds
    v_mfma_f32_16x16x32_bf16 v[224:227], a[24:27], a[80:83], v[224:227]
    v_mfma_f32_16x16x32_bf16 v[228:231], a[24:27], a[84:87], v[228:231]
    v_mfma_f32_16x16x32_bf16 v[252:255], a[28:31], a[84:87], v[252:255]
    buffer_load_dwordx4 v7, s[20:23], s61 offen offset:2048  lds
    v_mfma_f32_16x16x32_bf16 v[248:251], a[28:31], a[80:83], v[248:251]
    v_mfma_f32_16x16x32_bf16 v[244:247], a[28:31], a[76:79], v[244:247]
    v_mfma_f32_16x16x32_bf16 v[240:243], a[28:31], a[72:75], v[240:243]
    v_mfma_f32_16x16x32_bf16 v[236:239], a[28:31], a[68:71], v[236:239]
    buffer_load_dwordx4 v8, s[20:23], s61 offen offset:3072  lds
    s_add_u32 s73, s73, 524288
    s_and_b32 s73, s73, 0x3fffff
    v_mfma_f32_16x16x32_bf16 v[232:235], a[28:31], a[64:67], v[232:235]
    s_waitcnt vmcnt(16) lgkmcnt(0)
    s_barrier
    s_waitcnt vmcnt(8)
    v_mfma_f32_16x16x32_bf16 v[64:67], a[32:35], a[88:91], v[64:67]
    ds_read_b64_tr_b16 a[0:1], v12 offset:0
    v_mfma_f32_16x16x32_bf16 v[68:71], a[32:35], a[92:95], v[68:71]
    ds_read_b64_tr_b16 a[2:3], v12 offset:1024
    v_mfma_f32_16x16x32_bf16 v[72:75], a[32:35], a[96:99], v[72:75]
    ds_read_b64_tr_b16 a[4:5], v12 offset:8
    s_add_u32 s60, s73, s75
    s_or_b32 s61, s60, 131072
    s_add_u32 m0, s59, 16384
    s_nop 0
    buffer_load_dwordx4 v5, s[20:23], s60 offen offset:0  lds
    v_mfma_f32_16x16x32_bf16 v[76:79], a[32:35], a[100:103], v[76:79]
    ds_read_b64_tr_b16 a[6:7], v12 offset:1032
    v_mfma_f32_16x16x32_bf16 v[80:83], a[32:35], a[104:107], v[80:83]
    ds_read_b64_tr_b16 a[8:9], v13 offset:0
    v_mfma_f32_16x16x32_bf16 v[84:87], a[32:35], a[108:111], v[84:87]
    ds_read_b64_tr_b16 a[10:11], v13 offset:1024
    v_mfma_f32_16x16x32_bf16 v[108:111], a[36:39], a[108:111], v[108:111]
    ds_read_b64_tr_b16 a[12:13], v13 offset:8
    v_mfma_f32_16x16x32_bf16 v[104:107], a[36:39], a[104:107], v[104:107]
    ds_read_b64_tr_b16 a[14:15], v13 offset:1032
    buffer_load_dwordx4 v6, s[20:23], s60 offen offset:1024  lds
    v_mfma_f32_16x16x32_bf16 v[100:103], a[36:39], a[100:103], v[100:103]
    ds_read_b64_tr_b16 a[16:17], v14 offset:0
    v_mfma_f32_16x16x32_bf16 v[96:99], a[36:39], a[96:99], v[96:99]
    ds_read_b64_tr_b16 a[18:19], v14 offset:1024
    v_mfma_f32_16x16x32_bf16 v[92:95], a[36:39], a[92:95], v[92:95]
    ds_read_b64_tr_b16 a[20:21], v14 offset:8
    v_mfma_f32_16x16x32_bf16 v[88:91], a[36:39], a[88:91], v[88:91]
    ds_read_b64_tr_b16 a[22:23], v14 offset:1032
    v_mfma_f32_16x16x32_bf16 v[112:115], a[40:43], a[88:91], v[112:115]
    ds_read_b64_tr_b16 a[24:25], v15 offset:0
    buffer_load_dwordx4 v7, s[20:23], s60 offen offset:2048  lds
    v_mfma_f32_16x16x32_bf16 v[116:119], a[40:43], a[92:95], v[116:119]
    ds_read_b64_tr_b16 a[26:27], v15 offset:1024
    v_mfma_f32_16x16x32_bf16 v[120:123], a[40:43], a[96:99], v[120:123]
    ds_read_b64_tr_b16 a[28:29], v15 offset:8
    v_mfma_f32_16x16x32_bf16 v[124:127], a[40:43], a[100:103], v[124:127]
    ds_read_b64_tr_b16 a[30:31], v15 offset:1032
    v_mfma_f32_16x16x32_bf16 v[128:131], a[40:43], a[104:107], v[128:131]
    ds_read_b128 a[64:67], v16 offset:0
    v_mfma_f32_16x16x32_bf16 v[132:135], a[40:43], a[108:111], v[132:135]
    ds_read_b128 a[68:71], v16 offset:2048
    v_mfma_f32_16x16x32_bf16 v[156:159], a[44:47], a[108:111], v[156:159]
    ds_read_b128 a[72:75], v16 offset:4096
    buffer_load_dwordx4 v8, s[20:23], s60 offen offset:3072  lds
    v_mfma_f32_16x16x32_bf16 v[152:155], a[44:47], a[104:107], v[152:155]
    ds_read_b128 a[76:79], v16 offset:6144
    v_mfma_f32_16x16x32_bf16 v[148:151], a[44:47], a[100:103], v[148:151]
    ds_read_b128 a[80:83], v16 offset:8192
    v_mfma_f32_16x16x32_bf16 v[144:147], a[44:47], a[96:99], v[144:147]
    ds_read_b128 a[84:87], v16 offset:10240
    v_mfma_f32_16x16x32_bf16 v[140:143], a[44:47], a[92:95], v[140:143]
    s_add_u32 m0, s59, 20480
    v_mfma_f32_16x16x32_bf16 v[136:139], a[44:47], a[88:91], v[136:139]
    buffer_load_dwordx4 v5, s[20:23], s61 offen offset:0  lds
    v_mfma_f32_16x16x32_bf16 v[160:163], a[48:51], a[88:91], v[160:163]
    v_mfma_f32_16x16x32_bf16 v[164:167], a[48:51], a[92:95], v[164:167]
    v_mfma_f32_16x16x32_bf16 v[168:171], a[48:51], a[96:99], v[168:171]
    v_mfma_f32_16x16x32_bf16 v[172:175], a[48:51], a[100:103], v[172:175]
    v_mfma_f32_16x16x32_bf16 v[176:179], a[48:51], a[104:107], v[176:179]
    v_mfma_f32_16x16x32_bf16 v[180:183], a[48:51], a[108:111], v[180:183]
    buffer_load_dwordx4 v6, s[20:23], s61 offen offset:1024  lds
    v_mfma_f32_16x16x32_bf16 v[204:207], a[52:55], a[108:111], v[204:207]
    v_mfma_f32_16x16x32_bf16 v[200:203], a[52:55], a[104:107], v[200:203]
    v_mfma_f32_16x16x32_bf16 v[196:199], a[52:55], a[100:103], v[196:199]
    v_mfma_f32_16x16x32_bf16 v[192:195], a[52:55], a[96:99], v[192:195]
    v_mfma_f32_16x16x32_bf16 v[188:191], a[52:55], a[92:95], v[188:191]
    buffer_load_dwordx4 v7, s[20:23], s61 offen offset:2048  lds
    v_mfma_f32_16x16x32_bf16 v[184:187], a[52:55], a[88:91], v[184:187]
    v_mfma_f32_16x16x32_bf16 v[208:211], a[56:59], a[88:91], v[208:211]
    v_mfma_f32_16x16x32_bf16 v[212:215], a[56:59], a[92:95], v[212:215]
    v_mfma_f32_16x16x32_bf16 v[216:219], a[56:59], a[96:99], v[216:219]
    v_mfma_f32_16x16x32_bf16 v[220:223], a[56:59], a[100:103], v[220:223]
    v_mfma_f32_16x16x32_bf16 v[224:227], a[56:59], a[104:107], v[224:227]
    buffer_load_dwordx4 v8, s[20:23], s61 offen offset:3072  lds
    v_mfma_f32_16x16x32_bf16 v[228:231], a[56:59], a[108:111], v[228:231]
    s_add_u32 m0, s66, 12288
    v_mfma_f32_16x16x32_bf16 v[252:255], a[60:63], a[108:111], v[252:255]
    buffer_load_dwordx4 v2, s[8:11], s62 offen offset:0  lds
    v_mfma_f32_16x16x32_bf16 v[248:251], a[60:63], a[104:107], v[248:251]
    v_mfma_f32_16x16x32_bf16 v[244:247], a[60:63], a[100:103], v[244:247]
    buffer_load_dwordx4 v3, s[8:11], s62 offen offset:1024  lds
    v_mfma_f32_16x16x32_bf16 v[240:243], a[60:63], a[96:99], v[240:243]
    v_mfma_f32_16x16x32_bf16 v[236:239], a[60:63], a[92:95], v[236:239]
    buffer_load_dwordx4 v4, s[8:11], s62 offen offset:2048  lds
    s_add_u32 s62, s62, 128
    s_and_b32 s62, s62, 1023
    v_mfma_f32_16x16x32_bf16 v[232:235], a[60:63], a[88:91], v[232:235]
    s_waitcnt lgkmcnt(0)
    s_waitcnt vmcnt(11)
    v_mfma_f32_16x16x32_bf16 v[64:67], a[0:3], a[64:67], v[64:67]
    ds_read_b64_tr_b16 a[32:33], v12 offset:8192
    s_add_u32 s60, s73, s100
    s_or_b32 s61, s60, 131072
    s_add_u32 m0, s59, 24576
    s_nop 0
    buffer_load_dwordx4 v5, s[20:23], s60 offen offset:0  lds
    v_mfma_f32_16x16x32_bf16 v[68:71], a[0:3], a[68:71], v[68:71]
    ds_read_b64_tr_b16 a[34:35], v12 offset:9216
    v_mfma_f32_16x16x32_bf16 v[72:75], a[0:3], a[72:75], v[72:75]
    ds_read_b64_tr_b16 a[36:37], v12 offset:8200
    buffer_load_dwordx4 v6, s[20:23], s60 offen offset:1024  lds
    v_mfma_f32_16x16x32_bf16 v[76:79], a[0:3], a[76:79], v[76:79]
    ds_read_b64_tr_b16 a[38:39], v12 offset:9224
    v_mfma_f32_16x16x32_bf16 v[80:83], a[0:3], a[80:83], v[80:83]
    ds_read_b64_tr_b16 a[40:41], v13 offset:8192
    buffer_load_dwordx4 v7, s[20:23], s60 offen offset:2048  lds
    v_mfma_f32_16x16x32_bf16 v[84:87], a[0:3], a[84:87], v[84:87]
    ds_read_b64_tr_b16 a[42:43], v13 offset:9216
    v_mfma_f32_16x16x32_bf16 v[108:111], a[4:7], a[84:87], v[108:111]
    ds_read_b64_tr_b16 a[44:45], v13 offset:8200
    buffer_load_dwordx4 v8, s[20:23], s60 offen offset:3072  lds
    v_mfma_f32_16x16x32_bf16 v[104:107], a[4:7], a[80:83], v[104:107]
    ds_read_b64_tr_b16 a[46:47], v13 offset:9224
    v_mfma_f32_16x16x32_bf16 v[100:103], a[4:7], a[76:79], v[100:103]
    ds_read_b64_tr_b16 a[48:49], v14 offset:8192
    s_add_u32 m0, s59, 28672
    s_nop 0
    buffer_load_dwordx4 v5, s[20:23], s61 offen offset:0  lds
    v_mfma_f32_16x16x32_bf16 v[96:99], a[4:7], a[72:75], v[96:99]
    ds_read_b64_tr_b16 a[50:51], v14 offset:9216
    v_mfma_f32_16x16x32_bf16 v[92:95], a[4:7], a[68:71], v[92:95]
    ds_read_b64_tr_b16 a[52:53], v14 offset:8200
    buffer_load_dwordx4 v6, s[20:23], s61 offen offset:1024  lds
    v_mfma_f32_16x16x32_bf16 v[88:91], a[4:7], a[64:67], v[88:91]
    ds_read_b64_tr_b16 a[54:55], v14 offset:9224
    v_mfma_f32_16x16x32_bf16 v[112:115], a[8:11], a[64:67], v[112:115]
    ds_read_b64_tr_b16 a[56:57], v15 offset:8192
    buffer_load_dwordx4 v7, s[20:23], s61 offen offset:2048  lds
    v_mfma_f32_16x16x32_bf16 v[116:119], a[8:11], a[68:71], v[116:119]
    ds_read_b64_tr_b16 a[58:59], v15 offset:9216
    v_mfma_f32_16x16x32_bf16 v[120:123], a[8:11], a[72:75], v[120:123]
    ds_read_b64_tr_b16 a[60:61], v15 offset:8200
    buffer_load_dwordx4 v8, s[20:23], s61 offen offset:3072  lds
    s_add_u32 s73, s73, 524288
    s_and_b32 s73, s73, 0x3fffff
    v_mfma_f32_16x16x32_bf16 v[124:127], a[8:11], a[76:79], v[124:127]
    ds_read_b64_tr_b16 a[62:63], v15 offset:9224
    v_mfma_f32_16x16x32_bf16 v[128:131], a[8:11], a[80:83], v[128:131]
    ds_read_b128 a[88:91], v17 offset:0
    s_mov_b32 s64, 0
    s_add_u32 m0, s59, 0
    s_nop 0
    buffer_load_dwordx4 v32, s[12:15], s64 offen offset:0 nt lds
    v_mfma_f32_16x16x32_bf16 v[132:135], a[8:11], a[84:87], v[132:135]
    ds_read_b128 a[92:95], v17 offset:2048
    v_mfma_f32_16x16x32_bf16 v[156:159], a[12:15], a[84:87], v[156:159]
    ds_read_b128 a[96:99], v17 offset:4096
    buffer_load_dwordx4 v33, s[12:15], s64 offen offset:1024 nt lds
    v_mfma_f32_16x16x32_bf16 v[152:155], a[12:15], a[80:83], v[152:155]
    ds_read_b128 a[100:103], v17 offset:6144
    v_mfma_f32_16x16x32_bf16 v[148:151], a[12:15], a[76:79], v[148:151]
    ds_read_b128 a[104:107], v17 offset:8192
    buffer_load_dwordx4 v34, s[12:15], s64 offen offset:2048 nt lds
    v_mfma_f32_16x16x32_bf16 v[144:147], a[12:15], a[72:75], v[144:147]
    ds_read_b128 a[108:111], v17 offset:10240
    v_mfma_f32_16x16x32_bf16 v[140:143], a[12:15], a[68:71], v[140:143]
    buffer_load_dwordx4 v35, s[12:15], s64 offen offset:3072 nt lds
    v_mfma_f32_16x16x32_bf16 v[136:139], a[12:15], a[64:67], v[136:139]
    v_mfma_f32_16x16x32_bf16 v[160:163], a[16:19], a[64:67], v[160:163]
    s_mov_b32 s64, 4096
    s_add_u32 m0, s59, 4096
    s_nop 0
    buffer_load_dwordx4 v32, s[12:15], s64 offen offset:0 nt lds
    v_mfma_f32_16x16x32_bf16 v[164:167], a[16:19], a[68:71], v[164:167]
    v_mfma_f32_16x16x32_bf16 v[168:171], a[16:19], a[72:75], v[168:171]
    buffer_load_dwordx4 v33, s[12:15], s64 offen offset:1024 nt lds
    v_mfma_f32_16x16x32_bf16 v[172:175], a[16:19], a[76:79], v[172:175]
    v_mfma_f32_16x16x32_bf16 v[176:179], a[16:19], a[80:83], v[176:179]
    buffer_load_dwordx4 v34, s[12:15], s64 offen offset:2048 nt lds
    v_mfma_f32_16x16x32_bf16 v[180:183], a[16:19], a[84:87], v[180:183]
    v_mfma_f32_16x16x32_bf16 v[204:207], a[20:23], a[84:87], v[204:207]
    buffer_load_dwordx4 v35, s[12:15], s64 offen offset:3072 nt lds
    v_mfma_f32_16x16x32_bf16 v[200:203], a[20:23], a[80:83], v[200:203]
    v_mfma_f32_16x16x32_bf16 v[196:199], a[20:23], a[76:79], v[196:199]
    v_mfma_f32_16x16x32_bf16 v[192:195], a[20:23], a[72:75], v[192:195]
    v_mfma_f32_16x16x32_bf16 v[188:191], a[20:23], a[68:71], v[188:191]
    v_mfma_f32_16x16x32_bf16 v[184:187], a[20:23], a[64:67], v[184:187]
    v_mfma_f32_16x16x32_bf16 v[208:211], a[24:27], a[64:67], v[208:211]
    v_mfma_f32_16x16x32_bf16 v[212:215], a[24:27], a[68:71], v[212:215]
    v_mfma_f32_16x16x32_bf16 v[216:219], a[24:27], a[72:75], v[216:219]
    v_mfma_f32_16x16x32_bf16 v[220:223], a[24:27], a[76:79], v[220:223]
    v_mfma_f32_16x16x32_bf16 v[224:227], a[24:27], a[80:83], v[224:227]
    v_mfma_f32_16x16x32_bf16 v[228:231], a[24:27], a[84:87], v[228:231]
    v_mfma_f32_16x16x32_bf16 v[252:255], a[28:31], a[84:87], v[252:255]
    v_mfma_f32_16x16x32_bf16 v[248:251], a[28:31], a[80:83], v[248:251]
    v_mfma_f32_16x16x32_bf16 v[244:247], a[28:31], a[76:79], v[244:247]
    v_mfma_f32_16x16x32_bf16 v[240:243], a[28:31], a[72:75], v[240:243]
    v_mfma_f32_16x16x32_bf16 v[236:239], a[28:31], a[68:71], v[236:239]
    v_mfma_f32_16x16x32_bf16 v[232:235], a[28:31], a[64:67], v[232:235]
    s_waitcnt vmcnt(16) lgkmcnt(0)
    s_barrier
    v_mfma_f32_16x16x32_bf16 v[64:67], a[32:35], a[88:91], v[64:67]
    ds_read_b64_tr_b16 a[0:1], v12 offset:16384
    v_mfma_f32_16x16x32_bf16 v[68:71], a[32:35], a[92:95], v[68:71]
    ds_read_b64_tr_b16 a[2:3], v12 offset:17408
    v_mfma_f32_16x16x32_bf16 v[72:75], a[32:35], a[96:99], v[72:75]
    ds_read_b64_tr_b16 a[4:5], v12 offset:16392
    v_mfma_f32_16x16x32_bf16 v[76:79], a[32:35], a[100:103], v[76:79]
    ds_read_b64_tr_b16 a[6:7], v12 offset:17416
    v_mfma_f32_16x16x32_bf16 v[80:83], a[32:35], a[104:107], v[80:83]
    ds_read_b64_tr_b16 a[8:9], v13 offset:16384
    v_mfma_f32_16x16x32_bf16 v[84:87], a[32:35], a[108:111], v[84:87]
    ds_read_b64_tr_b16 a[10:11], v13 offset:17408
    v_mfma_f32_16x16x32_bf16 v[108:111], a[36:39], a[108:111], v[108:111]
    ds_read_b64_tr_b16 a[12:13], v13 offset:16392
    v_mfma_f32_16x16x32_bf16 v[104:107], a[36:39], a[104:107], v[104:107]
    ds_read_b64_tr_b16 a[14:15], v13 offset:17416
    v_mfma_f32_16x16x32_bf16 v[100:103], a[36:39], a[100:103], v[100:103]
    ds_read_b64_tr_b16 a[16:17], v14 offset:16384
    v_mfma_f32_16x16x32_bf16 v[96:99], a[36:39], a[96:99], v[96:99]
    ds_read_b64_tr_b16 a[18:19], v14 offset:17408
    v_mfma_f32_16x16x32_bf16 v[92:95], a[36:39], a[92:95], v[92:95]
    ds_read_b64_tr_b16 a[20:21], v14 offset:16392
    v_mfma_f32_16x16x32_bf16 v[88:91], a[36:39], a[88:91], v[88:91]
    ds_read_b64_tr_b16 a[22:23], v14 offset:17416
    v_mfma_f32_16x16x32_bf16 v[112:115], a[40:43], a[88:91], v[112:115]
    ds_read_b64_tr_b16 a[24:25], v15 offset:16384
    v_mfma_f32_16x16x32_bf16 v[116:119], a[40:43], a[92:95], v[116:119]
    ds_read_b64_tr_b16 a[26:27], v15 offset:17408
    v_mfma_f32_16x16x32_bf16 v[120:123], a[40:43], a[96:99], v[120:123]
    ds_read_b64_tr_b16 a[28:29], v15 offset:16392
    v_mfma_f32_16x16x32_bf16 v[124:127], a[40:43], a[100:103], v[124:127]
    ds_read_b64_tr_b16 a[30:31], v15 offset:17416
    v_mfma_f32_16x16x32_bf16 v[128:131], a[40:43], a[104:107], v[128:131]
    ds_read_b128 a[64:67], v16 offset:12288
    v_mfma_f32_16x16x32_bf16 v[132:135], a[40:43], a[108:111], v[132:135]
    ds_read_b128 a[68:71], v16 offset:14336
    v_mfma_f32_16x16x32_bf16 v[156:159], a[44:47], a[108:111], v[156:159]
    ds_read_b128 a[72:75], v16 offset:16384
    v_mfma_f32_16x16x32_bf16 v[152:155], a[44:47], a[104:107], v[152:155]
    ds_read_b128 a[76:79], v16 offset:18432
    v_mfma_f32_16x16x32_bf16 v[148:151], a[44:47], a[100:103], v[148:151]
    ds_read_b128 a[80:83], v16 offset:20480
    v_mfma_f32_16x16x32_bf16 v[144:147], a[44:47], a[96:99], v[144:147]
    ds_read_b128 a[84:87], v16 offset:22528
    v_mfma_f32_16x16x32_bf16 v[140:143], a[44:47], a[92:95], v[140:143]
    s_waitcnt vmcnt(0)
    ds_read_b128 a[112:115], v36 offset:0
    v_mfma_f32_16x16x32_bf16 v[136:139], a[44:47], a[88:91], v[136:139]
    ds_read_b128 a[116:119], v37 offset:0
    v_mfma_f32_16x16x32_bf16 v[160:163], a[48:51], a[88:91], v[160:163]
    ds_read_b128 a[120:123], v38 offset:0
    s_add_u32 m0, s66, 0
    s_nop 0
    buffer_load_dwordx4 v2, s[8:11], s62 offen offset:0  lds
    v_mfma_f32_16x16x32_bf16 v[164:167], a[48:51], a[92:95], v[164:167]
    ds_read_b128 a[124:127], v39 offset:0
    v_mfma_f32_16x16x32_bf16 v[168:171], a[48:51], a[96:99], v[168:171]
    ds_read_b128 a[128:131], v36 offset:4096
    buffer_load_dwordx4 v3, s[8:11], s62 offen offset:1024  lds
    v_mfma_f32_16x16x32_bf16 v[172:175], a[48:51], a[100:103], v[172:175]
    ds_read_b128 a[132:135], v37 offset:4096
    v_mfma_f32_16x16x32_bf16 v[176:179], a[48:51], a[104:107], v[176:179]
    ds_read_b128 a[136:139], v38 offset:4096
    buffer_load_dwordx4 v4, s[8:11], s62 offen offset:2048  lds
    s_add_u32 s62, s62, 128
    s_and_b32 s62, s62, 1023
    v_mfma_f32_16x16x32_bf16 v[180:183], a[48:51], a[108:111], v[180:183]
    ds_read_b128 a[140:143], v39 offset:4096
    v_mfma_f32_16x16x32_bf16 v[204:207], a[52:55], a[108:111], v[204:207]
    v_mfma_f32_16x16x32_bf16 v[200:203], a[52:55], a[104:107], v[200:203]
    v_mfma_f32_16x16x32_bf16 v[196:199], a[52:55], a[100:103], v[196:199]
    v_mfma_f32_16x16x32_bf16 v[192:195], a[52:55], a[96:99], v[192:195]
    s_waitcnt lgkmcnt(0)
    v_mfma_f32_16x16x32_bf16 v[188:191], a[52:55], a[92:95], v[188:191]
    s_add_u32 s60, s73, s75
    s_or_b32 s61, s60, 131072
    s_add_u32 m0, s59, 0
    s_nop 0
    buffer_load_dwordx4 v5, s[20:23], s60 offen offset:0  lds
    v_mfma_f32_16x16x32_bf16 v[184:187], a[52:55], a[88:91], v[184:187]
    buffer_load_dwordx4 v6, s[20:23], s60 offen offset:1024  lds
    v_mfma_f32_16x16x32_bf16 v[208:211], a[56:59], a[88:91], v[208:211]
    v_mfma_f32_16x16x32_bf16 v[212:215], a[56:59], a[92:95], v[212:215]
    buffer_load_dwordx4 v7, s[20:23], s60 offen offset:2048  lds
    v_mfma_f32_16x16x32_bf16 v[216:219], a[56:59], a[96:99], v[216:219]
    v_mfma_f32_16x16x32_bf16 v[220:223], a[56:59], a[100:103], v[220:223]
    buffer_load_dwordx4 v8, s[20:23], s60 offen offset:3072  lds
    v_mfma_f32_16x16x32_bf16 v[224:227], a[56:59], a[104:107], v[224:227]
    s_add_u32 m0, s59, 4096
    v_mfma_f32_16x16x32_bf16 v[228:231], a[56:59], a[108:111], v[228:231]
    buffer_load_dwordx4 v5, s[20:23], s61 offen offset:0  lds
    v_mfma_f32_16x16x32_bf16 v[252:255], a[60:63], a[108:111], v[252:255]
    v_mfma_f32_16x16x32_bf16 v[248:251], a[60:63], a[104:107], v[248:251]
    buffer_load_dwordx4 v6, s[20:23], s61 offen offset:1024  lds
    v_mfma_f32_16x16x32_bf16 v[244:247], a[60:63], a[100:103], v[244:247]
    v_mfma_f32_16x16x32_bf16 v[240:243], a[60:63], a[96:99], v[240:243]
    buffer_load_dwordx4 v7, s[20:23], s61 offen offset:2048  lds
    v_mfma_f32_16x16x32_bf16 v[236:239], a[60:63], a[92:95], v[236:239]
    v_mfma_f32_16x16x32_bf16 v[232:235], a[60:63], a[88:91], v[232:235]
    buffer_load_dwordx4 v8, s[20:23], s61 offen offset:3072  lds
    v_mfma_f32_16x16x32_bf16 v[64:67], a[0:3], a[64:67], v[64:67]
    ds_read_b64_tr_b16 a[32:33], v12 offset:24576
    v_mfma_f32_16x16x32_bf16 v[68:71], a[0:3], a[68:71], v[68:71]
    ds_read_b64_tr_b16 a[34:35], v12 offset:25600
    v_mfma_f32_16x16x32_bf16 v[72:75], a[0:3], a[72:75], v[72:75]
    ds_read_b64_tr_b16 a[36:37], v12 offset:24584
    s_add_u32 s60, s73, s100
    s_or_b32 s61, s60, 131072
    s_add_u32 m0, s59, 8192
    s_nop 0
    buffer_load_dwordx4 v5, s[20:23], s60 offen offset:0  lds
    v_mfma_f32_16x16x32_bf16 v[76:79], a[0:3], a[76:79], v[76:79]
    ds_read_b64_tr_b16 a[38:39], v12 offset:25608
    v_mfma_f32_16x16x32_bf16 v[80:83], a[0:3], a[80:83], v[80:83]
    ds_read_b64_tr_b16 a[40:41], v13 offset:24576
    v_mfma_f32_16x16x32_bf16 v[84:87], a[0:3], a[84:87], v[84:87]
    ds_read_b64_tr_b16 a[42:43], v13 offset:25600
    v_mfma_f32_16x16x32_bf16 v[108:111], a[4:7], a[84:87], v[108:111]
    ds_read_b64_tr_b16 a[44:45], v13 offset:24584
    v_mfma_f32_16x16x32_bf16 v[104:107], a[4:7], a[80:83], v[104:107]
    ds_read_b64_tr_b16 a[46:47], v13 offset:25608
    v_mfma_f32_16x16x32_bf16 v[100:103], a[4:7], a[76:79], v[100:103]
    ds_read_b64_tr_b16 a[48:49], v14 offset:24576
    buffer_load_dwordx4 v6, s[20:23], s60 offen offset:1024  lds
    v_mfma_f32_16x16x32_bf16 v[96:99], a[4:7], a[72:75], v[96:99]
    ds_read_b64_tr_b16 a[50:51], v14 offset:25600
    v_mfma_f32_16x16x32_bf16 v[92:95], a[4:7], a[68:71], v[92:95]
    ds_read_b64_tr_b16 a[52:53], v14 offset:24584
    v_mfma_f32_16x16x32_bf16 v[88:91], a[4:7], a[64:67], v[88:91]
    ds_read_b64_tr_b16 a[54:55], v14 offset:25608
    v_mfma_f32_16x16x32_bf16 v[112:115], a[8:11], a[64:67], v[112:115]
    ds_read_b64_tr_b16 a[56:57], v15 offset:24576
    v_mfma_f32_16x16x32_bf16 v[116:119], a[8:11], a[68:71], v[116:119]
    ds_read_b64_tr_b16 a[58:59], v15 offset:25600
    v_mfma_f32_16x16x32_bf16 v[120:123], a[8:11], a[72:75], v[120:123]
    ds_read_b64_tr_b16 a[60:61], v15 offset:24584
    buffer_load_dwordx4 v7, s[20:23], s60 offen offset:2048  lds
    v_mfma_f32_16x16x32_bf16 v[124:127], a[8:11], a[76:79], v[124:127]
    ds_read_b64_tr_b16 a[62:63], v15 offset:25608
    v_mfma_f32_16x16x32_bf16 v[128:131], a[8:11], a[80:83], v[128:131]
    ds_read_b128 a[88:91], v17 offset:12288
    v_mfma_f32_16x16x32_bf16 v[132:135], a[8:11], a[84:87], v[132:135]
    ds_read_b128 a[92:95], v17 offset:14336
    v_mfma_f32_16x16x32_bf16 v[156:159], a[12:15], a[84:87], v[156:159]
    ds_read_b128 a[96:99], v17 offset:16384
    v_mfma_f32_16x16x32_bf16 v[152:155], a[12:15], a[80:83], v[152:155]
    ds_read_b128 a[100:103], v17 offset:18432
    v_mfma_f32_16x16x32_bf16 v[148:151], a[12:15], a[76:79], v[148:151]
    ds_read_b128 a[104:107], v17 offset:20480
    buffer_load_dwordx4 v8, s[20:23], s60 offen offset:3072  lds
    v_mfma_f32_16x16x32_bf16 v[144:147], a[12:15], a[72:75], v[144:147]
    ds_read_b128 a[108:111], v17 offset:22528
    v_mfma_f32_16x16x32_bf16 v[140:143], a[12:15], a[68:71], v[140:143]
    v_mfma_f32_16x16x32_bf16 v[136:139], a[12:15], a[64:67], v[136:139]
    v_mfma_f32_16x16x32_bf16 v[160:163], a[16:19], a[64:67], v[160:163]
    v_mfma_f32_16x16x32_bf16 v[164:167], a[16:19], a[68:71], v[164:167]
    v_mfma_f32_16x16x32_bf16 v[168:171], a[16:19], a[72:75], v[168:171]
    s_add_u32 m0, s59, 12288
    v_mfma_f32_16x16x32_bf16 v[172:175], a[16:19], a[76:79], v[172:175]
    buffer_load_dwordx4 v5, s[20:23], s61 offen offset:0  lds
    v_mfma_f32_16x16x32_bf16 v[176:179], a[16:19], a[80:83], v[176:179]
    v_mfma_f32_16x16x32_bf16 v[180:183], a[16:19], a[84:87], v[180:183]
    v_mfma_f32_16x16x32_bf16 v[204:207], a[20:23], a[84:87], v[204:207]
    v_mfma_f32_16x16x32_bf16 v[200:203], a[20:23], a[80:83], v[200:203]
    v_mfma_f32_16x16x32_bf16 v[196:199], a[20:23], a[76:79], v[196:199]
    v_mfma_f32_16x16x32_bf16 v[192:195], a[20:23], a[72:75], v[192:195]
    buffer_load_dwordx4 v6, s[20:23], s61 offen offset:1024  lds
    v_mfma_f32_16x16x32_bf16 v[188:191], a[20:23], a[68:71], v[188:191]
    v_mfma_f32_16x16x32_bf16 v[184:187], a[20:23], a[64:67], v[184:187]
    v_mfma_f32_16x16x32_bf16 v[208:211], a[24:27], a[64:67], v[208:211]
    v_mfma_f32_16x16x32_bf16 v[212:215], a[24:27], a[68:71], v[212:215]
    v_mfma_f32_16x16x32_bf16 v[216:219], a[24:27], a[72:75], v[216:219]
    v_mfma_f32_16x16x32_bf16 v[220:223], a[24:27], a[76:79], v[220:223]
    buffer_load_dwordx4 v7, s[20:23], s61 offen offset:2048  lds
    v_mfma_f32_16x16x32_bf16 v[224:227], a[24:27], a[80:83], v[224:227]
    v_mfma_f32_16x16x32_bf16 v[228:231], a[24:27], a[84:87], v[228:231]
    v_mfma_f32_16x16x32_bf16 v[252:255], a[28:31], a[84:87], v[252:255]
    v_mfma_f32_16x16x32_bf16 v[248:251], a[28:31], a[80:83], v[248:251]
    v_mfma_f32_16x16x32_bf16 v[244:247], a[28:31], a[76:79], v[244:247]
    v_mfma_f32_16x16x32_bf16 v[240:243], a[28:31], a[72:75], v[240:243]
    v_mfma_f32_16x16x32_bf16 v[236:239], a[28:31], a[68:71], v[236:239]
    buffer_load_dwordx4 v8, s[20:23], s61 offen offset:3072  lds
    s_add_u32 s73, s73, 524288
    s_and_b32 s73, s73, 0x3fffff
    v_mfma_f32_16x16x32_bf16 v[232:235], a[28:31], a[64:67], v[232:235]
    s_waitcnt vmcnt(16) lgkmcnt(0)
    s_barrier
    s_waitcnt vmcnt(8)
    v_mfma_f32_16x16x32_bf16 v[64:67], a[32:35], a[88:91], v[64:67]
    ds_read_b64_tr_b16 a[0:1], v12 offset:0
    s_add_u32 s60, s73, s75
    s_or_b32 s61, s60, 131072
    s_add_u32 m0, s59, 16384
    s_nop 0
    buffer_load_dwordx4 v5, s[20:23], s60 offen offset:0  lds
    v_mfma_f32_16x16x32_bf16 v[68:71], a[32:35], a[92:95], v[68:71]
    ds_read_b64_tr_b16 a[2:3], v12 offset:1024
    v_mfma_f32_16x16x32_bf16 v[72:75], a[32:35], a[96:99], v[72:75]
    ds_read_b64_tr_b16 a[4:5], v12 offset:8
    buffer_load_dwordx4 v6, s[20:23], s60 offen offset:1024  lds
    v_mfma_f32_16x16x32_bf16 v[76:79], a[32:35], a[100:103], v[76:79]
    ds_read_b64_tr_b16 a[6:7], v12 offset:1032
    v_mfma_f32_16x16x32_bf16 v[80:83], a[32:35], a[104:107], v[80:83]
    ds_read_b64_tr_b16 a[8:9], v13 offset:0
    buffer_load_dwordx4 v7, s[20:23], s60 offen offset:2048  lds
    v_mfma_f32_16x16x32_bf16 v[84:87], a[32:35], a[108:111], v[84:87]
    ds_read_b64_tr_b16 a[10:11], v13 offset:1024
    v_mfma_f32_16x16x32_bf16 v[108:111], a[36:39], a[108:111], v[108:111]
    ds_read_b64_tr_b16 a[12:13], v13 offset:8
    buffer_load_dwordx4 v8, s[20:23], s60 offen offset:3072  lds
    v_mfma_f32_16x16x32_bf16 v[104:107], a[36:39], a[104:107], v[104:107]
    ds_read_b64_tr_b16 a[14:15], v13 offset:1032
    v_mfma_f32_16x16x32_bf16 v[100:103], a[36:39], a[100:103], v[100:103]
    ds_read_b64_tr_b16 a[16:17], v14 offset:0
    s_add_u32 m0, s59, 20480
    s_nop 0
    buffer_load_dwordx4 v5, s[20:23], s61 offen offset:0  lds
    v_mfma_f32_16x16x32_bf16 v[96:99], a[36:39], a[96:99], v[96:99]
    ds_read_b64_tr_b16 a[18:19], v14 offset:1024
    v_mfma_f32_16x16x32_bf16 v[92:95], a[36:39], a[92:95], v[92:95]
    ds_read_b64_tr_b16 a[20:21], v14 offset:8
    buffer_load_dwordx4 v6, s[20:23], s61 offen offset:1024  lds
    v_mfma_f32_16x16x32_bf16 v[88:91], a[36:39], a[88:91], v[88:91]
    ds_read_b64_tr_b16 a[22:23], v14 offset:1032
    v_mfma_f32_16x16x32_bf16 v[112:115], a[40:43], a[88:91], v[112:115]
    ds_read_b64_tr_b16 a[24:25], v15 offset:0
    buffer_load_dwordx4 v7, s[20:23], s61 offen offset:2048  lds
    v_mfma_f32_16x16x32_bf16 v[116:119], a[40:43], a[92:95], v[116:119]
    ds_read_b64_tr_b16 a[26:27], v15 offset:1024
    v_mfma_f32_16x16x32_bf16 v[120:123], a[40:43], a[96:99], v[120:123]
    ds_read_b64_tr_b16 a[28:29], v15 offset:8
    buffer_load_dwordx4 v8, s[20:23], s61 offen offset:3072  lds
    v_mfma_f32_16x16x32_bf16 v[124:127], a[40:43], a[100:103], v[124:127]
    ds_read_b64_tr_b16 a[30:31], v15 offset:1032
    v_mfma_f32_16x16x32_bf16 v[128:131], a[40:43], a[104:107], v[128:131]
    ds_read_b128 a[64:67], v16 offset:0
    s_mov_b32 s64, 8192
    s_add_u32 m0, s59, 24576
    s_nop 0
    buffer_load_dwordx4 v32, s[12:15], s64 offen offset:0 nt lds
    v_mfma_f32_16x16x32_bf16 v[132:135], a[40:43], a[108:111], v[132:135]
    ds_read_b128 a[68:71], v16 offset:2048
    v_mfma_f32_16x16x32_bf16 v[156:159], a[44:47], a[108:111], v[156:159]
    ds_read_b128 a[72:75], v16 offset:4096
    buffer_load_dwordx4 v33, s[12:15], s64 offen offset:1024 nt lds
    v_mfma_f32_16x16x32_bf16 v[152:155], a[44:47], a[104:107], v[152:155]
    ds_read_b128 a[76:79], v16 offset:6144
    v_mfma_f32_16x16x32_bf16 v[148:151], a[44:47], a[100:103], v[148:151]
    ds_read_b128 a[80:83], v16 offset:8192
    buffer_load_dwordx4 v34, s[12:15], s64 offen offset:2048 nt lds
    v_mfma_f32_16x16x32_bf16 v[144:147], a[44:47], a[96:99], v[144:147]
    ds_read_b128 a[84:87], v16 offset:10240
    v_mfma_f32_16x16x32_bf16 v[140:143], a[44:47], a[92:95], v[140:143]
    buffer_load_dwordx4 v35, s[12:15], s64 offen offset:3072 nt lds
    v_mfma_f32_16x16x32_bf16 v[136:139], a[44:47], a[88:91], v[136:139]
    v_mfma_f32_16x16x32_bf16 v[160:163], a[48:51], a[88:91], v[160:163]
    s_mov_b32 s64, 12288
    s_add_u32 m0, s59, 28672
    s_nop 0
    buffer_load_dwordx4 v32, s[12:15], s64 offen offset:0 nt lds
    v_mfma_f32_16x16x32_bf16 v[164:167], a[48:51], a[92:95], v[164:167]
    v_mfma_f32_16x16x32_bf16 v[168:171], a[48:51], a[96:99], v[168:171]
    buffer_load_dwordx4 v33, s[12:15], s64 offen offset:1024 nt lds
    v_mfma_f32_16x16x32_bf16 v[172:175], a[48:51], a[100:103], v[172:175]
    v_mfma_f32_16x16x32_bf16 v[176:179], a[48:51], a[104:107], v[176:179]
    buffer_load_dwordx4 v34, s[12:15], s64 offen offset:2048 nt lds
    v_mfma_f32_16x16x32_bf16 v[180:183], a[48:51], a[108:111], v[180:183]
    v_mfma_f32_16x16x32_bf16 v[204:207], a[52:55], a[108:111], v[204:207]
    buffer_load_dwordx4 v35, s[12:15], s64 offen offset:3072 nt lds
    v_mfma_f32_16x16x32_bf16 v[200:203], a[52:55], a[104:107], v[200:203]
    v_mfma_f32_16x16x32_bf16 v[196:199], a[52:55], a[100:103], v[196:199]
    v_mfma_f32_16x16x32_bf16 v[192:195], a[52:55], a[96:99], v[192:195]
    v_mfma_f32_16x16x32_bf16 v[188:191], a[52:55], a[92:95], v[188:191]
    v_mfma_f32_16x16x32_bf16 v[184:187], a[52:55], a[88:91], v[184:187]
    v_mfma_f32_16x16x32_bf16 v[208:211], a[56:59], a[88:91], v[208:211]
    v_mfma_f32_16x16x32_bf16 v[212:215], a[56:59], a[92:95], v[212:215]
    v_mfma_f32_16x16x32_bf16 v[216:219], a[56:59], a[96:99], v[216:219]
    v_mfma_f32_16x16x32_bf16 v[220:223], a[56:59], a[100:103], v[220:223]
    v_mfma_f32_16x16x32_bf16 v[224:227], a[56:59], a[104:107], v[224:227]
    v_mfma_f32_16x16x32_bf16 v[228:231], a[56:59], a[108:111], v[228:231]
    s_add_u32 m0, s66, 12288
    v_mfma_f32_16x16x32_bf16 v[252:255], a[60:63], a[108:111], v[252:255]
    buffer_load_dwordx4 v2, s[8:11], s62 offen offset:0  lds
    v_mfma_f32_16x16x32_bf16 v[248:251], a[60:63], a[104:107], v[248:251]
    v_mfma_f32_16x16x32_bf16 v[244:247], a[60:63], a[100:103], v[244:247]
    buffer_load_dwordx4 v3, s[8:11], s62 offen offset:1024  lds
    v_mfma_f32_16x16x32_bf16 v[240:243], a[60:63], a[96:99], v[240:243]
    v_mfma_f32_16x16x32_bf16 v[236:239], a[60:63], a[92:95], v[236:239]
    buffer_load_dwordx4 v4, s[8:11], s62 offen offset:2048  lds
    s_add_u32 s62, s62, 128
    s_and_b32 s62, s62, 1023
    v_mfma_f32_16x16x32_bf16 v[232:235], a[60:63], a[88:91], v[232:235]
    s_waitcnt lgkmcnt(0)
    s_waitcnt vmcnt(19)
    v_mfma_f32_16x16x32_bf16 v[64:67], a[0:3], a[64:67], v[64:67]
    ds_read_b64_tr_b16 a[32:33], v12 offset:8192
    v_mfma_f32_16x16x32_bf16 v[68:71], a[0:3], a[68:71], v[68:71]
    ds_read_b64_tr_b16 a[34:35], v12 offset:9216
    v_mfma_f32_16x16x32_bf16 v[72:75], a[0:3], a[72:75], v[72:75]
    ds_read_b64_tr_b16 a[36:37], v12 offset:8200
    v_mfma_f32_16x16x32_bf16 v[76:79], a[0:3], a[76:79], v[76:79]
    ds_read_b64_tr_b16 a[38:39], v12 offset:9224
    v_mfma_f32_16x16x32_bf16 v[80:83], a[0:3], a[80:83], v[80:83]
    ds_read_b64_tr_b16 a[40:41], v13 offset:8192
    v_mfma_f32_16x16x32_bf16 v[84:87], a[0:3], a[84:87], v[84:87]
    ds_read_b64_tr_b16 a[42:43], v13 offset:9216
    v_mfma_f32_16x16x32_bf16 v[108:111], a[4:7], a[84:87], v[108:111]
    ds_read_b64_tr_b16 a[44:45], v13 offset:8200
    v_mfma_f32_16x16x32_bf16 v[104:107], a[4:7], a[80:83], v[104:107]
    ds_read_b64_tr_b16 a[46:47], v13 offset:9224
    v_mfma_f32_16x16x32_bf16 v[100:103], a[4:7], a[76:79], v[100:103]
    ds_read_b64_tr_b16 a[48:49], v14 offset:8192
    v_mfma_f32_16x16x32_bf16 v[96:99], a[4:7], a[72:75], v[96:99]
    ds_read_b64_tr_b16 a[50:51], v14 offset:9216
    v_mfma_f32_16x16x32_bf16 v[92:95], a[4:7], a[68:71], v[92:95]
    ds_read_b64_tr_b16 a[52:53], v14 offset:8200
    v_mfma_f32_16x16x32_bf16 v[88:91], a[4:7], a[64:67], v[88:91]
    ds_read_b64_tr_b16 a[54:55], v14 offset:9224
    v_mfma_f32_16x16x32_bf16 v[112:115], a[8:11], a[64:67], v[112:115]
    ds_read_b64_tr_b16 a[56:57], v15 offset:8192
    v_mfma_f32_16x16x32_bf16 v[116:119], a[8:11], a[68:71], v[116:119]
    ds_read_b64_tr_b16 a[58:59], v15 offset:9216
    v_mfma_f32_16x16x32_bf16 v[120:123], a[8:11], a[72:75], v[120:123]
    ds_read_b64_tr_b16 a[60:61], v15 offset:8200
    v_mfma_f32_16x16x32_bf16 v[124:127], a[8:11], a[76:79], v[124:127]
    ds_read_b64_tr_b16 a[62:63], v15 offset:9224
    v_mfma_f32_16x16x32_bf16 v[128:131], a[8:11], a[80:83], v[128:131]
    ds_read_b128 a[88:91], v17 offset:0
    v_mfma_f32_16x16x32_bf16 v[132:135], a[8:11], a[84:87], v[132:135]
    ds_read_b128 a[92:95], v17 offset:2048
    v_mfma_f32_16x16x32_bf16 v[156:159], a[12:15], a[84:87], v[156:159]
    ds_read_b128 a[96:99], v17 offset:4096
    v_mfma_f32_16x16x32_bf16 v[152:155], a[12:15], a[80:83], v[152:155]
    ds_read_b128 a[100:103], v17 offset:6144
    v_mfma_f32_16x16x32_bf16 v[148:151], a[12:15], a[76:79], v[148:151]
    ds_read_b128 a[104:107], v17 offset:8192
    v_mfma_f32_16x16x32_bf16 v[144:147], a[12:15], a[72:75], v[144:147]
    ds_read_b128 a[108:111], v17 offset:10240
    v_mfma_f32_16x16x32_bf16 v[140:143], a[12:15], a[68:71], v[140:143]
    s_waitcnt vmcnt(3)
    ds_read_b128 a[144:147], v36 offset:24576
    v_mfma_f32_16x16x32_bf16 v[136:139], a[12:15], a[64:67], v[136:139]
    ds_read_b128 a[148:151], v37 offset:24576
    v_mfma_f32_16x16x32_bf16 v[160:163], a[16:19], a[64:67], v[160:163]
    ds_read_b128 a[152:155], v38 offset:24576
    v_mfma_f32_16x16x32_bf16 v[164:167], a[16:19], a[68:71], v[164:167]
    ds_read_b128 a[156:159], v39 offset:24576
    v_mfma_f32_16x16x32_bf16 v[168:171], a[16:19], a[72:75], v[168:171]
    ds_read_b128 a[160:163], v36 offset:28672
    v_mfma_f32_16x16x32_bf16 v[172:175], a[16:19], a[76:79], v[172:175]
    ds_read_b128 a[164:167], v37 offset:28672
    v_mfma_f32_16x16x32_bf16 v[176:179], a[16:19], a[80:83], v[176:179]
    ds_read_b128 a[168:171], v38 offset:28672
    v_mfma_f32_16x16x32_bf16 v[180:183], a[16:19], a[84:87], v[180:183]
    ds_read_b128 a[172:175], v39 offset:28672
    v_mfma_f32_16x16x32_bf16 v[204:207], a[20:23], a[84:87], v[204:207]
    v_mfma_f32_16x16x32_bf16 v[200:203], a[20:23], a[80:83], v[200:203]
    v_mfma_f32_16x16x32_bf16 v[196:199], a[20:23], a[76:79], v[196:199]
    v_mfma_f32_16x16x32_bf16 v[192:195], a[20:23], a[72:75], v[192:195]
    s_waitcnt lgkmcnt(0)
    v_mfma_f32_16x16x32_bf16 v[188:191], a[20:23], a[68:71], v[188:191]
    s_add_u32 s60, s73, s100
    s_or_b32 s61, s60, 131072
    s_add_u32 m0, s59, 24576
    s_nop 0
    buffer_load_dwordx4 v5, s[20:23], s60 offen offset:0  lds
    v_mfma_f32_16x16x32_bf16 v[184:187], a[20:23], a[64:67], v[184:187]
    buffer_load_dwordx4 v6, s[20:23], s60 offen offset:1024  lds
    v_mfma_f32_16x16x32_bf16 v[208:211], a[24:27], a[64:67], v[208:211]
    v_mfma_f32_16x16x32_bf16 v[212:215], a[24:27], a[68:71], v[212:215]
    buffer_load_dwordx4 v7, s[20:23], s60 offen offset:2048  lds
    v_mfma_f32_16x16x32_bf16 v[216:219], a[24:27], a[72:75], v[216:219]
    v_mfma_f32_16x16x32_bf16 v[220:223], a[24:27], a[76:79], v[220:223]
    buffer_load_dwordx4 v8, s[20:23], s60 offen offset:3072  lds
    v_mfma_f32_16x16x32_bf16 v[224:227], a[24:27], a[80:83], v[224:227]
    s_add_u32 m0, s59, 28672
    v_mfma_f32_16x16x32_bf16 v[228:231], a[24:27], a[84:87], v[228:231]
    buffer_load_dwordx4 v5, s[20:23], s61 offen offset:0  lds
    v_mfma_f32_16x16x32_bf16 v[252:255], a[28:31], a[84:87], v[252:255]
    v_mfma_f32_16x16x32_bf16 v[248:251], a[28:31], a[80:83], v[248:251]
    buffer_load_dwordx4 v6, s[20:23], s61 offen offset:1024  lds
    v_mfma_f32_16x16x32_bf16 v[244:247], a[28:31], a[76:79], v[244:247]
    v_mfma_f32_16x16x32_bf16 v[240:243], a[28:31], a[72:75], v[240:243]
    buffer_load_dwordx4 v7, s[20:23], s61 offen offset:2048  lds
    v_mfma_f32_16x16x32_bf16 v[236:239], a[28:31], a[68:71], v[236:239]
    v_mfma_f32_16x16x32_bf16 v[232:235], a[28:31], a[64:67], v[232:235]
    buffer_load_dwordx4 v8, s[20:23], s61 offen offset:3072  lds
    s_add_u32 s73, s73, 524288
    s_and_b32 s73, s73, 0x3fffff
    s_waitcnt vmcnt(8)
    s_barrier
    v_mfma_f32_16x16x32_bf16 v[64:67], a[32:35], a[88:91], v[64:67]
    ds_read_b64_tr_b16 a[0:1], v12 offset:16384
    v_mfma_f32_16x16x32_bf16 v[68:71], a[32:35], a[92:95], v[68:71]
    ds_read_b64_tr_b16 a[2:3], v12 offset:17408
    v_mfma_f32_16x16x32_bf16 v[72:75], a[32:35], a[96:99], v[72:75]
    ds_read_b64_tr_b16 a[4:5], v12 offset:16392
    s_add_u32 s60, s73, s75
    s_or_b32 s61, s60, 131072
    s_add_u32 m0, s59, 0
    s_nop 0
    buffer_load_dwordx4 v5, s[20:23], s60 offen offset:0  lds
    v_mfma_f32_16x16x32_bf16 v[76:79], a[32:35], a[100:103], v[76:79]
    ds_read_b64_tr_b16 a[6:7], v12 offset:17416
    v_mfma_f32_16x16x32_bf16 v[80:83], a[32:35], a[104:107], v[80:83]
    ds_read_b64_tr_b16 a[8:9], v13 offset:16384
    v_mfma_f32_16x16x32_bf16 v[84:87], a[32:35], a[108:111], v[84:87]
    ds_read_b64_tr_b16 a[10:11], v13 offset:17408
    v_mfma_f32_16x16x32_bf16 v[108:111], a[36:39], a[108:111], v[108:111]
    ds_read_b64_tr_b16 a[12:13], v13 offset:16392
    v_mfma_f32_16x16x32_bf16 v[104:107], a[36:39], a[104:107], v[104:107]
    ds_read_b64_tr_b16 a[14:15], v13 offset:17416
    buffer_load_dwordx4 v6, s[20:23], s60 offen offset:1024  lds
    v_mfma_f32_16x16x32_bf16 v[100:103], a[36:39], a[100:103], v[100:103]
    ds_read_b64_tr_b16 a[16:17], v14 offset:16384
    v_mfma_f32_16x16x32_bf16 v[96:99], a[36:39], a[96:99], v[96:99]
    ds_read_b64_tr_b16 a[18:19], v14 offset:17408
    v_mfma_f32_16x16x32_bf16 v[92:95], a[36:39], a[92:95], v[92:95]
    ds_read_b64_tr_b16 a[20:21], v14 offset:16392
    v_mfma_f32_16x16x32_bf16 v[88:91], a[36:39], a[88:91], v[88:91]
    ds_read_b64_tr_b16 a[22:23], v14 offset:17416
    v_mfma_f32_16x16x32_bf16 v[112:115], a[40:43], a[88:91], v[112:115]
    ds_read_b64_tr_b16 a[24:25], v15 offset:16384
    buffer_load_dwordx4 v7, s[20:23], s60 offen offset:2048  lds
    v_mfma_f32_16x16x32_bf16 v[116:119], a[40:43], a[92:95], v[116:119]
    ds_read_b64_tr_b16 a[26:27], v15 offset:17408
    v_mfma_f32_16x16x32_bf16 v[120:123], a[40:43], a[96:99], v[120:123]
    ds_read_b64_tr_b16 a[28:29], v15 offset:16392
    v_mfma_f32_16x16x32_bf16 v[124:127], a[40:43], a[100:103], v[124:127]
    ds_read_b64_tr_b16 a[30:31], v15 offset:17416
    v_mfma_f32_16x16x32_bf16 v[128:131], a[40:43], a[104:107], v[128:131]
    ds_read_b128 a[64:67], v16 offset:12288
    v_mfma_f32_16x16x32_bf16 v[132:135], a[40:43], a[108:111], v[132:135]
    ds_read_b128 a[68:71], v16 offset:14336
    v_mfma_f32_16x16x32_bf16 v[156:159], a[44:47], a[108:111], v[156:159]
    ds_read_b128 a[72:75], v16 offset:16384
    buffer_load_dwordx4 v8, s[20:23], s60 offen offset:3072  lds
    v_mfma_f32_16x16x32_bf16 v[152:155], a[44:47], a[104:107], v[152:155]
    ds_read_b128 a[76:79], v16 offset:18432
    v_mfma_f32_16x16x32_bf16 v[148:151], a[44:47], a[100:103], v[148:151]
    ds_read_b128 a[80:83], v16 offset:20480
    v_mfma_f32_16x16x32_bf16 v[144:147], a[44:47], a[96:99], v[144:147]
    ds_read_b128 a[84:87], v16 offset:22528
    v_mfma_f32_16x16x32_bf16 v[140:143], a[44:47], a[92:95], v[140:143]
    s_add_u32 m0, s59, 4096
    v_mfma_f32_16x16x32_bf16 v[136:139], a[44:47], a[88:91], v[136:139]
    buffer_load_dwordx4 v5, s[20:23], s61 offen offset:0  lds
    v_mfma_f32_16x16x32_bf16 v[160:163], a[48:51], a[88:91], v[160:163]
    v_mfma_f32_16x16x32_bf16 v[164:167], a[48:51], a[92:95], v[164:167]
    v_mfma_f32_16x16x32_bf16 v[168:171], a[48:51], a[96:99], v[168:171]
    v_mfma_f32_16x16x32_bf16 v[172:175], a[48:51], a[100:103], v[172:175]
    v_mfma_f32_16x16x32_bf16 v[176:179], a[48:51], a[104:107], v[176:179]
    v_mfma_f32_16x16x32_bf16 v[180:183], a[48:51], a[108:111], v[180:183]
    buffer_load_dwordx4 v6, s[20:23], s61 offen offset:1024  lds
    v_mfma_f32_16x16x32_bf16 v[204:207], a[52:55], a[108:111], v[204:207]
    v_mfma_f32_16x16x32_bf16 v[200:203], a[52:55], a[104:107], v[200:203]
    v_mfma_f32_16x16x32_bf16 v[196:199], a[52:55], a[100:103], v[196:199]
    v_mfma_f32_16x16x32_bf16 v[192:195], a[52:55], a[96:99], v[192:195]
    v_mfma_f32_16x16x32_bf16 v[188:191], a[52:55], a[92:95], v[188:191]
    buffer_load_dwordx4 v7, s[20:23], s61 offen offset:2048  lds
    v_mfma_f32_16x16x32_bf16 v[184:187], a[52:55], a[88:91], v[184:187]
    v_mfma_f32_16x16x32_bf16 v[208:211], a[56:59], a[88:91], v[208:211]
    v_mfma_f32_16x16x32_bf16 v[212:215], a[56:59], a[92:95], v[212:215]
    v_mfma_f32_16x16x32_bf16 v[216:219], a[56:59], a[96:99], v[216:219]
    v_mfma_f32_16x16x32_bf16 v[220:223], a[56:59], a[100:103], v[220:223]
    v_mfma_f32_16x16x32_bf16 v[224:227], a[56:59], a[104:107], v[224:227]
    buffer_load_dwordx4 v8, s[20:23], s61 offen offset:3072  lds
    v_mfma_f32_16x16x32_bf16 v[228:231], a[56:59], a[108:111], v[228:231]
    s_add_u32 m0, s66, 0
    v_mfma_f32_16x16x32_bf16 v[252:255], a[60:63], a[108:111], v[252:255]
    buffer_load_dwordx4 v2, s[8:11], s62 offen offset:0  lds
    v_mfma_f32_16x16x32_bf16 v[248:251], a[60:63], a[104:107], v[248:251]
    v_mfma_f32_16x16x32_bf16 v[244:247], a[60:63], a[100:103], v[244:247]
    buffer_load_dwordx4 v3, s[8:11], s62 offen offset:1024  lds
    v_mfma_f32_16x16x32_bf16 v[240:243], a[60:63], a[96:99], v[240:243]
    v_mfma_f32_16x16x32_bf16 v[236:239], a[60:63], a[92:95], v[236:239]
    buffer_load_dwordx4 v4, s[8:11], s62 offen offset:2048  lds
    s_add_u32 s62, s62, 128
    s_and_b32 s62, s62, 1023
    v_mfma_f32_16x16x32_bf16 v[232:235], a[60:63], a[88:91], v[232:235]
    s_waitcnt lgkmcnt(0)
    s_waitcnt vmcnt(11)
    v_mfma_f32_16x16x32_bf16 v[64:67], a[0:3], a[64:67], v[64:67]
    ds_read_b64_tr_b16 a[32:33], v12 offset:24576
    s_add_u32 s60, s73, s100
    s_or_b32 s61, s60, 131072
    s_add_u32 m0, s59, 8192
    s_nop 0
    buffer_load_dwordx4 v5, s[20:23], s60 offen offset:0  lds
    v_mfma_f32_16x16x32_bf16 v[68:71], a[0:3], a[68:71], v[68:71]
    ds_read_b64_tr_b16 a[34:35], v12 offset:25600
    v_mfma_f32_16x16x32_bf16 v[72:75], a[0:3], a[72:75], v[72:75]
    ds_read_b64_tr_b16 a[36:37], v12 offset:24584
    buffer_load_dwordx4 v6, s[20:23], s60 offen offset:1024  lds
    v_mfma_f32_16x16x32_bf16 v[76:79], a[0:3], a[76:79], v[76:79]
    ds_read_b64_tr_b16 a[38:39], v12 offset:25608
    v_mfma_f32_16x16x32_bf16 v[80:83], a[0:3], a[80:83], v[80:83]
    ds_read_b64_tr_b16 a[40:41], v13 offset:24576
    buffer_load_dwordx4 v7, s[20:23], s60 offen offset:2048  lds
    v_mfma_f32_16x16x32_bf16 v[84:87], a[0:3], a[84:87], v[84:87]
    ds_read_b64_tr_b16 a[42:43], v13 offset:25600
    v_mfma_f32_16x16x32_bf16 v[108:111], a[4:7], a[84:87], v[108:111]
    ds_read_b64_tr_b16 a[44:45], v13 offset:24584
    buffer_load_dwordx4 v8, s[20:23], s60 offen offset:3072  lds
    v_mfma_f32_16x16x32_bf16 v[104:107], a[4:7], a[80:83], v[104:107]
    ds_read_b64_tr_b16 a[46:47], v13 offset:25608
    v_mfma_f32_16x16x32_bf16 v[100:103], a[4:7], a[76:79], v[100:103]
    ds_read_b64_tr_b16 a[48:49], v14 offset:24576
    s_add_u32 m0, s59, 12288
    s_nop 0
    buffer_load_dwordx4 v5, s[20:23], s61 offen offset:0  lds
    v_mfma_f32_16x16x32_bf16 v[96:99], a[4:7], a[72:75], v[96:99]
    ds_read_b64_tr_b16 a[50:51], v14 offset:25600
    v_mfma_f32_16x16x32_bf16 v[92:95], a[4:7], a[68:71], v[92:95]
    ds_read_b64_tr_b16 a[52:53], v14 offset:24584
    buffer_load_dwordx4 v6, s[20:23], s61 offen offset:1024  lds
    v_mfma_f32_16x16x32_bf16 v[88:91], a[4:7], a[64:67], v[88:91]
    ds_read_b64_tr_b16 a[54:55], v14 offset:25608
    v_mfma_f32_16x16x32_bf16 v[112:115], a[8:11], a[64:67], v[112:115]
    ds_read_b64_tr_b16 a[56:57], v15 offset:24576
    buffer_load_dwordx4 v7, s[20:23], s61 offen offset:2048  lds
    v_mfma_f32_16x16x32_bf16 v[116:119], a[8:11], a[68:71], v[116:119]
    ds_read_b64_tr_b16 a[58:59], v15 offset:25600
    v_mfma_f32_16x16x32_bf16 v[120:123], a[8:11], a[72:75], v[120:123]
    ds_read_b64_tr_b16 a[60:61], v15 offset:24584
    buffer_load_dwordx4 v8, s[20:23], s61 offen offset:3072  lds
    s_add_u32 s73, s73, 524288
    s_and_b32 s73, s73, 0x3fffff
    v_mfma_f32_16x16x32_bf16 v[124:127], a[8:11], a[76:79], v[124:127]
    ds_read_b64_tr_b16 a[62:63], v15 offset:25608
    v_mfma_f32_16x16x32_bf16 v[128:131], a[8:11], a[80:83], v[128:131]
    ds_read_b128 a[88:91], v17 offset:12288
    s_mov_b32 s64, 16384
    s_add_u32 m0, s59, 16384
    s_nop 0
    buffer_load_dwordx4 v32, s[12:15], s64 offen offset:0 nt lds
    v_mfma_f32_16x16x32_bf16 v[132:135], a[8:11], a[84:87], v[132:135]
    ds_read_b128 a[92:95], v17 offset:14336
    v_mfma_f32_16x16x32_bf16 v[156:159], a[12:15], a[84:87], v[156:159]
    ds_read_b128 a[96:99], v17 offset:16384
    buffer_load_dwordx4 v33, s[12:15], s64 offen offset:1024 nt lds
    v_mfma_f32_16x16x32_bf16 v[152:155], a[12:15], a[80:83], v[152:155]
    ds_read_b128 a[100:103], v17 offset:18432
    v_mfma_f32_16x16x32_bf16 v[148:151], a[12:15], a[76:79], v[148:151]
    ds_read_b128 a[104:107], v17 offset:20480
    buffer_load_dwordx4 v34, s[12:15], s64 offen offset:2048 nt lds
    v_mfma_f32_16x16x32_bf16 v[144:147], a[12:15], a[72:75], v[144:147]
    ds_read_b128 a[108:111], v17 offset:22528
    v_mfma_f32_16x16x32_bf16 v[140:143], a[12:15], a[68:71], v[140:143]
    buffer_load_dwordx4 v35, s[12:15], s64 offen offset:3072 nt lds
    v_mfma_f32_16x16x32_bf16 v[136:139], a[12:15], a[64:67], v[136:139]
    v_mfma_f32_16x16x32_bf16 v[160:163], a[16:19], a[64:67], v[160:163]
    s_mov_b32 s64, 20480
    s_add_u32 m0, s59, 20480
    s_nop 0
    buffer_load_dwordx4 v32, s[12:15], s64 offen offset:0 nt lds
    v_mfma_f32_16x16x32_bf16 v[164:167], a[16:19], a[68:71], v[164:167]
    v_mfma_f32_16x16x32_bf16 v[168:171], a[16:19], a[72:75], v[168:171]
    buffer_load_dwordx4 v33, s[12:15], s64 offen offset:1024 nt lds
    v_mfma_f32_16x16x32_bf16 v[172:175], a[16:19], a[76:79], v[172:175]
    v_mfma_f32_16x16x32_bf16 v[176:179], a[16:19], a[80:83], v[176:179]
    buffer_load_dwordx4 v34, s[12:15], s64 offen offset:2048 nt lds
    v_mfma_f32_16x16x32_bf16 v[180:183], a[16:19], a[84:87], v[180:183]
    v_mfma_f32_16x16x32_bf16 v[204:207], a[20:23], a[84:87], v[204:207]
    buffer_load_dwordx4 v35, s[12:15], s64 offen offset:3072 nt lds
    v_mfma_f32_16x16x32_bf16 v[200:203], a[20:23], a[80:83], v[200:203]
    v_mfma_f32_16x16x32_bf16 v[196:199], a[20:23], a[76:79], v[196:199]
    v_mfma_f32_16x16x32_bf16 v[192:195], a[20:23], a[72:75], v[192:195]
    v_mfma_f32_16x16x32_bf16 v[188:191], a[20:23], a[68:71], v[188:191]
    v_mfma_f32_16x16x32_bf16 v[184:187], a[20:23], a[64:67], v[184:187]
    v_mfma_f32_16x16x32_bf16 v[208:211], a[24:27], a[64:67], v[208:211]
    v_mfma_f32_16x16x32_bf16 v[212:215], a[24:27], a[68:71], v[212:215]
    v_mfma_f32_16x16x32_bf16 v[216:219], a[24:27], a[72:75], v[216:219]
    v_mfma_f32_16x16x32_bf16 v[220:223], a[24:27], a[76:79], v[220:223]
    v_mfma_f32_16x16x32_bf16 v[224:227], a[24:27], a[80:83], v[224:227]
    v_mfma_f32_16x16x32_bf16 v[228:231], a[24:27], a[84:87], v[228:231]
    v_mfma_f32_16x16x32_bf16 v[252:255], a[28:31], a[84:87], v[252:255]
    v_mfma_f32_16x16x32_bf16 v[248:251], a[28:31], a[80:83], v[248:251]
    v_mfma_f32_16x16x32_bf16 v[244:247], a[28:31], a[76:79], v[244:247]
    v_mfma_f32_16x16x32_bf16 v[240:243], a[28:31], a[72:75], v[240:243]
    v_mfma_f32_16x16x32_bf16 v[236:239], a[28:31], a[68:71], v[236:239]
    v_mfma_f32_16x16x32_bf16 v[232:235], a[28:31], a[64:67], v[232:235]
    s_waitcnt vmcnt(16) lgkmcnt(0)
    s_barrier
    v_mfma_f32_16x16x32_bf16 v[64:67], a[32:35], a[88:91], v[64:67]
    ds_read_b64_tr_b16 a[0:1], v12 offset:0
    v_mfma_f32_16x16x32_bf16 v[68:71], a[32:35], a[92:95], v[68:71]
    ds_read_b64_tr_b16 a[2:3], v12 offset:1024
    v_mfma_f32_16x16x32_bf16 v[72:75], a[32:35], a[96:99], v[72:75]
    ds_read_b64_tr_b16 a[4:5], v12 offset:8
    v_mfma_f32_16x16x32_bf16 v[76:79], a[32:35], a[100:103], v[76:79]
    ds_read_b64_tr_b16 a[6:7], v12 offset:1032
    v_mfma_f32_16x16x32_bf16 v[80:83], a[32:35], a[104:107], v[80:83]
    ds_read_b64_tr_b16 a[8:9], v13 offset:0
    v_mfma_f32_16x16x32_bf16 v[84:87], a[32:35], a[108:111], v[84:87]
    ds_read_b64_tr_b16 a[10:11], v13 offset:1024
    v_mfma_f32_16x16x32_bf16 v[108:111], a[36:39], a[108:111], v[108:111]
    ds_read_b64_tr_b16 a[12:13], v13 offset:8
    v_mfma_f32_16x16x32_bf16 v[104:107], a[36:39], a[104:107], v[104:107]
    ds_read_b64_tr_b16 a[14:15], v13 offset:1032
    v_mfma_f32_16x16x32_bf16 v[100:103], a[36:39], a[100:103], v[100:103]
    ds_read_b64_tr_b16 a[16:17], v14 offset:0
    v_mfma_f32_16x16x32_bf16 v[96:99], a[36:39], a[96:99], v[96:99]
    ds_read_b64_tr_b16 a[18:19], v14 offset:1024
    v_mfma_f32_16x16x32_bf16 v[92:95], a[36:39], a[92:95], v[92:95]
    ds_read_b64_tr_b16 a[20:21], v14 offset:8
    v_mfma_f32_16x16x32_bf16 v[88:91], a[36:39], a[88:91], v[88:91]
    ds_read_b64_tr_b16 a[22:23], v14 offset:1032
    v_mfma_f32_16x16x32_bf16 v[112:115], a[40:43], a[88:91], v[112:115]
    ds_read_b64_tr_b16 a[24:25], v15 offset:0
    v_mfma_f32_16x16x32_bf16 v[116:119], a[40:43], a[92:95], v[116:119]
    ds_read_b64_tr_b16 a[26:27], v15 offset:1024
    v_mfma_f32_16x16x32_bf16 v[120:123], a[40:43], a[96:99], v[120:123]
    ds_read_b64_tr_b16 a[28:29], v15 offset:8
    v_mfma_f32_16x16x32_bf16 v[124:127], a[40:43], a[100:103], v[124:127]
    ds_read_b64_tr_b16 a[30:31], v15 offset:1032
    v_mfma_f32_16x16x32_bf16 v[128:131], a[40:43], a[104:107], v[128:131]
    ds_read_b128 a[64:67], v16 offset:0
    v_mfma_f32_16x16x32_bf16 v[132:135], a[40:43], a[108:111], v[132:135]
    ds_read_b128 a[68:71], v16 offset:2048
    v_mfma_f32_16x16x32_bf16 v[156:159], a[44:47], a[108:111], v[156:159]
    ds_read_b128 a[72:75], v16 offset:4096
    v_mfma_f32_16x16x32_bf16 v[152:155], a[44:47], a[104:107], v[152:155]
    ds_read_b128 a[76:79], v16 offset:6144
    v_mfma_f32_16x16x32_bf16 v[148:151], a[44:47], a[100:103], v[148:151]
    ds_read_b128 a[80:83], v16 offset:8192
    v_mfma_f32_16x16x32_bf16 v[144:147], a[44:47], a[96:99], v[144:147]
    ds_read_b128 a[84:87], v16 offset:10240
    v_mfma_f32_16x16x32_bf16 v[140:143], a[44:47], a[92:95], v[140:143]
    s_waitcnt vmcnt(0)
    ds_read_b128 a[176:179], v36 offset:16384
    v_mfma_f32_16x16x32_bf16 v[136:139], a[44:47], a[88:91], v[136:139]
    ds_read_b128 a[180:183], v37 offset:16384
    v_mfma_f32_16x16x32_bf16 v[160:163], a[48:51], a[88:91], v[160:163]
    ds_read_b128 a[184:187], v38 offset:16384
    s_add_u32 m0, s66, 12288
    s_nop 0
    buffer_load_dwordx4 v2, s[8:11], s62 offen offset:0  lds
    v_mfma_f32_16x16x32_bf16 v[164:167], a[48:51], a[92:95], v[164:167]
    ds_read_b128 a[188:191], v39 offset:16384
    v_mfma_f32_16x16x32_bf16 v[168:171], a[48:51], a[96:99], v[168:171]
    ds_read_b128 a[192:195], v36 offset:20480
    buffer_load_dwordx4 v3, s[8:11], s62 offen offset:1024  lds
    v_mfma_f32_16x16x32_bf16 v[172:175], a[48:51], a[100:103], v[172:175]
    ds_read_b128 a[196:199], v37 offset:20480
    v_mfma_f32_16x16x32_bf16 v[176:179], a[48:51], a[104:107], v[176:179]
    ds_read_b128 a[200:203], v38 offset:20480
    buffer_load_dwordx4 v4, s[8:11], s62 offen offset:2048  lds
    s_add_u32 s62, s62, 128
    s_and_b32 s62, s62, 1023
    v_mfma_f32_16x16x32_bf16 v[180:183], a[48:51], a[108:111], v[180:183]
    ds_read_b128 a[204:207], v39 offset:20480
    v_mfma_f32_16x16x32_bf16 v[204:207], a[52:55], a[108:111], v[204:207]
    v_mfma_f32_16x16x32_bf16 v[200:203], a[52:55], a[104:107], v[200:203]
    v_mfma_f32_16x16x32_bf16 v[196:199], a[52:55], a[100:103], v[196:199]
    v_mfma_f32_16x16x32_bf16 v[192:195], a[52:55], a[96:99], v[192:195]
    s_waitcnt lgkmcnt(0)
    v_mfma_f32_16x16x32_bf16 v[188:191], a[52:55], a[92:95], v[188:191]
    s_add_u32 s60, s73, s75
    s_or_b32 s61, s60, 131072
    s_add_u32 m0, s59, 16384
    s_nop 0
    buffer_load_dwordx4 v5, s[20:23], s60 offen offset:0  lds
    v_mfma_f32_16x16x32_bf16 v[184:187], a[52:55], a[88:91], v[184:187]
    buffer_load_dwordx4 v6, s[20:23], s60 offen offset:1024  lds
    v_mfma_f32_16x16x32_bf16 v[208:211], a[56:59], a[88:91], v[208:211]
    v_mfma_f32_16x16x32_bf16 v[212:215], a[56:59], a[92:95], v[212:215]
    buffer_load_dwordx4 v7, s[20:23], s60 offen offset:2048  lds
    v_mfma_f32_16x16x32_bf16 v[216:219], a[56:59], a[96:99], v[216:219]
    v_mfma_f32_16x16x32_bf16 v[220:223], a[56:59], a[100:103], v[220:223]
    buffer_load_dwordx4 v8, s[20:23], s60 offen offset:3072  lds
    v_mfma_f32_16x16x32_bf16 v[224:227], a[56:59], a[104:107], v[224:227]
    s_add_u32 m0, s59, 20480
    v_mfma_f32_16x16x32_bf16 v[228:231], a[56:59], a[108:111], v[228:231]
    buffer_load_dwordx4 v5, s[20:23], s61 offen offset:0  lds
    v_mfma_f32_16x16x32_bf16 v[252:255], a[60:63], a[108:111], v[252:255]
    v_mfma_f32_16x16x32_bf16 v[248:251], a[60:63], a[104:107], v[248:251]
    buffer_load_dwordx4 v6, s[20:23], s61 offen offset:1024  lds
    v_mfma_f32_16x16x32_bf16 v[244:247], a[60:63], a[100:103], v[244:247]
    v_mfma_f32_16x16x32_bf16 v[240:243], a[60:63], a[96:99], v[240:243]
    buffer_load_dwordx4 v7, s[20:23], s61 offen offset:2048  lds
    v_mfma_f32_16x16x32_bf16 v[236:239], a[60:63], a[92:95], v[236:239]
    v_mfma_f32_16x16x32_bf16 v[232:235], a[60:63], a[88:91], v[232:235]
    buffer_load_dwordx4 v8, s[20:23], s61 offen offset:3072  lds
    v_mfma_f32_16x16x32_bf16 v[64:67], a[0:3], a[64:67], v[64:67]
    ds_read_b64_tr_b16 a[32:33], v12 offset:8192
    v_mfma_f32_16x16x32_bf16 v[68:71], a[0:3], a[68:71], v[68:71]
    ds_read_b64_tr_b16 a[34:35], v12 offset:9216
    v_mfma_f32_16x16x32_bf16 v[72:75], a[0:3], a[72:75], v[72:75]
    ds_read_b64_tr_b16 a[36:37], v12 offset:8200
    s_add_u32 s60, s73, s100
    s_or_b32 s61, s60, 131072
    s_add_u32 m0, s59, 24576
    s_nop 0
    buffer_load_dwordx4 v5, s[20:23], s60 offen offset:0  lds
    v_mfma_f32_16x16x32_bf16 v[76:79], a[0:3], a[76:79], v[76:79]
    ds_read_b64_tr_b16 a[38:39], v12 offset:9224
    v_mfma_f32_16x16x32_bf16 v[80:83], a[0:3], a[80:83], v[80:83]
    ds_read_b64_tr_b16 a[40:41], v13 offset:8192
    v_mfma_f32_16x16x32_bf16 v[84:87], a[0:3], a[84:87], v[84:87]
    ds_read_b64_tr_b16 a[42:43], v13 offset:9216
    v_mfma_f32_16x16x32_bf16 v[108:111], a[4:7], a[84:87], v[108:111]
    ds_read_b64_tr_b16 a[44:45], v13 offset:8200
    v_mfma_f32_16x16x32_bf16 v[104:107], a[4:7], a[80:83], v[104:107]
    ds_read_b64_tr_b16 a[46:47], v13 offset:9224
    v_mfma_f32_16x16x32_bf16 v[100:103], a[4:7], a[76:79], v[100:103]
    ds_read_b64_tr_b16 a[48:49], v14 offset:8192
    buffer_load_dwordx4 v6, s[20:23], s60 offen offset:1024  lds
    v_mfma_f32_16x16x32_bf16 v[96:99], a[4:7], a[72:75], v[96:99]
    ds_read_b64_tr_b16 a[50:51], v14 offset:9216
    v_mfma_f32_16x16x32_bf16 v[92:95], a[4:7], a[68:71], v[92:95]
    ds_read_b64_tr_b16 a[52:53], v14 offset:8200
    v_mfma_f32_16x16x32_bf16 v[88:91], a[4:7], a[64:67], v[88:91]
    ds_read_b64_tr_b16 a[54:55], v14 offset:9224
    v_mfma_f32_16x16x32_bf16 v[112:115], a[8:11], a[64:67], v[112:115]
    ds_read_b64_tr_b16 a[56:57], v15 offset:8192
    v_mfma_f32_16x16x32_bf16 v[116:119], a[8:11], a[68:71], v[116:119]
    ds_read_b64_tr_b16 a[58:59], v15 offset:9216
    v_mfma_f32_16x16x32_bf16 v[120:123], a[8:11], a[72:75], v[120:123]
    ds_read_b64_tr_b16 a[60:61], v15 offset:8200
    buffer_load_dwordx4 v7, s[20:23], s60 offen offset:2048  lds
    v_mfma_f32_16x16x32_bf16 v[124:127], a[8:11], a[76:79], v[124:127]
    ds_read_b64_tr_b16 a[62:63], v15 offset:9224
    v_mfma_f32_16x16x32_bf16 v[128:131], a[8:11], a[80:83], v[128:131]
    ds_read_b128 a[88:91], v17 offset:0
    v_mfma_f32_16x16x32_bf16 v[132:135], a[8:11], a[84:87], v[132:135]
    ds_read_b128 a[92:95], v17 offset:2048
    v_mfma_f32_16x16x32_bf16 v[156:159], a[12:15], a[84:87], v[156:159]
    ds_read_b128 a[96:99], v17 offset:4096
    v_mfma_f32_16x16x32_bf16 v[152:155], a[12:15], a[80:83], v[152:155]
    ds_read_b128 a[100:103], v17 offset:6144
    v_mfma_f32_16x16x32_bf16 v[148:151], a[12:15], a[76:79], v[148:151]
    ds_read_b128 a[104:107], v17 offset:8192
    buffer_load_dwordx4 v8, s[20:23], s60 offen offset:3072  lds
    v_mfma_f32_16x16x32_bf16 v[144:147], a[12:15], a[72:75], v[144:147]
    ds_read_b128 a[108:111], v17 offset:10240
    v_mfma_f32_16x16x32_bf16 v[140:143], a[12:15], a[68:71], v[140:143]
    v_mfma_f32_16x16x32_bf16 v[136:139], a[12:15], a[64:67], v[136:139]
    v_mfma_f32_16x16x32_bf16 v[160:163], a[16:19], a[64:67], v[160:163]
    v_mfma_f32_16x16x32_bf16 v[164:167], a[16:19], a[68:71], v[164:167]
    v_mfma_f32_16x16x32_bf16 v[168:171], a[16:19], a[72:75], v[168:171]
    s_add_u32 m0, s59, 28672
    v_mfma_f32_16x16x32_bf16 v[172:175], a[16:19], a[76:79], v[172:175]
    buffer_load_dwordx4 v5, s[20:23], s61 offen offset:0  lds
    v_mfma_f32_16x16x32_bf16 v[176:179], a[16:19], a[80:83], v[176:179]
    v_mfma_f32_16x16x32_bf16 v[180:183], a[16:19], a[84:87], v[180:183]
    v_mfma_f32_16x16x32_bf16 v[204:207], a[20:23], a[84:87], v[204:207]
    v_mfma_f32_16x16x32_bf16 v[200:203], a[20:23], a[80:83], v[200:203]
    v_mfma_f32_16x16x32_bf16 v[196:199], a[20:23], a[76:79], v[196:199]
    v_mfma_f32_16x16x32_bf16 v[192:195], a[20:23], a[72:75], v[192:195]
    buffer_load_dwordx4 v6, s[20:23], s61 offen offset:1024  lds
    v_mfma_f32_16x16x32_bf16 v[188:191], a[20:23], a[68:71], v[188:191]
    v_mfma_f32_16x16x32_bf16 v[184:187], a[20:23], a[64:67], v[184:187]
    v_mfma_f32_16x16x32_bf16 v[208:211], a[24:27], a[64:67], v[208:211]
    v_mfma_f32_16x16x32_bf16 v[212:215], a[24:27], a[68:71], v[212:215]
    v_mfma_f32_16x16x32_bf16 v[216:219], a[24:27], a[72:75], v[216:219]
    v_mfma_f32_16x16x32_bf16 v[220:223], a[24:27], a[76:79], v[220:223]
    buffer_load_dwordx4 v7, s[20:23], s61 offen offset:2048  lds
    v_mfma_f32_16x16x32_bf16 v[224:227], a[24:27], a[80:83], v[224:227]
    v_mfma_f32_16x16x32_bf16 v[228:231], a[24:27], a[84:87], v[228:231]
    v_mfma_f32_16x16x32_bf16 v[252:255], a[28:31], a[84:87], v[252:255]
    v_mfma_f32_16x16x32_bf16 v[248:251], a[28:31], a[80:83], v[248:251]
    v_mfma_f32_16x16x32_bf16 v[244:247], a[28:31], a[76:79], v[244:247]
    v_mfma_f32_16x16x32_bf16 v[240:243], a[28:31], a[72:75], v[240:243]
    v_mfma_f32_16x16x32_bf16 v[236:239], a[28:31], a[68:71], v[236:239]
    buffer_load_dwordx4 v8, s[20:23], s61 offen offset:3072  lds
    s_add_u32 s73, s73, 524288
    s_and_b32 s73, s73, 0x3fffff
    v_mfma_f32_16x16x32_bf16 v[232:235], a[28:31], a[64:67], v[232:235]
    s_waitcnt vmcnt(16) lgkmcnt(0)
    s_barrier
    s_waitcnt vmcnt(8)
    v_mfma_f32_16x16x32_bf16 v[64:67], a[32:35], a[88:91], v[64:67]
    ds_read_b64_tr_b16 a[0:1], v12 offset:16384
    v_mfma_f32_16x16x32_bf16 v[68:71], a[32:35], a[92:95], v[68:71]
    ds_read_b64_tr_b16 a[2:3], v12 offset:17408
    v_mfma_f32_16x16x32_bf16 v[72:75], a[32:35], a[96:99], v[72:75]
    ds_read_b64_tr_b16 a[4:5], v12 offset:16392
    s_mov_b32 s63, 0
    s_add_u32 m0, s59, 0
    s_nop 0
    buffer_load_dwordx4 v10, s[16:19], s63 offen offset:0 nt lds
    v_mfma_f32_16x16x32_bf16 v[76:79], a[32:35], a[100:103], v[76:79]
    ds_read_b64_tr_b16 a[6:7], v12 offset:17416
    v_mfma_f32_16x16x32_bf16 v[80:83], a[32:35], a[104:107], v[80:83]
    ds_read_b64_tr_b16 a[8:9], v13 offset:16384
    buffer_load_dwordx4 v11, s[16:19], s63 offen offset:1024 nt lds
    v_mfma_f32_16x16x32_bf16 v[84:87], a[32:35], a[108:111], v[84:87]
    ds_read_b64_tr_b16 a[10:11], v13 offset:17408
    v_mfma_f32_16x16x32_bf16 v[108:111], a[36:39], a[108:111], v[108:111]
    ds_read_b64_tr_b16 a[12:13], v13 offset:16392
    buffer_load_dwordx4 v10, s[16:19], s63 offen offset:2048 nt lds
    v_mfma_f32_16x16x32_bf16 v[104:107], a[36:39], a[104:107], v[104:107]
    ds_read_b64_tr_b16 a[14:15], v13 offset:17416
    v_mfma_f32_16x16x32_bf16 v[100:103], a[36:39], a[100:103], v[100:103]
    ds_read_b64_tr_b16 a[16:17], v14 offset:16384
    buffer_load_dwordx4 v11, s[16:19], s63 offen offset:3072 nt lds
    v_mfma_f32_16x16x32_bf16 v[96:99], a[36:39], a[96:99], v[96:99]
    ds_read_b64_tr_b16 a[18:19], v14 offset:17408
    v_mfma_f32_16x16x32_bf16 v[92:95], a[36:39], a[92:95], v[92:95]
    ds_read_b64_tr_b16 a[20:21], v14 offset:16392
    s_mov_b32 s63, 4096
    s_add_u32 m0, s59, 4096
    s_nop 0
    buffer_load_dwordx4 v10, s[16:19], s63 offen offset:0 nt lds
    v_mfma_f32_16x16x32_bf16 v[88:91], a[36:39], a[88:91], v[88:91]
    ds_read_b64_tr_b16 a[22:23], v14 offset:17416
    v_mfma_f32_16x16x32_bf16 v[112:115], a[40:43], a[88:91], v[112:115]
    ds_read_b64_tr_b16 a[24:25], v15 offset:16384
    buffer_load_dwordx4 v11, s[16:19], s63 offen offset:1024 nt lds
    v_mfma_f32_16x16x32_bf16 v[116:119], a[40:43], a[92:95], v[116:119]
    ds_read_b64_tr_b16 a[26:27], v15 offset:17408
    v_mfma_f32_16x16x32_bf16 v[120:123], a[40:43], a[96:99], v[120:123]
    ds_read_b64_tr_b16 a[28:29], v15 offset:16392
    buffer_load_dwordx4 v10, s[16:19], s63 offen offset:2048 nt lds
    v_mfma_f32_16x16x32_bf16 v[124:127], a[40:43], a[100:103], v[124:127]
    ds_read_b64_tr_b16 a[30:31], v15 offset:17416
    v_mfma_f32_16x16x32_bf16 v[128:131], a[40:43], a[104:107], v[128:131]
    ds_read_b128 a[64:67], v16 offset:12288
    buffer_load_dwordx4 v11, s[16:19], s63 offen offset:3072 nt lds
    v_mfma_f32_16x16x32_bf16 v[132:135], a[40:43], a[108:111], v[132:135]
    ds_read_b128 a[68:71], v16 offset:14336
    v_mfma_f32_16x16x32_bf16 v[156:159], a[44:47], a[108:111], v[156:159]
    ds_read_b128 a[72:75], v16 offset:16384
    v_mfma_f32_16x16x32_bf16 v[152:155], a[44:47], a[104:107], v[152:155]
    ds_read_b128 a[76:79], v16 offset:18432
    v_mfma_f32_16x16x32_bf16 v[148:151], a[44:47], a[100:103], v[148:151]
    ds_read_b128 a[80:83], v16 offset:20480
    v_mfma_f32_16x16x32_bf16 v[144:147], a[44:47], a[96:99], v[144:147]
    ds_read_b128 a[84:87], v16 offset:22528
    v_mfma_f32_16x16x32_bf16 v[140:143], a[44:47], a[92:95], v[140:143]
    v_mfma_f32_16x16x32_bf16 v[136:139], a[44:47], a[88:91], v[136:139]
    v_mfma_f32_16x16x32_bf16 v[160:163], a[48:51], a[88:91], v[160:163]
    v_mfma_f32_16x16x32_bf16 v[164:167], a[48:51], a[92:95], v[164:167]
    v_mfma_f32_16x16x32_bf16 v[168:171], a[48:51], a[96:99], v[168:171]
    v_mfma_f32_16x16x32_bf16 v[172:175], a[48:51], a[100:103], v[172:175]
    v_mfma_f32_16x16x32_bf16 v[176:179], a[48:51], a[104:107], v[176:179]
    v_mfma_f32_16x16x32_bf16 v[180:183], a[48:51], a[108:111], v[180:183]
    v_mfma_f32_16x16x32_bf16 v[204:207], a[52:55], a[108:111], v[204:207]
    v_mfma_f32_16x16x32_bf16 v[200:203], a[52:55], a[104:107], v[200:203]
    v_mfma_f32_16x16x32_bf16 v[196:199], a[52:55], a[100:103], v[196:199]
    v_mfma_f32_16x16x32_bf16 v[192:195], a[52:55], a[96:99], v[192:195]
    v_mfma_f32_16x16x32_bf16 v[188:191], a[52:55], a[92:95], v[188:191]
    v_mfma_f32_16x16x32_bf16 v[184:187], a[52:55], a[88:91], v[184:187]
    v_mfma_f32_16x16x32_bf16 v[208:211], a[56:59], a[88:91], v[208:211]
    v_mfma_f32_16x16x32_bf16 v[212:215], a[56:59], a[92:95], v[212:215]
    v_mfma_f32_16x16x32_bf16 v[216:219], a[56:59], a[96:99], v[216:219]
    v_mfma_f32_16x16x32_bf16 v[220:223], a[56:59], a[100:103], v[220:223]
    v_mfma_f32_16x16x32_bf16 v[224:227], a[56:59], a[104:107], v[224:227]
    v_mfma_f32_16x16x32_bf16 v[228:231], a[56:59], a[108:111], v[228:231]
    v_mfma_f32_16x16x32_bf16 v[252:255], a[60:63], a[108:111], v[252:255]
    v_mfma_f32_16x16x32_bf16 v[248:251], a[60:63], a[104:107], v[248:251]
    v_mfma_f32_16x16x32_bf16 v[244:247], a[60:63], a[100:103], v[244:247]
    v_mfma_f32_16x16x32_bf16 v[240:243], a[60:63], a[96:99], v[240:243]
    v_mfma_f32_16x16x32_bf16 v[236:239], a[60:63], a[92:95], v[236:239]
    v_mfma_f32_16x16x32_bf16 v[232:235], a[60:63], a[88:91], v[232:235]
    s_waitcnt lgkmcnt(0)
    s_waitcnt vmcnt(8)
    v_mfma_f32_16x16x32_bf16 v[64:67], a[0:3], a[64:67], v[64:67]
    ds_read_b64_tr_b16 a[32:33], v12 offset:24576
    v_mfma_f32_16x16x32_bf16 v[68:71], a[0:3], a[68:71], v[68:71]
    ds_read_b64_tr_b16 a[34:35], v12 offset:25600
    v_mfma_f32_16x16x32_bf16 v[72:75], a[0:3], a[72:75], v[72:75]
    ds_read_b64_tr_b16 a[36:37], v12 offset:24584
    v_mfma_f32_16x16x32_bf16 v[76:79], a[0:3], a[76:79], v[76:79]
    ds_read_b64_tr_b16 a[38:39], v12 offset:25608
    v_mfma_f32_16x16x32_bf16 v[80:83], a[0:3], a[80:83], v[80:83]
    ds_read_b64_tr_b16 a[40:41], v13 offset:24576
    v_mfma_f32_16x16x32_bf16 v[84:87], a[0:3], a[84:87], v[84:87]
    ds_read_b64_tr_b16 a[42:43], v13 offset:25600
    v_mfma_f32_16x16x32_bf16 v[108:111], a[4:7], a[84:87], v[108:111]
    ds_read_b64_tr_b16 a[44:45], v13 offset:24584
    v_mfma_f32_16x16x32_bf16 v[104:107], a[4:7], a[80:83], v[104:107]
    ds_read_b64_tr_b16 a[46:47], v13 offset:25608
    v_mfma_f32_16x16x32_bf16 v[100:103], a[4:7], a[76:79], v[100:103]
    ds_read_b64_tr_b16 a[48:49], v14 offset:24576
    v_mfma_f32_16x16x32_bf16 v[96:99], a[4:7], a[72:75], v[96:99]
    ds_read_b64_tr_b16 a[50:51], v14 offset:25600
    v_mfma_f32_16x16x32_bf16 v[92:95], a[4:7], a[68:71], v[92:95]
    ds_read_b64_tr_b16 a[52:53], v14 offset:24584
    v_mfma_f32_16x16x32_bf16 v[88:91], a[4:7], a[64:67], v[88:91]
    ds_read_b64_tr_b16 a[54:55], v14 offset:25608
    v_mfma_f32_16x16x32_bf16 v[112:115], a[8:11], a[64:67], v[112:115]
    ds_read_b64_tr_b16 a[56:57], v15 offset:24576
    v_mfma_f32_16x16x32_bf16 v[116:119], a[8:11], a[68:71], v[116:119]
    ds_read_b64_tr_b16 a[58:59], v15 offset:25600
    v_mfma_f32_16x16x32_bf16 v[120:123], a[8:11], a[72:75], v[120:123]
    ds_read_b64_tr_b16 a[60:61], v15 offset:24584
    v_mfma_f32_16x16x32_bf16 v[124:127], a[8:11], a[76:79], v[124:127]
    ds_read_b64_tr_b16 a[62:63], v15 offset:25608
    v_mfma_f32_16x16x32_bf16 v[128:131], a[8:11], a[80:83], v[128:131]
    ds_read_b128 a[88:91], v17 offset:12288
    v_mfma_f32_16x16x32_bf16 v[132:135], a[8:11], a[84:87], v[132:135]
    ds_read_b128 a[92:95], v17 offset:14336
    v_mfma_f32_16x16x32_bf16 v[156:159], a[12:15], a[84:87], v[156:159]
    ds_read_b128 a[96:99], v17 offset:16384
    v_mfma_f32_16x16x32_bf16 v[152:155], a[12:15], a[80:83], v[152:155]
    ds_read_b128 a[100:103], v17 offset:18432
    v_mfma_f32_16x16x32_bf16 v[148:151], a[12:15], a[76:79], v[148:151]
    ds_read_b128 a[104:107], v17 offset:20480
    v_mfma_f32_16x16x32_bf16 v[144:147], a[12:15], a[72:75], v[144:147]
    ds_read_b128 a[108:111], v17 offset:22528
    v_mfma_f32_16x16x32_bf16 v[140:143], a[12:15], a[68:71], v[140:143]
    v_mfma_f32_16x16x32_bf16 v[136:139], a[12:15], a[64:67], v[136:139]
    v_mfma_f32_16x16x32_bf16 v[160:163], a[16:19], a[64:67], v[160:163]
    v_mfma_f32_16x16x32_bf16 v[164:167], a[16:19], a[68:71], v[164:167]
    v_mfma_f32_16x16x32_bf16 v[168:171], a[16:19], a[72:75], v[168:171]
    v_mfma_f32_16x16x32_bf16 v[172:175], a[16:19], a[76:79], v[172:175]
    v_mfma_f32_16x16x32_bf16 v[176:179], a[16:19], a[80:83], v[176:179]
    v_mfma_f32_16x16x32_bf16 v[180:183], a[16:19], a[84:87], v[180:183]
    v_mfma_f32_16x16x32_bf16 v[204:207], a[20:23], a[84:87], v[204:207]
    v_mfma_f32_16x16x32_bf16 v[200:203], a[20:23], a[80:83], v[200:203]
    v_mfma_f32_16x16x32_bf16 v[196:199], a[20:23], a[76:79], v[196:199]
    v_mfma_f32_16x16x32_bf16 v[192:195], a[20:23], a[72:75], v[192:195]
    v_mfma_f32_16x16x32_bf16 v[188:191], a[20:23], a[68:71], v[188:191]
    v_mfma_f32_16x16x32_bf16 v[184:187], a[20:23], a[64:67], v[184:187]
    v_mfma_f32_16x16x32_bf16 v[208:211], a[24:27], a[64:67], v[208:211]
    v_mfma_f32_16x16x32_bf16 v[212:215], a[24:27], a[68:71], v[212:215]
    v_mfma_f32_16x16x32_bf16 v[216:219], a[24:27], a[72:75], v[216:219]
    v_mfma_f32_16x16x32_bf16 v[220:223], a[24:27], a[76:79], v[220:223]
    v_mfma_f32_16x16x32_bf16 v[224:227], a[24:27], a[80:83], v[224:227]
    v_mfma_f32_16x16x32_bf16 v[228:231], a[24:27], a[84:87], v[228:231]
    v_mfma_f32_16x16x32_bf16 v[252:255], a[28:31], a[84:87], v[252:255]
    v_mfma_f32_16x16x32_bf16 v[248:251], a[28:31], a[80:83], v[248:251]
    v_mfma_f32_16x16x32_bf16 v[244:247], a[28:31], a[76:79], v[244:247]
    v_mfma_f32_16x16x32_bf16 v[240:243], a[28:31], a[72:75], v[240:243]
    v_mfma_f32_16x16x32_bf16 v[236:239], a[28:31], a[68:71], v[236:239]
    v_mfma_f32_16x16x32_bf16 v[232:235], a[28:31], a[64:67], v[232:235]
    s_waitcnt lgkmcnt(0)
    s_barrier
    v_mfma_f32_16x16x32_bf16 v[64:67], a[32:35], a[88:91], v[64:67]
    v_mfma_f32_16x16x32_bf16 v[68:71], a[32:35], a[92:95], v[68:71]
    v_mfma_f32_16x16x32_bf16 v[72:75], a[32:35], a[96:99], v[72:75]
    s_mov_b32 s63, 8192
    s_add_u32 m0, s59, 8192
    s_nop 0
    buffer_load_dwordx4 v10, s[16:19], s63 offen offset:0 nt lds
    v_mfma_f32_16x16x32_bf16 v[76:79], a[32:35], a[100:103], v[76:79]
    v_mfma_f32_16x16x32_bf16 v[80:83], a[32:35], a[104:107], v[80:83]
    buffer_load_dwordx4 v11, s[16:19], s63 offen offset:1024 nt lds
    v_mfma_f32_16x16x32_bf16 v[84:87], a[32:35], a[108:111], v[84:87]
    v_mfma_f32_16x16x32_bf16 v[108:111], a[36:39], a[108:111], v[108:111]
    buffer_load_dwordx4 v10, s[16:19], s63 offen offset:2048 nt lds
    v_mfma_f32_16x16x32_bf16 v[104:107], a[36:39], a[104:107], v[104:107]
    v_mfma_f32_16x16x32_bf16 v[100:103], a[36:39], a[100:103], v[100:103]
    buffer_load_dwordx4 v11, s[16:19], s63 offen offset:3072 nt lds
    v_mfma_f32_16x16x32_bf16 v[96:99], a[36:39], a[96:99], v[96:99]
    v_mfma_f32_16x16x32_bf16 v[92:95], a[36:39], a[92:95], v[92:95]
    s_mov_b32 s63, 12288
    s_add_u32 m0, s59, 12288
    s_nop 0
    buffer_load_dwordx4 v10, s[16:19], s63 offen offset:0 nt lds
    v_mfma_f32_16x16x32_bf16 v[88:91], a[36:39], a[88:91], v[88:91]
    v_mfma_f32_16x16x32_bf16 v[112:115], a[40:43], a[88:91], v[112:115]
    buffer_load_dwordx4 v11, s[16:19], s63 offen offset:1024 nt lds
    v_mfma_f32_16x16x32_bf16 v[116:119], a[40:43], a[92:95], v[116:119]
    v_mfma_f32_16x16x32_bf16 v[120:123], a[40:43], a[96:99], v[120:123]
    buffer_load_dwordx4 v10, s[16:19], s63 offen offset:2048 nt lds
    v_cvt_pk_bf16_f32 v84, v84, v85
    v_cvt_pk_bf16_f32 v85, v86, v87
    v_mfma_f32_16x16x32_bf16 v[124:127], a[40:43], a[100:103], v[124:127]
    v_cvt_pk_bf16_f32 v86, v108, v109
    v_cvt_pk_bf16_f32 v87, v110, v111
    v_mfma_f32_16x16x32_bf16 v[128:131], a[40:43], a[104:107], v[128:131]
    buffer_load_dwordx4 v11, s[16:19], s63 offen offset:3072 nt lds
    v_cvt_pk_bf16_f32 v80, v80, v81
    v_cvt_pk_bf16_f32 v81, v82, v83
    v_mfma_f32_16x16x32_bf16 v[132:135], a[40:43], a[108:111], v[132:135]
    v_cvt_pk_bf16_f32 v82, v104, v105
    v_cvt_pk_bf16_f32 v83, v106, v107
    v_mfma_f32_16x16x32_bf16 v[156:159], a[44:47], a[108:111], v[156:159]
    v_cvt_pk_bf16_f32 v76, v76, v77
    v_cvt_pk_bf16_f32 v77, v78, v79
    v_mfma_f32_16x16x32_bf16 v[152:155], a[44:47], a[104:107], v[152:155]
    v_cvt_pk_bf16_f32 v78, v100, v101
    v_cvt_pk_bf16_f32 v79, v102, v103
    v_mfma_f32_16x16x32_bf16 v[148:151], a[44:47], a[100:103], v[148:151]
    v_cvt_pk_bf16_f32 v72, v72, v73
    v_cvt_pk_bf16_f32 v73, v74, v75
    v_mfma_f32_16x16x32_bf16 v[144:147], a[44:47], a[96:99], v[144:147]
    v_cvt_pk_bf16_f32 v74, v96, v97
    v_cvt_pk_bf16_f32 v75, v98, v99
    v_mfma_f32_16x16x32_bf16 v[140:143], a[44:47], a[92:95], v[140:143]
    v_cvt_pk_bf16_f32 v68, v68, v69
    v_cvt_pk_bf16_f32 v69, v70, v71
    v_mfma_f32_16x16x32_bf16 v[136:139], a[44:47], a[88:91], v[136:139]
    v_cvt_pk_bf16_f32 v70, v92, v93
    v_cvt_pk_bf16_f32 v71, v94, v95
    v_mfma_f32_16x16x32_bf16 v[160:163], a[48:51], a[88:91], v[160:163]
    v_cvt_pk_bf16_f32 v64, v64, v65
    v_cvt_pk_bf16_f32 v65, v66, v67
    v_mfma_f32_16x16x32_bf16 v[164:167], a[48:51], a[92:95], v[164:167]
    v_cvt_pk_bf16_f32 v66, v88, v89
    v_cvt_pk_bf16_f32 v67, v90, v91
    v_mfma_f32_16x16x32_bf16 v[168:171], a[48:51], a[96:99], v[168:171]
    v_cvt_pk_bf16_f32 v132, v132, v133
    v_cvt_pk_bf16_f32 v133, v134, v135
    v_mfma_f32_16x16x32_bf16 v[172:175], a[48:51], a[100:103], v[172:175]
    v_cvt_pk_bf16_f32 v134, v156, v157
    v_cvt_pk_bf16_f32 v135, v158, v159
    v_mfma_f32_16x16x32_bf16 v[176:179], a[48:51], a[104:107], v[176:179]
    v_cvt_pk_bf16_f32 v128, v128, v129
    v_cvt_pk_bf16_f32 v129, v130, v131
    v_mfma_f32_16x16x32_bf16 v[180:183], a[48:51], a[108:111], v[180:183]
    v_cvt_pk_bf16_f32 v130, v152, v153
    v_cvt_pk_bf16_f32 v131, v154, v155
    v_mfma_f32_16x16x32_bf16 v[204:207], a[52:55], a[108:111], v[204:207]
    v_cvt_pk_bf16_f32 v124, v124, v125
    v_cvt_pk_bf16_f32 v125, v126, v127
    v_mfma_f32_16x16x32_bf16 v[200:203], a[52:55], a[104:107], v[200:203]
    v_cvt_pk_bf16_f32 v126, v148, v149
    v_cvt_pk_bf16_f32 v127, v150, v151
    v_mfma_f32_16x16x32_bf16 v[196:199], a[52:55], a[100:103], v[196:199]
    v_cvt_pk_bf16_f32 v120, v120, v121
    v_cvt_pk_bf16_f32 v121, v122, v123
    v_mfma_f32_16x16x32_bf16 v[192:195], a[52:55], a[96:99], v[192:195]
    v_cvt_pk_bf16_f32 v122, v144, v145
    v_cvt_pk_bf16_f32 v123, v146, v147
    v_mfma_f32_16x16x32_bf16 v[188:191], a[52:55], a[92:95], v[188:191]
    v_cvt_pk_bf16_f32 v116, v116, v117
    v_cvt_pk_bf16_f32 v117, v118, v119
    v_mfma_f32_16x16x32_bf16 v[184:187], a[52:55], a[88:91], v[184:187]
    v_cvt_pk_bf16_f32 v118, v140, v141
    v_cvt_pk_bf16_f32 v119, v142, v143
    v_mfma_f32_16x16x32_bf16 v[208:211], a[56:59], a[88:91], v[208:211]
    v_cvt_pk_bf16_f32 v112, v112, v113
    v_cvt_pk_bf16_f32 v113, v114, v115
    v_mfma_f32_16x16x32_bf16 v[212:215], a[56:59], a[92:95], v[212:215]
    v_cvt_pk_bf16_f32 v114, v136, v137
    v_cvt_pk_bf16_f32 v115, v138, v139
    v_mfma_f32_16x16x32_bf16 v[216:219], a[56:59], a[96:99], v[216:219]
    v_cvt_pk_bf16_f32 v180, v180, v181
    v_cvt_pk_bf16_f32 v181, v182, v183
    v_cvt_pk_bf16_f32 v182, v204, v205
    v_mfma_f32_16x16x32_bf16 v[220:223], a[56:59], a[100:103], v[220:223]
    v_cvt_pk_bf16_f32 v183, v206, v207
    v_cvt_pk_bf16_f32 v176, v176, v177
    v_cvt_pk_bf16_f32 v177, v178, v179
    v_mfma_f32_16x16x32_bf16 v[224:227], a[56:59], a[104:107], v[224:227]
    v_cvt_pk_bf16_f32 v178, v200, v201
    v_cvt_pk_bf16_f32 v179, v202, v203
    v_mfma_f32_16x16x32_bf16 v[228:231], a[56:59], a[108:111], v[228:231]
    v_cvt_pk_bf16_f32 v172, v172, v173
    v_cvt_pk_bf16_f32 v173, v174, v175
    v_cvt_pk_bf16_f32 v174, v196, v197
    v_mfma_f32_16x16x32_bf16 v[252:255], a[60:63], a[108:111], v[252:255]
    v_cvt_pk_bf16_f32 v175, v198, v199
    v_cvt_pk_bf16_f32 v168, v168, v169
    v_cvt_pk_bf16_f32 v169, v170, v171
    v_mfma_f32_16x16x32_bf16 v[248:251], a[60:63], a[104:107], v[248:251]
    v_cvt_pk_bf16_f32 v170, v192, v193
    v_cvt_pk_bf16_f32 v171, v194, v195
    v_mfma_f32_16x16x32_bf16 v[244:247], a[60:63], a[100:103], v[244:247]
    v_cvt_pk_bf16_f32 v164, v164, v165
    v_cvt_pk_bf16_f32 v165, v166, v167
    v_cvt_pk_bf16_f32 v166, v188, v189
    v_mfma_f32_16x16x32_bf16 v[240:243], a[60:63], a[96:99], v[240:243]
    v_cvt_pk_bf16_f32 v167, v190, v191
    v_cvt_pk_bf16_f32 v160, v160, v161
    v_cvt_pk_bf16_f32 v161, v162, v163
    v_mfma_f32_16x16x32_bf16 v[236:239], a[60:63], a[92:95], v[236:239]
    v_cvt_pk_bf16_f32 v162, v184, v185
    v_cvt_pk_bf16_f32 v163, v186, v187
    v_mfma_f32_16x16x32_bf16 v[232:235], a[60:63], a[88:91], v[232:235]
    s_branch L_join
L_p1_2:
    v_mfma_f32_16x16x32_bf16 v[64:67], a[0:3], a[64:67], 0
    ds_read_b128 a[88:91], v17 offset:0
    v_mfma_f32_16x16x32_bf16 v[68:71], a[0:3], a[68:71], 0
    ds_read_b128 a[92:95], v17 offset:2048
    v_mfma_f32_16x16x32_bf16 v[72:75], a[0:3], a[72:75], 0
    ds_read_b128 a[96:99], v17 offset:4096
    v_mfma_f32_16x16x32_bf16 v[76:79], a[0:3], a[76:79], 0
    ds_read_b128 a[100:103], v17 offset:6144
    v_mfma_f32_16x16x32_bf16 v[80:83], a[0:3], a[80:83], 0
    ds_read_b128 a[104:107], v17 offset:8192
    v_mfma_f32_16x16x32_bf16 v[84:87], a[0:3], a[84:87], 0
    ds_read_b128 a[108:111], v17 offset:10240
    v_mfma_f32_16x16x32_bf16 v[108:111], a[4:7], a[84:87], 0
    v_mfma_f32_16x16x32_bf16 v[104:107], a[4:7], a[80:83], 0
    v_mfma_f32_16x16x32_bf16 v[100:103], a[4:7], a[76:79], 0
    v_mfma_f32_16x16x32_bf16 v[96:99], a[4:7], a[72:75], 0
    v_mfma_f32_16x16x32_bf16 v[92:95], a[4:7], a[68:71], 0
    v_mfma_f32_16x16x32_bf16 v[88:91], a[4:7], a[64:67], 0
    v_mfma_f32_16x16x32_bf16 v[112:115], a[8:11], a[64:67], 0
    v_mfma_f32_16x16x32_bf16 v[116:119], a[8:11], a[68:71], 0
    v_mfma_f32_16x16x32_bf16 v[120:123], a[8:11], a[72:75], 0
    v_mfma_f32_16x16x32_bf16 v[124:127], a[8:11], a[76:79], 0
    v_mfma_f32_16x16x32_bf16 v[128:131], a[8:11], a[80:83], 0
    v_mfma_f32_16x16x32_bf16 v[132:135], a[8:11], a[84:87], 0
    v_mfma_f32_16x16x32_bf16 v[156:159], a[12:15], a[84:87], 0
    v_mfma_f32_16x16x32_bf16 v[152:155], a[12:15], a[80:83], 0
    v_mfma_f32_16x16x32_bf16 v[148:151], a[12:15], a[76:79], 0
    v_mfma_f32_16x16x32_bf16 v[144:147], a[12:15], a[72:75], 0
    v_mfma_f32_16x16x32_bf16 v[140:143], a[12:15], a[68:71], 0
    s_waitcnt vmcnt(4)
    ds_read_b64_tr_b16 a[32:33], v12 offset:8192
    v_mfma_f32_16x16x32_bf16 v[136:139], a[12:15], a[64:67], 0
    ds_read_b64_tr_b16 a[34:35], v12 offset:9216
    v_mfma_f32_16x16x32_bf16 v[160:163], a[16:19], a[64:67], 0
    ds_read_b64_tr_b16 a[36:37], v12 offset:8200
    s_add_u32 s60, s73, s75
    s_or_b32 s61, s60, 131072
    s_add_u32 m0, s59, 16384
    s_nop 0
    buffer_load_dwordx4 v5, s[20:23], s60 offen offset:0  lds
    v_mfma_f32_16x16x32_bf16 v[164:167], a[16:19], a[68:71], 0
    ds_read_b64_tr_b16 a[38:39], v12 offset:9224
    v_mfma_f32_16x16x32_bf16 v[168:171], a[16:19], a[72:75], 0
    ds_read_b64_tr_b16 a[40:41], v13 offset:8192
    v_mfma_f32_16x16x32_bf16 v[172:175], a[16:19], a[76:79], 0
    ds_read_b64_tr_b16 a[42:43], v13 offset:9216
    buffer_load_dwordx4 v6, s[20:23], s60 offen offset:1024  lds
    v_mfma_f32_16x16x32_bf16 v[176:179], a[16:19], a[80:83], 0
    ds_read_b64_tr_b16 a[44:45], v13 offset:8200
    v_mfma_f32_16x16x32_bf16 v[180:183], a[16:19], a[84:87], 0
    ds_read_b64_tr_b16 a[46:47], v13 offset:9224
    v_mfma_f32_16x16x32_bf16 v[204:207], a[20:23], a[84:87], 0
    ds_read_b64_tr_b16 a[48:49], v14 offset:8192
    buffer_load_dwordx4 v7, s[20:23], s60 offen offset:2048  lds
    v_mfma_f32_16x16x32_bf16 v[200:203], a[20:23], a[80:83], 0
    ds_read_b64_tr_b16 a[50:51], v14 offset:9216
    v_mfma_f32_16x16x32_bf16 v[196:199], a[20:23], a[76:79], 0
    ds_read_b64_tr_b16 a[52:53], v14 offset:8200
    v_mfma_f32_16x16x32_bf16 v[192:195], a[20:23], a[72:75], 0
    ds_read_b64_tr_b16 a[54:55], v14 offset:9224
    buffer_load_dwordx4 v8, s[20:23], s60 offen offset:3072  lds
    v_mfma_f32_16x16x32_bf16 v[188:191], a[20:23], a[68:71], 0
    ds_read_b64_tr_b16 a[56:57], v15 offset:8192
    v_mfma_f32_16x16x32_bf16 v[184:187], a[20:23], a[64:67], 0
    ds_read_b64_tr_b16 a[58:59], v15 offset:9216
    v_mfma_f32_16x16x32_bf16 v[208:211], a[24:27], a[64:67], 0
    ds_read_b64_tr_b16 a[60:61], v15 offset:8200
    s_add_u32 m0, s59, 20480
    s_nop 0
    buffer_load_dwordx4 v5, s[20:23], s61 offen offset:0  lds
    v_mfma_f32_16x16x32_bf16 v[212:215], a[24:27], a[68:71], 0
    ds_read_b64_tr_b16 a[62:63], v15 offset:9224
    v_mfma_f32_16x16x32_bf16 v[216:219], a[24:27], a[72:75], 0
    v_mfma_f32_16x16x32_bf16 v[220:223], a[24:27], a[76:79], 0
    buffer_load_dwordx4 v6, s[20:23], s61 offen offset:1024  lds
    v_mfma_f32_16x16x32_bf16 v[224:227], a[24:27], a[80:83], 0
    v_mfma_f32_16x16x32_bf16 v[228:231], a[24:27], a[84:87], 0
    v_mfma_f32_16x16x32_bf16 v[252:255], a[28:31], a[84:87], 0
    buffer_load_dwordx4 v7, s[20:23], s61 offen offset:2048  lds
    v_mfma_f32_16x16x32_bf16 v[248:251], a[28:31], a[80:83], 0
    v_mfma_f32_16x16x32_bf16 v[244:247], a[28:31], a[76:79], 0
    v_mfma_f32_16x16x32_bf16 v[240:243], a[28:31], a[72:75], 0
    v_mfma_f32_16x16x32_bf16 v[236:239], a[28:31], a[68:71], 0
    buffer_load_dwordx4 v8, s[20:23], s61 offen offset:3072  lds
    v_mfma_f32_16x16x32_bf16 v[232:235], a[28:31], a[64:67], 0
    s_waitcnt vmcnt(9) lgkmcnt(0)
    s_barrier
    v_mfma_f32_16x16x32_bf16 v[64:67], a[32:35], a[88:91], v[64:67]
    ds_read_b128 a[64:67], v16 offset:12288
    v_mfma_f32_16x16x32_bf16 v[68:71], a[32:35], a[92:95], v[68:71]
    ds_read_b128 a[68:71], v16 offset:14336
    v_mfma_f32_16x16x32_bf16 v[72:75], a[32:35], a[96:99], v[72:75]
    ds_read_b128 a[72:75], v16 offset:16384
    v_mfma_f32_16x16x32_bf16 v[76:79], a[32:35], a[100:103], v[76:79]
    ds_read_b128 a[76:79], v16 offset:18432
    v_mfma_f32_16x16x32_bf16 v[80:83], a[32:35], a[104:107], v[80:83]
    ds_read_b128 a[80:83], v16 offset:20480
    v_mfma_f32_16x16x32_bf16 v[84:87], a[32:35], a[108:111], v[84:87]
    ds_read_b128 a[84:87], v16 offset:22528
    v_mfma_f32_16x16x32_bf16 v[108:111], a[36:39], a[108:111], v[108:111]
    v_mfma_f32_16x16x32_bf16 v[104:107], a[36:39], a[104:107], v[104:107]
    v_mfma_f32_16x16x32_bf16 v[100:103], a[36:39], a[100:103], v[100:103]
    v_mfma_f32_16x16x32_bf16 v[96:99], a[36:39], a[96:99], v[96:99]
    v_mfma_f32_16x16x32_bf16 v[92:95], a[36:39], a[92:95], v[92:95]
    v_mfma_f32_16x16x32_bf16 v[88:91], a[36:39], a[88:91], v[88:91]
    v_mfma_f32_16x16x32_bf16 v[112:115], a[40:43], a[88:91], v[112:115]
    v_mfma_f32_16x16x32_bf16 v[116:119], a[40:43], a[92:95], v[116:119]
    v_mfma_f32_16x16x32_bf16 v[120:123], a[40:43], a[96:99], v[120:123]
    v_mfma_f32_16x16x32_bf16 v[124:127], a[40:43], a[100:103], v[124:127]
    v_mfma_f32_16x16x32_bf16 v[128:131], a[40:43], a[104:107], v[128:131]
    v_mfma_f32_16x16x32_bf16 v[132:135], a[40:43], a[108:111], v[132:135]
    v_mfma_f32_16x16x32_bf16 v[156:159], a[44:47], a[108:111], v[156:159]
    v_mfma_f32_16x16x32_bf16 v[152:155], a[44:47], a[104:107], v[152:155]
    v_mfma_f32_16x16x32_bf16 v[148:151], a[44:47], a[100:103], v[148:151]
    v_mfma_f32_16x16x32_bf16 v[144:147], a[44:47], a[96:99], v[144:147]
    v_mfma_f32_16x16x32_bf16 v[140:143], a[44:47], a[92:95], v[140:143]
    s_waitcnt vmcnt(0)
    ds_read_b64_tr_b16 a[0:1], v12 offset:16384
    v_mfma_f32_16x16x32_bf16 v[136:139], a[44:47], a[88:91], v[136:139]
    ds_read_b64_tr_b16 a[2:3], v12 offset:17408
    v_mfma_f32_16x16x32_bf16 v[160:163], a[48:51], a[88:91], v[160:163]
    ds_read_b64_tr_b16 a[4:5], v12 offset:16392
    s_add_u32 s60, s73, s100
    s_or_b32 s61, s60, 131072
    s_add_u32 m0, s59, 24576
    s_nop 0
    buffer_load_dwordx4 v5, s[20:23], s60 offen offset:0  lds
    v_mfma_f32_16x16x32_bf16 v[164:167], a[48:51], a[92:95], v[164:167]
    ds_read_b64_tr_b16 a[6:7], v12 offset:17416
    v_mfma_f32_16x16x32_bf16 v[168:171], a[48:51], a[96:99], v[168:171]
    ds_read_b64_tr_b16 a[8:9], v13 offset:16384
    v_mfma_f32_16x16x32_bf16 v[172:175], a[48:51], a[100:103], v[172:175]
    ds_read_b64_tr_b16 a[10:11], v13 offset:17408
    buffer_load_dwordx4 v6, s[20:23], s60 offen offset:1024  lds
    v_mfma_f32_16x16x32_bf16 v[176:179], a[48:51], a[104:107], v[176:179]
    ds_read_b64_tr_b16 a[12:13], v13 offset:16392
    v_mfma_f32_16x16x32_bf16 v[180:183], a[48:51], a[108:111], v[180:183]
    ds_read_b64_tr_b16 a[14:15], v13 offset:17416
    v_mfma_f32_16x16x32_bf16 v[204:207], a[52:55], a[108:111], v[204:207]
    ds_read_b64_tr_b16 a[16:17], v14 offset:16384
    buffer_load_dwordx4 v7, s[20:23], s60 offen offset:2048  lds
    v_mfma_f32_16x16x32_bf16 v[200:203], a[52:55], a[104:107], v[200:203]
    ds_read_b64_tr_b16 a[18:19], v14 offset:17408
    v_mfma_f32_16x16x32_bf16 v[196:199], a[52:55], a[100:103], v[196:199]
    ds_read_b64_tr_b16 a[20:21], v14 offset:16392
    v_mfma_f32_16x16x32_bf16 v[192:195], a[52:55], a[96:99], v[192:195]
    ds_read_b64_tr_b16 a[22:23], v14 offset:17416
    buffer_load_dwordx4 v8, s[20:23], s60 offen offset:3072  lds
    v_mfma_f32_16x16x32_bf16 v[188:191], a[52:55], a[92:95], v[188:191]
    ds_read_b64_tr_b16 a[24:25], v15 offset:16384
    v_mfma_f32_16x16x32_bf16 v[184:187], a[52:55], a[88:91], v[184:187]
    ds_read_b64_tr_b16 a[26:27], v15 offset:17408
    v_mfma_f32_16x16x32_bf16 v[208:211], a[56:59], a[88:91], v[208:211]
    ds_read_b64_tr_b16 a[28:29], v15 offset:16392
    s_add_u32 m0, s59, 28672
    s_nop 0
    buffer_load_dwordx4 v5, s[20:23], s61 offen offset:0  lds
    v_mfma_f32_16x16x32_bf16 v[212:215], a[56:59], a[92:95], v[212:215]
    ds_read_b64_tr_b16 a[30:31], v15 offset:17416
    v_mfma_f32_16x16x32_bf16 v[216:219], a[56:59], a[96:99], v[216:219]
    v_mfma_f32_16x16x32_bf16 v[220:223], a[56:59], a[100:103], v[220:223]
    buffer_load_dwordx4 v6, s[20:23], s61 offen offset:1024  lds
    v_mfma_f32_16x16x32_bf16 v[224:227], a[56:59], a[104:107], v[224:227]
    v_mfma_f32_16x16x32_bf16 v[228:231], a[56:59], a[108:111], v[228:231]
    v_mfma_f32_16x16x32_bf16 v[252:255], a[60:63], a[108:111], v[252:255]
    buffer_load_dwordx4 v7, s[20:23], s61 offen offset:2048  lds
    s_add_u32 m0, s66, 0
    s_nop 0
    buffer_load_dwordx4 v2, s[8:11], s62 offen offset:0  lds
    v_mfma_f32_16x16x32_bf16 v[248:251], a[60:63], a[104:107], v[248:251]
    v_mfma_f32_16x16x32_bf16 v[244:247], a[60:63], a[100:103], v[244:247]
    buffer_load_dwordx4 v3, s[8:11], s62 offen offset:1024  lds
    v_mfma_f32_16x16x32_bf16 v[240:243], a[60:63], a[96:99], v[240:243]
    s_add_u32 m0, s59, 28672
    v_mfma_f32_16x16x32_bf16 v[236:239], a[60:63], a[92:95], v[236:239]
    buffer_load_dwordx4 v8, s[20:23], s61 offen offset:3072  lds
    s_add_u32 s73, s73, 524288
    s_and_b32 s73, s73, 0x3fffff
    s_add_u32 m0, s66, 0
    s_nop 0
    buffer_load_dwordx4 v4, s[8:11], s62 offen offset:2048  lds
    s_add_u32 s62, s62, 128
    s_and_b32 s62, s62, 1023
    v_mfma_f32_16x16x32_bf16 v[232:235], a[60:63], a[88:91], v[232:235]
    s_waitcnt lgkmcnt(0)
    v_mfma_f32_16x16x32_bf16 v[64:67], a[0:3], a[64:67], v[64:67]
    ds_read_b128 a[88:91], v17 offset:12288
    v_mfma_f32_16x16x32_bf16 v[68:71], a[0:3], a[68:71], v[68:71]
    ds_read_b128 a[92:95], v17 offset:14336
    s_add_u32 s60, s73, s75
    s_or_b32 s61, s60, 131072
    s_add_u32 m0, s59, 0
    s_nop 0
    buffer_load_dwordx4 v5, s[20:23], s60 offen offset:0  lds
    v_mfma_f32_16x16x32_bf16 v[72:75], a[0:3], a[72:75], v[72:75]
    ds_read_b128 a[96:99], v17 offset:16384
    v_mfma_f32_16x16x32_bf16 v[76:79], a[0:3], a[76:79], v[76:79]
    ds_read_b128 a[100:103], v17 offset:18432
    buffer_load_dwordx4 v6, s[20:23], s60 offen offset:1024  lds
    v_mfma_f32_16x16x32_bf16 v[80:83], a[0:3], a[80:83], v[80:83]
    ds_read_b128 a[104:107], v17 offset:20480
    v_mfma_f32_16x16x32_bf16 v[84:87], a[0:3], a[84:87], v[84:87]
    ds_read_b128 a[108:111], v17 offset:22528
    v_mfma_f32_16x16x32_bf16 v[108:111], a[4:7], a[84:87], v[108:111]
    buffer_load_dwordx4 v7, s[20:23], s60 offen offset:2048  lds
    v_mfma_f32_16x16x32_bf16 v[104:107], a[4:7], a[80:83], v[104:107]
    v_mfma_f32_16x16x32_bf16 v[100:103], a[4:7], a[76:79], v[100:103]
    v_mfma_f32_16x16x32_bf16 v[96:99], a[4:7], a[72:75], v[96:99]
    buffer_load_dwordx4 v8, s[20:23], s60 offen offset:3072  lds
    v_mfma_f32_16x16x32_bf16 v[92:95], a[4:7], a[68:71], v[92:95]
    v_mfma_f32_16x16x32_bf16 v[88:91], a[4:7], a[64:67], v[88:91]
    s_add_u32 m0, s59, 4096
    v_mfma_f32_16x16x32_bf16 v[112:115], a[8:11], a[64:67], v[112:115]
    buffer_load_dwordx4 v5, s[20:23], s61 offen offset:0  lds
    v_mfma_f32_16x16x32_bf16 v[116:119], a[8:11], a[68:71], v[116:119]
    v_mfma_f32_16x16x32_bf16 v[120:123], a[8:11], a[72:75], v[120:123]
    v_mfma_f32_16x16x32_bf16 v[124:127], a[8:11], a[76:79], v[124:127]
    buffer_load_dwordx4 v6, s[20:23], s61 offen offset:1024  lds
    v_mfma_f32_16x16x32_bf16 v[128:131], a[8:11], a[80:83], v[128:131]
    v_mfma_f32_16x16x32_bf16 v[132:135], a[8:11], a[84:87], v[132:135]
    v_mfma_f32_16x16x32_bf16 v[156:159], a[12:15], a[84:87], v[156:159]
    buffer_load_dwordx4 v7, s[20:23], s61 offen offset:2048  lds
    v_mfma_f32_16x16x32_bf16 v[152:155], a[12:15], a[80:83], v[152:155]
    v_mfma_f32_16x16x32_bf16 v[148:151], a[12:15], a[76:79], v[148:151]
    v_mfma_f32_16x16x32_bf16 v[144:147], a[12:15], a[72:75], v[144:147]
    buffer_load_dwordx4 v8, s[20:23], s61 offen offset:3072  lds
    v_mfma_f32_16x16x32_bf16 v[140:143], a[12:15], a[68:71], v[140:143]
    s_waitcnt vmcnt(9)
    ds_read_b64_tr_b16 a[32:33], v12 offset:24576
    v_mfma_f32_16x16x32_bf16 v[136:139], a[12:15], a[64:67], v[136:139]
    ds_read_b64_tr_b16 a[34:35], v12 offset:25600
    v_mfma_f32_16x16x32_bf16 v[160:163], a[16:19], a[64:67], v[160:163]
    ds_read_b64_tr_b16 a[36:37], v12 offset:24584
    s_add_u32 s60, s73, s100
    s_or_b32 s61, s60, 131072
    s_add_u32 m0, s59, 8192
    s_nop 0
    buffer_load_dwordx4 v5, s[20:23], s60 offen offset:0  lds
    v_mfma_f32_16x16x32_bf16 v[164:167], a[16:19], a[68:71], v[164:167]
    ds_read_b64_tr_b16 a[38:39], v12 offset:25608
    v_mfma_f32_16x16x32_bf16 v[168:171], a[16:19], a[72:75], v[168:171]
    ds_read_b64_tr_b16 a[40:41], v13 offset:24576
    v_mfma_f32_16x16x32_bf16 v[172:175], a[16:19], a[76:79], v[172:175]
    ds_read_b64_tr_b16 a[42:43], v13 offset:25600
    buffer_load_dwordx4 v6, s[20:23], s60 offen offset:1024  lds
    v_mfma_f32_16x16x32_bf16 v[176:179], a[16:19], a[80:83], v[176:179]
    ds_read_b64_tr_b16 a[44:45], v13 offset:24584
    v_mfma_f32_16x16x32_bf16 v[180:183], a[16:19], a[84:87], v[180:183]
    ds_read_b64_tr_b16 a[46:47], v13 offset:25608
    v_mfma_f32_16x16x32_bf16 v[204:207], a[20:23], a[84:87], v[204:207]
    ds_read_b64_tr_b16 a[48:49], v14 offset:24576
    buffer_load_dwordx4 v7, s[20:23], s60 offen offset:2048  lds
    v_mfma_f32_16x16x32_bf16 v[200:203], a[20:23], a[80:83], v[200:203]
    ds_read_b64_tr_b16 a[50:51], v14 offset:25600
    v_mfma_f32_16x16x32_bf16 v[196:199], a[20:23], a[76:79], v[196:199]
    ds_read_b64_tr_b16 a[52:53], v14 offset:24584
    v_mfma_f32_16x16x32_bf16 v[192:195], a[20:23], a[72:75], v[192:195]
    ds_read_b64_tr_b16 a[54:55], v14 offset:25608
    buffer_load_dwordx4 v8, s[20:23], s60 offen offset:3072  lds
    v_mfma_f32_16x16x32_bf16 v[188:191], a[20:23], a[68:71], v[188:191]
    ds_read_b64_tr_b16 a[56:57], v15 offset:24576
    v_mfma_f32_16x16x32_bf16 v[184:187], a[20:23], a[64:67], v[184:187]
    ds_read_b64_tr_b16 a[58:59], v15 offset:25600
    v_mfma_f32_16x16x32_bf16 v[208:211], a[24:27], a[64:67], v[208:211]
    ds_read_b64_tr_b16 a[60:61], v15 offset:24584
    s_add_u32 m0, s59, 12288
    s_nop 0
    buffer_load_dwordx4 v5, s[20:23], s61 offen offset:0  lds
    v_mfma_f32_16x16x32_bf16 v[212:215], a[24:27], a[68:71], v[212:215]
    ds_read_b64_tr_b16 a[62:63], v15 offset:25608
    v_mfma_f32_16x16x32_bf16 v[216:219], a[24:27], a[72:75], v[216:219]
    v_mfma_f32_16x16x32_bf16 v[220:223], a[24:27], a[76:79], v[220:223]
    buffer_load_dwordx4 v6, s[20:23], s61 offen offset:1024  lds
    v_mfma_f32_16x16x32_bf16 v[224:227], a[24:27], a[80:83], v[224:227]
    v_mfma_f32_16x16x32_bf16 v[228:231], a[24:27], a[84:87], v[228:231]
    v_mfma_f32_16x16x32_bf16 v[252:255], a[28:31], a[84:87], v[252:255]
    buffer_load_dwordx4 v7, s[20:23], s61 offen offset:2048  lds
    v_mfma_f32_16x16x32_bf16 v[248:251], a[28:31], a[80:83], v[248:251]
    v_mfma_f32_16x16x32_bf16 v[244:247], a[28:31], a[76:79], v[244:247]
    v_mfma_f32_16x16x32_bf16 v[240:243], a[28:31], a[72:75], v[240:243]
    v_mfma_f32_16x16x32_bf16 v[236:239], a[28:31], a[68:71], v[236:239]
    buffer_load_dwordx4 v8, s[20:23], s61 offen offset:3072  lds
    s_add_u32 s73, s73, 524288
    s_and_b32 s73, s73, 0x3fffff
    v_mfma_f32_16x16x32_bf16 v[232:235], a[28:31], a[64:67], v[232:235]
    s_waitcnt vmcnt(16) lgkmcnt(0)
    s_barrier
    s_waitcnt vmcnt(8)
    v_mfma_f32_16x16x32_bf16 v[64:67], a[32:35], a[88:91], v[64:67]
    ds_read_b64_tr_b16 a[0:1], v12 offset:0
    v_mfma_f32_16x16x32_bf16 v[68:71], a[32:35], a[92:95], v[68:71]
    ds_read_b64_tr_b16 a[2:3], v12 offset:1024
    v_mfma_f32_16x16x32_bf16 v[72:75], a[32:35], a[96:99], v[72:75]
    ds_read_b64_tr_b16 a[4:5], v12 offset:8
    s_add_u32 s60, s73, s75
    s_or_b32 s61, s60, 131072
    s_add_u32 m0, s59, 16384
    s_nop 0
    buffer_load_dwordx4 v5, s[20:23], s60 offen offset:0  lds
    v_mfma_f32_16x16x32_bf16 v[76:79], a[32:35], a[100:103], v[76:79]
    ds_read_b64_tr_b16 a[6:7], v12 offset:1032
    v_mfma_f32_16x16x32_bf16 v[80:83], a[32:35], a[104:107], v[80:83]
    ds_read_b64_tr_b16 a[8:9], v13 offset:0
    v_mfma_f32_16x16x32_bf16 v[84:87], a[32:35], a[108:111], v[84:87]
    ds_read_b64_tr_b16 a[10:11], v13 offset:1024
    v_mfma_f32_16x16x32_bf16 v[108:111], a[36:39], a[108:111], v[108:111]
    ds_read_b64_tr_b16 a[12:13], v13 offset:8
    v_mfma_f32_16x16x32_bf16 v[104:107], a[36:39], a[104:107], v[104:107]
    ds_read_b64_tr_b16 a[14:15], v13 offset:1032
    buffer_load_dwordx4 v6, s[20:23], s60 offen offset:1024  lds
    v_mfma_f32_16x16x32_bf16 v[100:103], a[36:39], a[100:103], v[100:103]
    ds_read_b64_tr_b16 a[16:17], v14 offset:0
    v_mfma_f32_16x16x32_bf16 v[96:99], a[36:39], a[96:99], v[96:99]
    ds_read_b64_tr_b16 a[18:19], v14 offset:1024
    v_mfma_f32_16x16x32_bf16 v[92:95], a[36:39], a[92:95], v[92:95]
    ds_read_b64_tr_b16 a[20:21], v14 offset:8
    v_mfma_f32_16x16x32_bf16 v[88:91], a[36:39], a[88:91], v[88:91]
    ds_read_b64_tr_b16 a[22:23], v14 offset:1032
    v_mfma_f32_16x16x32_bf16 v[112:115], a[40:43], a[88:91], v[112:115]
    ds_read_b64_tr_b16 a[24:25], v15 offset:0
    buffer_load_dwordx4 v7, s[20:23], s60 offen offset:2048  lds
    v_mfma_f32_16x16x32_bf16 v[116:119], a[40:43], a[92:95], v[116:119]
    ds_read_b64_tr_b16 a[26:27], v15 offset:1024
    v_mfma_f32_16x16x32_bf16 v[120:123], a[40:43], a[96:99], v[120:123]
    ds_read_b64_tr_b16 a[28:29], v15 offset:8
    v_mfma_f32_16x16x32_bf16 v[124:127], a[40:43], a[100:103], v[124:127]
    ds_read_b64_tr_b16 a[30:31], v15 offset:1032
    v_mfma_f32_16x16x32_bf16 v[128:131], a[40:43], a[104:107], v[128:131]
    ds_read_b128 a[64:67], v16 offset:0
    v_mfma_f32_16x16x32_bf16 v[132:135], a[40:43], a[108:111], v[132:135]
    ds_read_b128 a[68:71], v16 offset:2048
    v_mfma_f32_16x16x32_bf16 v[156:159], a[44:47], a[108:111], v[156:159]
    ds_read_b128 a[72:75], v16 offset:4096
    buffer_load_dwordx4 v8, s[20:23], s60 offen offset:3072  lds
    v_mfma_f32_16x16x32_bf16 v[152:155], a[44:47], a[104:107], v[152:155]
    ds_read_b128 a[76:79], v16 offset:6144
    v_mfma_f32_16x16x32_bf16 v[148:151], a[44:47], a[100:103], v[148:151]
    ds_read_b128 a[80:83], v16 offset:8192
    v_mfma_f32_16x16x32_bf16 v[144:147], a[44:47], a[96:99], v[144:147]
    ds_read_b128 a[84:87], v16 offset:10240
    v_mfma_f32_16x16x32_bf16 v[140:143], a[44:47], a[92:95], v[140:143]
    s_add_u32 m0, s59, 20480
    v_mfma_f32_16x16x32_bf16 v[136:139], a[44:47], a[88:91], v[136:139]
    buffer_load_dwordx4 v5, s[20:23], s61 offen offset:0  lds
    v_mfma_f32_16x16x32_bf16 v[160:163], a[48:51], a[88:91], v[160:163]
    v_mfma_f32_16x16x32_bf16 v[164:167], a[48:51], a[92:95], v[164:167]
    v_mfma_f32_16x16x32_bf16 v[168:171], a[48:51], a[96:99], v[168:171]
    v_mfma_f32_16x16x32_bf16 v[172:175], a[48:51], a[100:103], v[172:175]
    v_mfma_f32_16x16x32_bf16 v[176:179], a[48:51], a[104:107], v[176:179]
    v_mfma_f32_16x16x32_bf16 v[180:183], a[48:51], a[108:111], v[180:183]
    buffer_load_dwordx4 v6, s[20:23], s61 offen offset:1024  lds
    v_mfma_f32_16x16x32_bf16 v[204:207], a[52:55], a[108:111], v[204:207]
    v_mfma_f32_16x16x32_bf16 v[200:203], a[52:55], a[104:107], v[200:203]
    v_mfma_f32_16x16x32_bf16 v[196:199], a[52:55], a[100:103], v[196:199]
    v_mfma_f32_16x16x32_bf16 v[192:195], a[52:55], a[96:99], v[192:195]
    v_mfma_f32_16x16x32_bf16 v[188:191], a[52:55], a[92:95], v[188:191]
    buffer_load_dwordx4 v7, s[20:23], s61 offen offset:2048  lds
    v_mfma_f32_16x16x32_bf16 v[184:187], a[52:55], a[88:91], v[184:187]
    v_mfma_f32_16x16x32_bf16 v[208:211], a[56:59], a[88:91], v[208:211]
    v_mfma_f32_16x16x32_bf16 v[212:215], a[56:59], a[92:95], v[212:215]
    v_mfma_f32_16x16x32_bf16 v[216:219], a[56:59], a[96:99], v[216:219]
    v_mfma_f32_16x16x32_bf16 v[220:223], a[56:59], a[100:103], v[220:223]
    v_mfma_f32_16x16x32_bf16 v[224:227], a[56:59], a[104:107], v[224:227]
    buffer_load_dwordx4 v8, s[20:23], s61 offen offset:3072  lds
    v_mfma_f32_16x16x32_bf16 v[228:231], a[56:59], a[108:111], v[228:231]
    s_add_u32 m0, s66, 12288
    v_mfma_f32_16x16x32_bf16 v[252:255], a[60:63], a[108:111], v[252:255]
    buffer_load_dwordx4 v2, s[8:11], s62 offen offset:0  lds
    v_mfma_f32_16x16x32_bf16 v[248:251], a[60:63], a[104:107], v[248:251]
    v_mfma_f32_16x16x32_bf16 v[244:247], a[60:63], a[100:103], v[244:247]
    buffer_load_dwordx4 v3, s[8:11], s62 offen offset:1024  lds
    v_mfma_f32_16x16x32_bf16 v[240:243], a[60:63], a[96:99], v[240:243]
    v_mfma_f32_16x16x32_bf16 v[236:239], a[60:63], a[92:95], v[236:239]
    buffer_load_dwordx4 v4, s[8:11], s62 offen offset:2048  lds
    s_add_u32 s62, s62, 128
    s_and_b32 s62, s62, 1023
    v_mfma_f32_16x16x32_bf16 v[232:235], a[60:63], a[88:91], v[232:235]
    s_waitcnt lgkmcnt(0)
    s_waitcnt vmcnt(11)
    v_mfma_f32_16x16x32_bf16 v[64:67], a[0:3], a[64:67], v[64:67]
    ds_read_b64_tr_b16 a[32:33], v12 offset:8192
    v_mfma_f32_16x16x32_bf16 v[68:71], a[0:3], a[68:71], v[68:71]
    ds_read_b64_tr_b16 a[34:35], v12 offset:9216
    v_mfma_f32_16x16x32_bf16 v[72:75], a[0:3], a[72:75], v[72:75]
    ds_read_b64_tr_b16 a[36:37], v12 offset:8200
    s_add_u32 s60, s73, s100
    s_or_b32 s61, s60, 131072
    s_add_u32 m0, s59, 24576
    s_nop 0
    buffer_load_dwordx4 v5, s[20:23], s60 offen offset:0  lds
    v_mfma_f32_16x16x32_bf16 v[76:79], a[0:3], a[76:79], v[76:79]
    ds_read_b64_tr_b16 a[38:39], v12 offset:9224
    v_mfma_f32_16x16x32_bf16 v[80:83], a[0:3], a[80:83], v[80:83]
    ds_read_b64_tr_b16 a[40:41], v13 offset:8192
    v_mfma_f32_16x16x32_bf16 v[84:87], a[0:3], a[84:87], v[84:87]
    ds_read_b64_tr_b16 a[42:43], v13 offset:9216
    v_mfma_f32_16x16x32_bf16 v[108:111], a[4:7], a[84:87], v[108:111]
    ds_read_b64_tr_b16 a[44:45], v13 offset:8200
    v_mfma_f32_16x16x32_bf16 v[104:107], a[4:7], a[80:83], v[104:107]
    ds_read_b64_tr_b16 a[46:47], v13 offset:9224
    v_mfma_f32_16x16x32_bf16 v[100:103], a[4:7], a[76:79], v[100:103]
    ds_read_b64_tr_b16 a[48:49], v14 offset:8192
    buffer_load_dwordx4 v6, s[20:23], s60 offen offset:1024  lds
    v_mfma_f32_16x16x32_bf16 v[96:99], a[4:7], a[72:75], v[96:99]
    ds_read_b64_tr_b16 a[50:51], v14 offset:9216
    v_mfma_f32_16x16x32_bf16 v[92:95], a[4:7], a[68:71], v[92:95]
    ds_read_b64_tr_b16 a[52:53], v14 offset:8200
    v_mfma_f32_16x16x32_bf16 v[88:91], a[4:7], a[64:67], v[88:91]
    ds_read_b64_tr_b16 a[54:55], v14 offset:9224
    v_mfma_f32_16x16x32_bf16 v[112:115], a[8:11], a[64:67], v[112:115]
    ds_read_b64_tr_b16 a[56:57], v15 offset:8192
    v_mfma_f32_16x16x32_bf16 v[116:119], a[8:11], a[68:71], v[116:119]
    ds_read_b64_tr_b16 a[58:59], v15 offset:9216
    v_mfma_f32_16x16x32_bf16 v[120:123], a[8:11], a[72:75], v[120:123]
    ds_read_b64_tr_b16 a[60:61], v15 offset:8200
    buffer_load_dwordx4 v7, s[20:23], s60 offen offset:2048  lds
    v_mfma_f32_16x16x32_bf16 v[124:127], a[8:11], a[76:79], v[124:127]
    ds_read_b64_tr_b16 a[62:63], v15 offset:9224
    v_mfma_f32_16x16x32_bf16 v[128:131], a[8:11], a[80:83], v[128:131]
    ds_read_b128 a[88:91], v17 offset:0
    v_mfma_f32_16x16x32_bf16 v[132:135], a[8:11], a[84:87], v[132:135]
    ds_read_b128 a[92:95], v17 offset:2048
    v_mfma_f32_16x16x32_bf16 v[156:159], a[12:15], a[84:87], v[156:159]
    ds_read_b128 a[96:99], v17 offset:4096
    v_mfma_f32_16x16x32_bf16 v[152:155], a[12:15], a[80:83], v[152:155]
    ds_read_b128 a[100:103], v17 offset:6144
    v_mfma_f32_16x16x32_bf16 v[148:151], a[12:15], a[76:79], v[148:151]
    ds_read_b128 a[104:107], v17 offset:8192
    buffer_load_dwordx4 v8, s[20:23], s60 offen offset:3072  lds
    v_mfma_f32_16x16x32_bf16 v[144:147], a[12:15], a[72:75], v[144:147]
    ds_read_b128 a[108:111], v17 offset:10240
    v_mfma_f32_16x16x32_bf16 v[140:143], a[12:15], a[68:71], v[140:143]
    v_mfma_f32_16x16x32_bf16 v[136:139], a[12:15], a[64:67], v[136:139]
    v_mfma_f32_16x16x32_bf16 v[160:163], a[16:19], a[64:67], v[160:163]
    v_mfma_f32_16x16x32_bf16 v[164:167], a[16:19], a[68:71], v[164:167]
    v_mfma_f32_16x16x32_bf16 v[168:171], a[16:19], a[72:75], v[168:171]
    s_add_u32 m0, s59, 28672
    v_mfma_f32_16x16x32_bf16 v[172:175], a[16:19], a[76:79], v[172:175]
    buffer_load_dwordx4 v5, s[20:23], s61 offen offset:0  lds
    v_mfma_f32_16x16x32_bf16 v[176:179], a[16:19], a[80:83], v[176:179]
    v_mfma_f32_16x16x32_bf16 v[180:183], a[16:19], a[84:87], v[180:183]
    v_mfma_f32_16x16x32_bf16 v[204:207], a[20:23], a[84:87], v[204:207]
    v_mfma_f32_16x16x32_bf16 v[200:203], a[20:23], a[80:83], v[200:203]
    v_mfma_f32_16x16x32_bf16 v[196:199], a[20:23], a[76:79], v[196:199]
    v_mfma_f32_16x16x32_bf16 v[192:195], a[20:23], a[72:75], v[192:195]
    buffer_load_dwordx4 v6, s[20:23], s61 offen offset:1024  lds
    v_mfma_f32_16x16x32_bf16 v[188:191], a[20:23], a[68:71], v[188:191]
    v_mfma_f32_16x16x32_bf16 v[184:187], a[20:23], a[64:67], v[184:187]
    v_mfma_f32_16x16x32_bf16 v[208:211], a[24:27], a[64:67], v[208:211]
    v_mfma_f32_16x16x32_bf16 v[212:215], a[24:27], a[68:71], v[212:215]
    v_mfma_f32_16x16x32_bf16 v[216:219], a[24:27], a[72:75], v[216:219]
    v_mfma_f32_16x16x32_bf16 v[220:223], a[24:27], a[76:79], v[220:223]
    buffer_load_dwordx4 v7, s[20:23], s61 offen offset:2048  lds
    v_mfma_f32_16x16x32_bf16 v[224:227], a[24:27], a[80:83], v[224:227]
    v_mfma_f32_16x16x32_bf16 v[228:231], a[24:27], a[84:87], v[228:231]
    v_mfma_f32_16x16x32_bf16 v[252:255], a[28:31], a[84:87], v[252:255]
    v_mfma_f32_16x16x32_bf16 v[248:251], a[28:31], a[80:83], v[248:251]
    v_mfma_f32_16x16x32_bf16 v[244:247], a[28:31], a[76:79], v[244:247]
    v_mfma_f32_16x16x32_bf16 v[240:243], a[28:31], a[72:75], v[240:243]
    v_mfma_f32_16x16x32_bf16 v[236:239], a[28:31], a[68:71], v[236:239]
    buffer_load_dwordx4 v8, s[20:23], s61 offen offset:3072  lds
    s_add_u32 s73, s73, 524288
    s_and_b32 s73, s73, 0x3fffff
    v_mfma_f32_16x16x32_bf16 v[232:235], a[28:31], a[64:67], v[232:235]
    s_waitcnt vmcnt(8) lgkmcnt(0)
    s_barrier
    v_mfma_f32_16x16x32_bf16 v[64:67], a[32:35], a[88:91], v[64:67]
    ds_read_b64_tr_b16 a[0:1], v12 offset:16384
    s_add_u32 s60, s73, s75
    s_or_b32 s61, s60, 131072
    s_add_u32 m0, s59, 0
    s_nop 0
    buffer_load_dwordx4 v5, s[20:23], s60 offen offset:0  lds
    v_mfma_f32_16x16x32_bf16 v[68:71], a[32:35], a[92:95], v[68:71]
    ds_read_b64_tr_b16 a[2:3], v12 offset:17408
    v_mfma_f32_16x16x32_bf16 v[72:75], a[32:35], a[96:99], v[72:75]
    ds_read_b64_tr_b16 a[4:5], v12 offset:16392
    buffer_load_dwordx4 v6, s[20:23], s60 offen offset:1024  lds
    v_mfma_f32_16x16x32_bf16 v[76:79], a[32:35], a[100:103], v[76:79]
    ds_read_b64_tr_b16 a[6:7], v12 offset:17416
    v_mfma_f32_16x16x32_bf16 v[80:83], a[32:35], a[104:107], v[80:83]
    ds_read_b64_tr_b16 a[8:9], v13 offset:16384
    buffer_load_dwordx4 v7, s[20:23], s60 offen offset:2048  lds
    v_mfma_f32_16x16x32_bf16 v[84:87], a[32:35], a[108:111], v[84:87]
    ds_read_b64_tr_b16 a[10:11], v13 offset:17408
    v_mfma_f32_16x16x32_bf16 v[108:111], a[36:39], a[108:111], v[108:111]
    ds_read_b64_tr_b16 a[12:13], v13 offset:16392
    buffer_load_dwordx4 v8, s[20:23], s60 offen offset:3072  lds
    v_mfma_f32_16x16x32_bf16 v[104:107], a[36:39], a[104:107], v[104:107]
    ds_read_b64_tr_b16 a[14:15], v13 offset:17416
    v_mfma_f32_16x16x32_bf16 v[100:103], a[36:39], a[100:103], v[100:103]
    ds_read_b64_tr_b16 a[16:17], v14 offset:16384
    s_add_u32 m0, s59, 4096
    s_nop 0
    buffer_load_dwordx4 v5, s[20:23], s61 offen offset:0  lds
    v_mfma_f32_16x16x32_bf16 v[96:99], a[36:39], a[96:99], v[96:99]
    ds_read_b64_tr_b16 a[18:19], v14 offset:17408
    v_mfma_f32_16x16x32_bf16 v[92:95], a[36:39], a[92:95], v[92:95]
    ds_read_b64_tr_b16 a[20:21], v14 offset:16392
    buffer_load_dwordx4 v6, s[20:23], s61 offen offset:1024  lds
    v_mfma_f32_16x16x32_bf16 v[88:91], a[36:39], a[88:91], v[88:91]
    ds_read_b64_tr_b16 a[22:23], v14 offset:17416
    v_mfma_f32_16x16x32_bf16 v[112:115], a[40:43], a[88:91], v[112:115]
    ds_read_b64_tr_b16 a[24:25], v15 offset:16384
    buffer_load_dwordx4 v7, s[20:23], s61 offen offset:2048  lds
    v_mfma_f32_16x16x32_bf16 v[116:119], a[40:43], a[92:95], v[116:119]
    ds_read_b64_tr_b16 a[26:27], v15 offset:17408
    v_mfma_f32_16x16x32_bf16 v[120:123], a[40:43], a[96:99], v[120:123]
    ds_read_b64_tr_b16 a[28:29], v15 offset:16392
    buffer_load_dwordx4 v8, s[20:23], s61 offen offset:3072  lds
    v_mfma_f32_16x16x32_bf16 v[124:127], a[40:43], a[100:103], v[124:127]
    ds_read_b64_tr_b16 a[30:31], v15 offset:17416
    v_mfma_f32_16x16x32_bf16 v[128:131], a[40:43], a[104:107], v[128:131]
    ds_read_b128 a[64:67], v16 offset:12288
    s_mov_b32 s64, 0
    s_add_u32 m0, s59, 8192
    s_nop 0
    buffer_load_dwordx4 v32, s[12:15], s64 offen offset:0 nt lds
    v_mfma_f32_16x16x32_bf16 v[132:135], a[40:43], a[108:111], v[132:135]
    ds_read_b128 a[68:71], v16 offset:14336
    v_mfma_f32_16x16x32_bf16 v[156:159], a[44:47], a[108:111], v[156:159]
    ds_read_b128 a[72:75], v16 offset:16384
    buffer_load_dwordx4 v33, s[12:15], s64 offen offset:1024 nt lds
    v_mfma_f32_16x16x32_bf16 v[152:155], a[44:47], a[104:107], v[152:155]
    ds_read_b128 a[76:79], v16 offset:18432
    v_mfma_f32_16x16x32_bf16 v[148:151], a[44:47], a[100:103], v[148:151]
    ds_read_b128 a[80:83], v16 offset:20480
    buffer_load_dwordx4 v34, s[12:15], s64 offen offset:2048 nt lds
    v_mfma_f32_16x16x32_bf16 v[144:147], a[44:47], a[96:99], v[144:147]
    ds_read_b128 a[84:87], v16 offset:22528
    v_mfma_f32_16x16x32_bf16 v[140:143], a[44:47], a[92:95], v[140:143]
    buffer_load_dwordx4 v35, s[12:15], s64 offen offset:3072 nt lds
    v_mfma_f32_16x16x32_bf16 v[136:139], a[44:47], a[88:91], v[136:139]
    v_mfma_f32_16x16x32_bf16 v[160:163], a[48:51], a[88:91], v[160:163]
    s_mov_b32 s64, 4096
    s_add_u32 m0, s59, 12288
    s_nop 0
    buffer_load_dwordx4 v32, s[12:15], s64 offen offset:0 nt lds
    v_mfma_f32_16x16x32_bf16 v[164:167], a[48:51], a[92:95], v[164:167]
    v_mfma_f32_16x16x32_bf16 v[168:171], a[48:51], a[96:99], v[168:171]
    buffer_load_dwordx4 v33, s[12:15], s64 offen offset:1024 nt lds
    v_mfma_f32_16x16x32_bf16 v[172:175], a[48:51], a[100:103], v[172:175]
    v_mfma_f32_16x16x32_bf16 v[176:179], a[48:51], a[104:107], v[176:179]
    buffer_load_dwordx4 v34, s[12:15], s64 offen offset:2048 nt lds
    v_mfma_f32_16x16x32_bf16 v[180:183], a[48:51], a[108:111], v[180:183]
    v_mfma_f32_16x16x32_bf16 v[204:207], a[52:55], a[108:111], v[204:207]
    buffer_load_dwordx4 v35, s[12:15], s64 offen offset:3072 nt lds
    v_mfma_f32_16x16x32_bf16 v[200:203], a[52:55], a[104:107], v[200:203]
    v_mfma_f32_16x16x32_bf16 v[196:199], a[52:55], a[100:103], v[196:199]
    v_mfma_f32_16x16x32_bf16 v[192:195], a[52:55], a[96:99], v[192:195]
    v_mfma_f32_16x16x32_bf16 v[188:191], a[52:55], a[92:95], v[188:191]
    v_mfma_f32_16x16x32_bf16 v[184:187], a[52:55], a[88:91], v[184:187]
    v_mfma_f32_16x16x32_bf16 v[208:211], a[56:59], a[88:91], v[208:211]
    v_mfma_f32_16x16x32_bf16 v[212:215], a[56:59], a[92:95], v[212:215]
    v_mfma_f32_16x16x32_bf16 v[216:219], a[56:59], a[96:99], v[216:219]
    v_mfma_f32_16x16x32_bf16 v[220:223], a[56:59], a[100:103], v[220:223]
    v_mfma_f32_16x16x32_bf16 v[224:227], a[56:59], a[104:107], v[224:227]
    v_mfma_f32_16x16x32_bf16 v[228:231], a[56:59], a[108:111], v[228:231]
    s_add_u32 m0, s66, 0
    v_mfma_f32_16x16x32_bf16 v[252:255], a[60:63], a[108:111], v[252:255]
    buffer_load_dwordx4 v2, s[8:11], s62 offen offset:0  lds
    v_mfma_f32_16x16x32_bf16 v[248:251], a[60:63], a[104:107], v[248:251]
    v_mfma_f32_16x16x32_bf16 v[244:247], a[60:63], a[100:103], v[244:247]
    buffer_load_dwordx4 v3, s[8:11], s62 offen offset:1024  lds
    v_mfma_f32_16x16x32_bf16 v[240:243], a[60:63], a[96:99], v[240:243]
    v_mfma_f32_16x16x32_bf16 v[236:239], a[60:63], a[92:95], v[236:239]
    buffer_load_dwordx4 v4, s[8:11], s62 offen offset:2048  lds
    s_add_u32 s62, s62, 128
    s_and_b32 s62, s62, 1023
    v_mfma_f32_16x16x32_bf16 v[232:235], a[60:63], a[88:91], v[232:235]
    s_waitcnt lgkmcnt(0)
    s_waitcnt vmcnt(19)
    v_mfma_f32_16x16x32_bf16 v[64:67], a[0:3], a[64:67], v[64:67]
    ds_read_b64_tr_b16 a[32:33], v12 offset:24576
    v_mfma_f32_16x16x32_bf16 v[68:71], a[0:3], a[68:71], v[68:71]
    ds_read_b64_tr_b16 a[34:35], v12 offset:25600
    v_mfma_f32_16x16x32_bf16 v[72:75], a[0:3], a[72:75], v[72:75]
    ds_read_b64_tr_b16 a[36:37], v12 offset:24584
    v_mfma_f32_16x16x32_bf16 v[76:79], a[0:3], a[76:79], v[76:79]
    ds_read_b64_tr_b16 a[38:39], v12 offset:25608
    v_mfma_f32_16x16x32_bf16 v[80:83], a[0:3], a[80:83], v[80:83]
    ds_read_b64_tr_b16 a[40:41], v13 offset:24576
    v_mfma_f32_16x16x32_bf16 v[84:87], a[0:3], a[84:87], v[84:87]
    ds_read_b64_tr_b16 a[42:43], v13 offset:25600
    v_mfma_f32_16x16x32_bf16 v[108:111], a[4:7], a[84:87], v[108:111]
    ds_read_b64_tr_b16 a[44:45], v13 offset:24584
    v_mfma_f32_16x16x32_bf16 v[104:107], a[4:7], a[80:83], v[104:107]
    ds_read_b64_tr_b16 a[46:47], v13 offset:25608
    v_mfma_f32_16x16x32_bf16 v[100:103], a[4:7], a[76:79], v[100:103]
    ds_read_b64_tr_b16 a[48:49], v14 offset:24576
    v_mfma_f32_16x16x32_bf16 v[96:99], a[4:7], a[72:75], v[96:99]
    ds_read_b64_tr_b16 a[50:51], v14 offset:25600
    v_mfma_f32_16x16x32_bf16 v[92:95], a[4:7], a[68:71], v[92:95]
    ds_read_b64_tr_b16 a[52:53], v14 offset:24584
    v_mfma_f32_16x16x32_bf16 v[88:91], a[4:7], a[64:67], v[88:91]
    ds_read_b64_tr_b16 a[54:55], v14 offset:25608
    v_mfma_f32_16x16x32_bf16 v[112:115], a[8:11], a[64:67], v[112:115]
    ds_read_b64_tr_b16 a[56:57], v15 offset:24576
    v_mfma_f32_16x16x32_bf16 v[116:119], a[8:11], a[68:71], v[116:119]
    ds_read_b64_tr_b16 a[58:59], v15 offset:25600
    v_mfma_f32_16x16x32_bf16 v[120:123], a[8:11], a[72:75], v[120:123]
    ds_read_b64_tr_b16 a[60:61], v15 offset:24584
    v_mfma_f32_16x16x32_bf16 v[124:127], a[8:11], a[76:79], v[124:127]
    ds_read_b64_tr_b16 a[62:63], v15 offset:25608
    v_mfma_f32_16x16x32_bf16 v[128:131], a[8:11], a[80:83], v[128:131]
    ds_read_b128 a[88:91], v17 offset:12288
    v_mfma_f32_16x16x32_bf16 v[132:135], a[8:11], a[84:87], v[132:135]
    ds_read_b128 a[92:95], v17 offset:14336
    v_mfma_f32_16x16x32_bf16 v[156:159], a[12:15], a[84:87], v[156:159]
    ds_read_b128 a[96:99], v17 offset:16384
    v_mfma_f32_16x16x32_bf16 v[152:155], a[12:15], a[80:83], v[152:155]
    ds_read_b128 a[100:103], v17 offset:18432
    v_mfma_f32_16x16x32_bf16 v[148:151], a[12:15], a[76:79], v[148:151]
    ds_read_b128 a[104:107], v17 offset:20480
    v_mfma_f32_16x16x32_bf16 v[144:147], a[12:15], a[72:75], v[144:147]
    ds_read_b128 a[108:111], v17 offset:22528
    v_mfma_f32_16x16x32_bf16 v[140:143], a[12:15], a[68:71], v[140:143]
    s_waitcnt vmcnt(3)
    ds_read_b128 a[112:115], v36 offset:8192
    v_mfma_f32_16x16x32_bf16 v[136:139], a[12:15], a[64:67], v[136:139]
    ds_read_b128 a[116:119], v37 offset:8192
    v_mfma_f32_16x16x32_bf16 v[160:163], a[16:19], a[64:67], v[160:163]
    ds_read_b128 a[120:123], v38 offset:8192
    v_mfma_f32_16x16x32_bf16 v[164:167], a[16:19], a[68:71], v[164:167]
    ds_read_b128 a[124:127], v39 offset:8192
    v_mfma_f32_16x16x32_bf16 v[168:171], a[16:19], a[72:75], v[168:171]
    ds_read_b128 a[128:131], v36 offset:12288
    v_mfma_f32_16x16x32_bf16 v[172:175], a[16:19], a[76:79], v[172:175]
    ds_read_b128 a[132:135], v37 offset:12288
    v_mfma_f32_16x16x32_bf16 v[176:179], a[16:19], a[80:83], v[176:179]
    ds_read_b128 a[136:139], v38 offset:12288
    v_mfma_f32_16x16x32_bf16 v[180:183], a[16:19], a[84:87], v[180:183]
    ds_read_b128 a[140:143], v39 offset:12288
    v_mfma_f32_16x16x32_bf16 v[204:207], a[20:23], a[84:87], v[204:207]
    v_mfma_f32_16x16x32_bf16 v[200:203], a[20:23], a[80:83], v[200:203]
    v_mfma_f32_16x16x32_bf16 v[196:199], a[20:23], a[76:79], v[196:199]
    v_mfma_f32_16x16x32_bf16 v[192:195], a[20:23], a[72:75], v[192:195]
    s_waitcnt lgkmcnt(0)
    v_mfma_f32_16x16x32_bf16 v[188:191], a[20:23], a[68:71], v[188:191]
    s_add_u32 s60, s73, s100
    s_or_b32 s61, s60, 131072
    s_add_u32 m0, s59, 8192
    s_nop 0
    buffer_load_dwordx4 v5, s[20:23], s60 offen offset:0  lds
    v_mfma_f32_16x16x32_bf16 v[184:187], a[20:23], a[64:67], v[184:187]
    buffer_load_dwordx4 v6, s[20:23], s60 offen offset:1024  lds
    v_mfma_f32_16x16x32_bf16 v[208:211], a[24:27], a[64:67], v[208:211]
    v_mfma_f32_16x16x32_bf16 v[212:215], a[24:27], a[68:71], v[212:215]
    buffer_load_dwordx4 v7, s[20:23], s60 offen offset:2048  lds
    v_mfma_f32_16x16x32_bf16 v[216:219], a[24:27], a[72:75], v[216:219]
    v_mfma_f32_16x16x32_bf16 v[220:223], a[24:27], a[76:79], v[220:223]
    buffer_load_dwordx4 v8, s[20:23], s60 offen offset:3072  lds
    v_mfma_f32_16x16x32_bf16 v[224:227], a[24:27], a[80:83], v[224:227]
    s_add_u32 m0, s59, 12288
    v_mfma_f32_16x16x32_bf16 v[228:231], a[24:27], a[84:87], v[228:231]
    buffer_load_dwordx4 v5, s[20:23], s61 offen offset:0  lds
    v_mfma_f32_16x16x32_bf16 v[252:255], a[28:31], a[84:87], v[252:255]
    v_mfma_f32_16x16x32_bf16 v[248:251], a[28:31], a[80:83], v[248:251]
    buffer_load_dwordx4 v6, s[20:23], s61 offen offset:1024  lds
    v_mfma_f32_16x16x32_bf16 v[244:247], a[28:31], a[76:79], v[244:247]
    v_mfma_f32_16x16x32_bf16 v[240:243], a[28:31], a[72:75], v[240:243]
    buffer_load_dwordx4 v7, s[20:23], s61 offen offset:2048  lds
    v_mfma_f32_16x16x32_bf16 v[236:239], a[28:31], a[68:71], v[236:239]
    v_mfma_f32_16x16x32_bf16 v[232:235], a[28:31], a[64:67], v[232:235]
    buffer_load_dwordx4 v8, s[20:23], s61 offen offset:3072  lds
    s_add_u32 s73, s73, 524288
    s_and_b32 s73, s73, 0x3fffff
    s_waitcnt vmcnt(8)
    s_barrier
    v_mfma_f32_16x16x32_bf16 v[64:67], a[32:35], a[88:91], v[64:67]
    ds_read_b64_tr_b16 a[0:1], v12 offset:0
    v_mfma_f32_16x16x32_bf16 v[68:71], a[32:35], a[92:95], v[68:71]
    ds_read_b64_tr_b16 a[2:3], v12 offset:1024
    v_mfma_f32_16x16x32_bf16 v[72:75], a[32:35], a[96:99], v[72:75]
    ds_read_b64_tr_b16 a[4:5], v12 offset:8
    s_add_u32 s60, s73, s75
    s_or_b32 s61, s60, 131072
    s_add_u32 m0, s59, 16384
    s_nop 0
    buffer_load_dwordx4 v5, s[20:23], s60 offen offset:0  lds
    v_mfma_f32_16x16x32_bf16 v[76:79], a[32:35], a[100:103], v[76:79]
    ds_read_b64_tr_b16 a[6:7], v12 offset:1032
    v_mfma_f32_16x16x32_bf16 v[80:83], a[32:35], a[104:107], v[80:83]
    ds_read_b64_tr_b16 a[8:9], v13 offset:0
    v_mfma_f32_16x16x32_bf16 v[84:87], a[32:35], a[108:111], v[84:87]
    ds_read_b64_tr_b16 a[10:11], v13 offset:1024
    v_mfma_f32_16x16x32_bf16 v[108:111], a[36:39], a[108:111], v[108:111]
    ds_read_b64_tr_b16 a[12:13], v13 offset:8
    v_mfma_f32_16x16x32_bf16 v[104:107], a[36:39], a[104:107], v[104:107]
    ds_read_b64_tr_b16 a[14:15], v13 offset:1032
    buffer_load_dwordx4 v6, s[20:23], s60 offen offset:1024  lds
    v_mfma_f32_16x16x32_bf16 v[100:103], a[36:39], a[100:103], v[100:103]
    ds_read_b64_tr_b16 a[16:17], v14 offset:0
    v_mfma_f32_16x16x32_bf16 v[96:99], a[36:39], a[96:99], v[96:99]
    ds_read_b64_tr_b16 a[18:19], v14 offset:1024
    v_mfma_f32_16x16x32_bf16 v[92:95], a[36:39], a[92:95], v[92:95]
    ds_read_b64_tr_b16 a[20:21], v14 offset:8
    v_mfma_f32_16x16x32_bf16 v[88:91], a[36:39], a[88:91], v[88:91]
    ds_read_b64_tr_b16 a[22:23], v14 offset:1032
    v_mfma_f32_16x16x32_bf16 v[112:115], a[40:43], a[88:91], v[112:115]
    ds_read_b64_tr_b16 a[24:25], v15 offset:0
    buffer_load_dwordx4 v7, s[20:23], s60 offen offset:2048  lds
    v_mfma_f32_16x16x32_bf16 v[116:119], a[40:43], a[92:95], v[116:119]
    ds_read_b64_tr_b16 a[26:27], v15 offset:1024
    v_mfma_f32_16x16x32_bf16 v[120:123], a[40:43], a[96:99], v[120:123]
    ds_read_b64_tr_b16 a[28:29], v15 offset:8
    v_mfma_f32_16x16x32_bf16 v[124:127], a[40:43], a[100:103], v[124:127]
    ds_read_b64_tr_b16 a[30:31], v15 offset:1032
    v_mfma_f32_16x16x32_bf16 v[128:131], a[40:43], a[104:107], v[128:131]
    ds_read_b128 a[64:67], v16 offset:0
    v_mfma_f32_16x16x32_bf16 v[132:135], a[40:43], a[108:111], v[132:135]
    ds_read_b128 a[68:71], v16 offset:2048
    v_mfma_f32_16x16x32_bf16 v[156:159], a[44:47], a[108:111], v[156:159]
    ds_read_b128 a[72:75], v16 offset:4096
    buffer_load_dwordx4 v8, s[20:23], s60 offen offset:3072  lds
    v_mfma_f32_16x16x32_bf16 v[152:155], a[44:47], a[104:107], v[152:155]
    ds_read_b128 a[76:79], v16 offset:6144
    v_mfma_f32_16x16x32_bf16 v[148:151], a[44:47], a[100:103], v[148:151]
    ds_read_b128 a[80:83], v16 offset:8192
    v_mfma_f32_16x16x32_bf16 v[144:147], a[44:47], a[96:99], v[144:147]
    ds_read_b128 a[84:87], v16 offset:10240
    v_mfma_f32_16x16x32_bf16 v[140:143], a[44:47], a[92:95], v[140:143]
    s_add_u32 m0, s59, 20480
    v_mfma_f32_16x16x32_bf16 v[136:139], a[44:47], a[88:91], v[136:139]
    buffer_load_dwordx4 v5, s[20:23], s61 offen offset:0  lds
    v_mfma_f32_16x16x32_bf16 v[160:163], a[48:51], a[88:91], v[160:163]
    v_mfma_f32_16x16x32_bf16 v[164:167], a[48:51], a[92:95], v[164:167]
    v_mfma_f32_16x16x32_bf16 v[168:171], a[48:51], a[96:99], v[168:171]
    v_mfma_f32_16x16x32_bf16 v[172:175], a[48:51], a[100:103], v[172:175]
    v_mfma_f32_16x16x32_bf16 v[176:179], a[48:51], a[104:107], v[176:179]
    v_mfma_f32_16x16x32_bf16 v[180:183], a[48:51], a[108:111], v[180:183]
    buffer_load_dwordx4 v6, s[20:23], s61 offen offset:1024  lds
    v_mfma_f32_16x16x32_bf16 v[204:207], a[52:55], a[108:111], v[204:207]
    v_mfma_f32_16x16x32_bf16 v[200:203], a[52:55], a[104:107], v[200:203]
    v_mfma_f32_16x16x32_bf16 v[196:199], a[52:55], a[100:103], v[196:199]
    v_mfma_f32_16x16x32_bf16 v[192:195], a[52:55], a[96:99], v[192:195]
    v_mfma_f32_16x16x32_bf16 v[188:191], a[52:55], a[92:95], v[188:191]
    buffer_load_dwordx4 v7, s[20:23], s61 offen offset:2048  lds
    v_mfma_f32_16x16x32_bf16 v[184:187], a[52:55], a[88:91], v[184:187]
    v_mfma_f32_16x16x32_bf16 v[208:211], a[56:59], a[88:91], v[208:211]
    v_mfma_f32_16x16x32_bf16 v[212:215], a[56:59], a[92:95], v[212:215]
    v_mfma_f32_16x16x32_bf16 v[216:219], a[56:59], a[96:99], v[216:219]
    v_mfma_f32_16x16x32_bf16 v[220:223], a[56:59], a[100:103], v[220:223]
    v_mfma_f32_16x16x32_bf16 v[224:227], a[56:59], a[104:107], v[224:227]
    buffer_load_dwordx4 v8, s[20:23], s61 offen offset:3072  lds
    v_mfma_f32_16x16x32_bf16 v[228:231], a[56:59], a[108:111], v[228:231]
    s_add_u32 m0, s66, 12288
    v_mfma_f32_16x16x32_bf16 v[252:255], a[60:63], a[108:111], v[252:255]
    buffer_load_dwordx4 v2, s[8:11], s62 offen offset:0  lds
    v_mfma_f32_16x16x32_bf16 v[248:251], a[60:63], a[104:107], v[248:251]
    v_mfma_f32_16x16x32_bf16 v[244:247], a[60:63], a[100:103], v[244:247]
    buffer_load_dwordx4 v3, s[8:11], s62 offen offset:1024  lds
    v_mfma_f32_16x16x32_bf16 v[240:243], a[60:63], a[96:99], v[240:243]
    v_mfma_f32_16x16x32_bf16 v[236:239], a[60:63], a[92:95], v[236:239]
    buffer_load_dwordx4 v4, s[8:11], s62 offen offset:2048  lds
    s_add_u32 s62, s62, 128
    s_and_b32 s62, s62, 1023
    v_mfma_f32_16x16x32_bf16 v[232:235], a[60:63], a[88:91], v[232:235]
    s_waitcnt lgkmcnt(0)
    s_waitcnt vmcnt(11)
    v_mfma_f32_16x16x32_bf16 v[64:67], a[0:3], a[64:67], v[64:67]
    ds_read_b64_tr_b16 a[32:33], v12 offset:8192
    s_add_u32 s60, s73, s100
    s_or_b32 s61, s60, 131072
    s_add_u32 m0, s59, 24576
    s_nop 0
    buffer_load_dwordx4 v5, s[20:23], s60 offen offset:0  lds
    v_mfma_f32_16x16x32_bf16 v[68:71], a[0:3], a[68:71], v[68:71]
    ds_read_b64_tr_b16 a[34:35], v12 offset:9216
    v_mfma_f32_16x16x32_bf16 v[72:75], a[0:3], a[72:75], v[72:75]
    ds_read_b64_tr_b16 a[36:37], v12 offset:8200
    buffer_load_dwordx4 v6, s[20:23], s60 offen offset:1024  lds
    v_mfma_f32_16x16x32_bf16 v[76:79], a[0:3], a[76:79], v[76:79]
    ds_read_b64_tr_b16 a[38:39], v12 offset:9224
    v_mfma_f32_16x16x32_bf16 v[80:83], a[0:3], a[80:83], v[80:83]
    ds_read_b64_tr_b16 a[40:41], v13 offset:8192
    buffer_load_dwordx4 v7, s[20:23], s60 offen offset:2048  lds
    v_mfma_f32_16x16x32_bf16 v[84:87], a[0:3], a[84:87], v[84:87]
    ds_read_b64_tr_b16 a[42:43], v13 offset:9216
    v_mfma_f32_16x16x32_bf16 v[108:111], a[4:7], a[84:87], v[108:111]
    ds_read_b64_tr_b16 a[44:45], v13 offset:8200
    buffer_load_dwordx4 v8, s[20:23], s60 offen offset:3072  lds
    v_mfma_f32_16x16x32_bf16 v[104:107], a[4:7], a[80:83], v[104:107]
    ds_read_b64_tr_b16 a[46:47], v13 offset:9224
    v_mfma_f32_16x16x32_bf16 v[100:103], a[4:7], a[76:79], v[100:103]
    ds_read_b64_tr_b16 a[48:49], v14 offset:8192
    s_add_u32 m0, s59, 28672
    s_nop 0
    buffer_load_dwordx4 v5, s[20:23], s61 offen offset:0  lds
    v_mfma_f32_16x16x32_bf16 v[96:99], a[4:7], a[72:75], v[96:99]
    ds_read_b64_tr_b16 a[50:51], v14 offset:9216
    v_mfma_f32_16x16x32_bf16 v[92:95], a[4:7], a[68:71], v[92:95]
    ds_read_b64_tr_b16 a[52:53], v14 offset:8200
    buffer_load_dwordx4 v6, s[20:23], s61 offen offset:1024  lds
    v_mfma_f32_16x16x32_bf16 v[88:91], a[4:7], a[64:67], v[88:91]
    ds_read_b64_tr_b16 a[54:55], v14 offset:9224
    v_mfma_f32_16x16x32_bf16 v[112:115], a[8:11], a[64:67], v[112:115]
    ds_read_b64_tr_b16 a[56:57], v15 offset:8192
    buffer_load_dwordx4 v7, s[20:23], s61 offen offset:2048  lds
    v_mfma_f32_16x16x32_bf16 v[116:119], a[8:11], a[68:71], v[116:119]
    ds_read_b64_tr_b16 a[58:59], v15 offset:9216
    v_mfma_f32_16x16x32_bf16 v[120:123], a[8:11], a[72:75], v[120:123]
    ds_read_b64_tr_b16 a[60:61], v15 offset:8200
    buffer_load_dwordx4 v8, s[20:23], s61 offen offset:3072  lds
    s_add_u32 s73, s73, 524288
    s_and_b32 s73, s73, 0x3fffff
    v_mfma_f32_16x16x32_bf16 v[124:127], a[8:11], a[76:79], v[124:127]
    ds_read_b64_tr_b16 a[62:63], v15 offset:9224
    v_mfma_f32_16x16x32_bf16 v[128:131], a[8:11], a[80:83], v[128:131]
    ds_read_b128 a[88:91], v17 offset:0
    s_mov_b32 s64, 8192
    s_add_u32 m0, s59, 0
    s_nop 0
    buffer_load_dwordx4 v32, s[12:15], s64 offen offset:0 nt lds
    v_mfma_f32_16x16x32_bf16 v[132:135], a[8:11], a[84:87], v[132:135]
    ds_read_b128 a[92:95], v17 offset:2048
    v_mfma_f32_16x16x32_bf16 v[156:159], a[12:15], a[84:87], v[156:159]
    ds_read_b128 a[96:99], v17 offset:4096
    buffer_load_dwordx4 v33, s[12:15], s64 offen offset:1024 nt lds
    v_mfma_f32_16x16x32_bf16 v[152:155], a[12:15], a[80:83], v[152:155]
    ds_read_b128 a[100:103], v17 offset:6144
    v_mfma_f32_16x16x32_bf16 v[148:151], a[12:15], a[76:79], v[148:151]
    ds_read_b128 a[104:107], v17 offset:8192
    buffer_load_dwordx4 v34, s[12:15], s64 offen offset:2048 nt lds
    v_mfma_f32_16x16x32_bf16 v[144:147], a[12:15], a[72:75], v[144:147]
    ds_read_b128 a[108:111], v17 offset:10240
    v_mfma_f32_16x16x32_bf16 v[140:143], a[12:15], a[68:71], v[140:143]
    buffer_load_dwordx4 v35, s[12:15], s64 offen offset:3072 nt lds
    v_mfma_f32_16x16x32_bf16 v[136:139], a[12:15], a[64:67], v[136:139]
    v_mfma_f32_16x16x32_bf16 v[160:163], a[16:19], a[64:67], v[160:163]
    s_mov_b32 s64, 12288
    s_add_u32 m0, s59, 4096
    s_nop 0
    buffer_load_dwordx4 v32, s[12:15], s64 offen offset:0 nt lds
    v_mfma_f32_16x16x32_bf16 v[164:167], a[16:19], a[68:71], v[164:167]
    v_mfma_f32_16x16x32_bf16 v[168:171], a[16:19], a[72:75], v[168:171]
    buffer_load_dwordx4 v33, s[12:15], s64 offen offset:1024 nt lds
    v_mfma_f32_16x16x32_bf16 v[172:175], a[16:19], a[76:79], v[172:175]
    v_mfma_f32_16x16x32_bf16 v[176:179], a[16:19], a[80:83], v[176:179]
    buffer_load_dwordx4 v34, s[12:15], s64 offen offset:2048 nt lds
    v_mfma_f32_16x16x32_bf16 v[180:183], a[16:19], a[84:87], v[180:183]
    v_mfma_f32_16x16x32_bf16 v[204:207], a[20:23], a[84:87], v[204:207]
    buffer_load_dwordx4 v35, s[12:15], s64 offen offset:3072 nt lds
    v_mfma_f32_16x16x32_bf16 v[200:203], a[20:23], a[80:83], v[200:203]
    v_mfma_f32_16x16x32_bf16 v[196:199], a[20:23], a[76:79], v[196:199]
    v_mfma_f32_16x16x32_bf16 v[192:195], a[20:23], a[72:75], v[192:195]
    v_mfma_f32_16x16x32_bf16 v[188:191], a[20:23], a[68:71], v[188:191]
    v_mfma_f32_16x16x32_bf16 v[184:187], a[20:23], a[64:67], v[184:187]
    v_mfma_f32_16x16x32_bf16 v[208:211], a[24:27], a[64:67], v[208:211]
    v_mfma_f32_16x16x32_bf16 v[212:215], a[24:27], a[68:71], v[212:215]
    v_mfma_f32_16x16x32_bf16 v[216:219], a[24:27], a[72:75], v[216:219]
    v_mfma_f32_16x16x32_bf16 v[220:223], a[24:27], a[76:79], v[220:223]
    v_mfma_f32_16x16x32_bf16 v[224:227], a[24:27], a[80:83], v[224:227]
    v_mfma_f32_16x16x32_bf16 v[228:231], a[24:27], a[84:87], v[228:231]
    v_mfma_f32_16x16x32_bf16 v[252:255], a[28:31], a[84:87], v[252:255]
    v_mfma_f32_16x16x32_bf16 v[248:251], a[28:31], a[80:83], v[248:251]
    v_mfma_f32_16x16x32_bf16 v[244:247], a[28:31], a[76:79], v[244:247]
    v_mfma_f32_16x16x32_bf16 v[240:243], a[28:31], a[72:75], v[240:243]
    v_mfma_f32_16x16x32_bf16 v[236:239], a[28:31], a[68:71], v[236:239]
    v_mfma_f32_16x16x32_bf16 v[232:235], a[28:31], a[64:67], v[232:235]
    s_waitcnt vmcnt(16) lgkmcnt(0)
    s_barrier
    v_mfma_f32_16x16x32_bf16 v[64:67], a[32:35], a[88:91], v[64:67]
    ds_read_b64_tr_b16 a[0:1], v12 offset:16384
    v_mfma_f32_16x16x32_bf16 v[68:71], a[32:35], a[92:95], v[68:71]
    ds_read_b64_tr_b16 a[2:3], v12 offset:17408
    v_mfma_f32_16x16x32_bf16 v[72:75], a[32:35], a[96:99], v[72:75]
    ds_read_b64_tr_b16 a[4:5], v12 offset:16392
    v_mfma_f32_16x16x32_bf16 v[76:79], a[32:35], a[100:103], v[76:79]
    ds_read_b64_tr_b16 a[6:7], v12 offset:17416
    v_mfma_f32_16x16x32_bf16 v[80:83], a[32:35], a[104:107], v[80:83]
    ds_read_b64_tr_b16 a[8:9], v13 offset:16384
    v_mfma_f32_16x16x32_bf16 v[84:87], a[32:35], a[108:111], v[84:87]
    ds_read_b64_tr_b16 a[10:11], v13 offset:17408
    v_mfma_f32_16x16x32_bf16 v[108:111], a[36:39], a[108:111], v[108:111]
    ds_read_b64_tr_b16 a[12:13], v13 offset:16392
    v_mfma_f32_16x16x32_bf16 v[104:107], a[36:39], a[104:107], v[104:107]
    ds_read_b64_tr_b16 a[14:15], v13 offset:17416
    v_mfma_f32_16x16x32_bf16 v[100:103], a[36:39], a[100:103], v[100:103]
    ds_read_b64_tr_b16 a[16:17], v14 offset:16384
    v_mfma_f32_16x16x32_bf16 v[96:99], a[36:39], a[96:99], v[96:99]
    ds_read_b64_tr_b16 a[18:19], v14 offset:17408
    v_mfma_f32_16x16x32_bf16 v[92:95], a[36:39], a[92:95], v[92:95]
    ds_read_b64_tr_b16 a[20:21], v14 offset:16392
    v_mfma_f32_16x16x32_bf16 v[88:91], a[36:39], a[88:91], v[88:91]
    ds_read_b64_tr_b16 a[22:23], v14 offset:17416
    v_mfma_f32_16x16x32_bf16 v[112:115], a[40:43], a[88:91], v[112:115]
    ds_read_b64_tr_b16 a[24:25], v15 offset:16384
    v_mfma_f32_16x16x32_bf16 v[116:119], a[40:43], a[92:95], v[116:119]
    ds_read_b64_tr_b16 a[26:27], v15 offset:17408
    v_mfma_f32_16x16x32_bf16 v[120:123], a[40:43], a[96:99], v[120:123]
    ds_read_b64_tr_b16 a[28:29], v15 offset:16392
    v_mfma_f32_16x16x32_bf16 v[124:127], a[40:43], a[100:103], v[124:127]
    ds_read_b64_tr_b16 a[30:31], v15 offset:17416
    v_mfma_f32_16x16x32_bf16 v[128:131], a[40:43], a[104:107], v[128:131]
    ds_read_b128 a[64:67], v16 offset:12288
    v_mfma_f32_16x16x32_bf16 v[132:135], a[40:43], a[108:111], v[132:135]
    ds_read_b128 a[68:71], v16 offset:14336
    v_mfma_f32_16x16x32_bf16 v[156:159], a[44:47], a[108:111], v[156:159]
    ds_read_b128 a[72:75], v16 offset:16384
    v_mfma_f32_16x16x32_bf16 v[152:155], a[44:47], a[104:107], v[152:155]
    ds_read_b128 a[76:79], v16 offset:18432
    v_mfma_f32_16x16x32_bf16 v[148:151], a[44:47], a[100:103], v[148:151]
    ds_read_b128 a[80:83], v16 offset:20480
    v_mfma_f32_16x16x32_bf16 v[144:147], a[44:47], a[96:99], v[144:147]
    ds_read_b128 a[84:87], v16 offset:22528
    v_mfma_f32_16x16x32_bf16 v[140:143], a[44:47], a[92:95], v[140:143]
    s_waitcnt vmcnt(0)
    ds_read_b128 a[144:147], v36 offset:0
    v_mfma_f32_16x16x32_bf16 v[136:139], a[44:47], a[88:91], v[136:139]
    ds_read_b128 a[148:151], v37 offset:0
    v_mfma_f32_16x16x32_bf16 v[160:163], a[48:51], a[88:91], v[160:163]
    ds_read_b128 a[152:155], v38 offset:0
    s_add_u32 m0, s66, 0
    s_nop 0
    buffer_load_dwordx4 v2, s[8:11], s62 offen offset:0  lds
    v_mfma_f32_16x16x32_bf16 v[164:167], a[48:51], a[92:95], v[164:167]
    ds_read_b128 a[156:159], v39 offset:0
    v_mfma_f32_16x16x32_bf16 v[168:171], a[48:51], a[96:99], v[168:171]
    ds_read_b128 a[160:163], v36 offset:4096
    buffer_load_dwordx4 v3, s[8:11], s62 offen offset:1024  lds
    v_mfma_f32_16x16x32_bf16 v[172:175], a[48:51], a[100:103], v[172:175]
    ds_read_b128 a[164:167], v37 offset:4096
    v_mfma_f32_16x16x32_bf16 v[176:179], a[48:51], a[104:107], v[176:179]
    ds_read_b128 a[168:171], v38 offset:4096
    buffer_load_dwordx4 v4, s[8:11], s62 offen offset:2048  lds
    s_add_u32 s62, s62, 128
    s_and_b32 s62, s62, 1023
    v_mfma_f32_16x16x32_bf16 v[180:183], a[48:51], a[108:111], v[180:183]
    ds_read_b128 a[172:175], v39 offset:4096
    v_mfma_f32_16x16x32_bf16 v[204:207], a[52:55], a[108:111], v[204:207]
    v_mfma_f32_16x16x32_bf16 v[200:203], a[52:55], a[104:107], v[200:203]
    v_mfma_f32_16x16x32_bf16 v[196:199], a[52:55], a[100:103], v[196:199]
    v_mfma_f32_16x16x32_bf16 v[192:195], a[52:55], a[96:99], v[192:195]
    s_waitcnt lgkmcnt(0)
    v_mfma_f32_16x16x32_bf16 v[188:191], a[52:55], a[92:95], v[188:191]
    s_add_u32 s60, s73, s75
    s_or_b32 s61, s60, 131072
    s_add_u32 m0, s59, 0
    s_nop 0
    buffer_load_dwordx4 v5, s[20:23], s60 offen offset:0  lds
    v_mfma_f32_16x16x32_bf16 v[184:187], a[52:55], a[88:91], v[184:187]
    buffer_load_dwordx4 v6, s[20:23], s60 offen offset:1024  lds
    v_mfma_f32_16x16x32_bf16 v[208:211], a[56:59], a[88:91], v[208:211]
    v_mfma_f32_16x16x32_bf16 v[212:215], a[56:59], a[92:95], v[212:215]
    buffer_load_dwordx4 v7, s[20:23], s60 offen offset:2048  lds
    v_mfma_f32_16x16x32_bf16 v[216:219], a[56:59], a[96:99], v[216:219]
    v_mfma_f32_16x16x32_bf16 v[220:223], a[56:59], a[100:103], v[220:223]
    buffer_load_dwordx4 v8, s[20:23], s60 offen offset:3072  lds
    v_mfma_f32_16x16x32_bf16 v[224:227], a[56:59], a[104:107], v[224:227]
    s_add_u32 m0, s59, 4096
    v_mfma_f32_16x16x32_bf16 v[228:231], a[56:59], a[108:111], v[228:231]
    buffer_load_dwordx4 v5, s[20:23], s61 offen offset:0  lds
    v_mfma_f32_16x16x32_bf16 v[252:255], a[60:63], a[108:111], v[252:255]
    v_mfma_f32_16x16x32_bf16 v[248:251], a[60:63], a[104:107], v[248:251]
    buffer_load_dwordx4 v6, s[20:23], s61 offen offset:1024  lds
    v_mfma_f32_16x16x32_bf16 v[244:247], a[60:63], a[100:103], v[244:247]
    v_mfma_f32_16x16x32_bf16 v[240:243], a[60:63], a[96:99], v[240:243]
    buffer_load_dwordx4 v7, s[20:23], s61 offen offset:2048  lds
    v_mfma_f32_16x16x32_bf16 v[236:239], a[60:63], a[92:95], v[236:239]
    v_mfma_f32_16x16x32_bf16 v[232:235], a[60:63], a[88:91], v[232:235]
    buffer_load_dwordx4 v8, s[20:23], s61 offen offset:3072  lds
    v_mfma_f32_16x16x32_bf16 v[64:67], a[0:3], a[64:67], v[64:67]
    ds_read_b64_tr_b16 a[32:33], v12 offset:24576
    v_mfma_f32_16x16x32_bf16 v[68:71], a[0:3], a[68:71], v[68:71]
    ds_read_b64_tr_b16 a[34:35], v12 offset:25600
    v_mfma_f32_16x16x32_bf16 v[72:75], a[0:3], a[72:75], v[72:75]
    ds_read_b64_tr_b16 a[36:37], v12 offset:24584
    s_add_u32 s60, s73, s100
    s_or_b32 s61, s60, 131072
    s_add_u32 m0, s59, 8192
    s_nop 0
    buffer_load_dwordx4 v5, s[20:23], s60 offen offset:0  lds
    v_mfma_f32_16x16x32_bf16 v[76:79], a[0:3], a[76:79], v[76:79]
    ds_read_b64_tr_b16 a[38:39], v12 offset:25608
    v_mfma_f32_16x16x32_bf16 v[80:83], a[0:3], a[80:83], v[80:83]
    ds_read_b64_tr_b16 a[40:41], v13 offset:24576
    v_mfma_f32_16x16x32_bf16 v[84:87], a[0:3], a[84:87], v[84:87]
    ds_read_b64_tr_b16 a[42:43], v13 offset:25600
    v_mfma_f32_16x16x32_bf16 v[108:111], a[4:7], a[84:87], v[108:111]
    ds_read_b64_tr_b16 a[44:45], v13 offset:24584
    v_mfma_f32_16x16x32_bf16 v[104:107], a[4:7], a[80:83], v[104:107]
    ds_read_b64_tr_b16 a[46:47], v13 offset:25608
    v_mfma_f32_16x16x32_bf16 v[100:103], a[4:7], a[76:79], v[100:103]
    ds_read_b64_tr_b16 a[48:49], v14 offset:24576
    buffer_load_dwordx4 v6, s[20:23], s60 offen offset:1024  lds
    v_mfma_f32_16x16x32_bf16 v[96:99], a[4:7], a[72:75], v[96:99]
    ds_read_b64_tr_b16 a[50:51], v14 offset:25600
    v_mfma_f32_16x16x32_bf16 v[92:95], a[4:7], a[68:71], v[92:95]
    ds_read_b64_tr_b16 a[52:53], v14 offset:24584
    v_mfma_f32_16x16x32_bf16 v[88:91], a[4:7], a[64:67], v[88:91]
    ds_read_b64_tr_b16 a[54:55], v14 offset:25608
    v_mfma_f32_16x16x32_bf16 v[112:115], a[8:11], a[64:67], v[112:115]
    ds_read_b64_tr_b16 a[56:57], v15 offset:24576
    v_mfma_f32_16x16x32_bf16 v[116:119], a[8:11], a[68:71], v[116:119]
    ds_read_b64_tr_b16 a[58:59], v15 offset:25600
    v_mfma_f32_16x16x32_bf16 v[120:123], a[8:11], a[72:75], v[120:123]
    ds_read_b64_tr_b16 a[60:61], v15 offset:24584
    buffer_load_dwordx4 v7, s[20:23], s60 offen offset:2048  lds
    v_mfma_f32_16x16x32_bf16 v[124:127], a[8:11], a[76:79], v[124:127]
    ds_read_b64_tr_b16 a[62:63], v15 offset:25608
    v_mfma_f32_16x16x32_bf16 v[128:131], a[8:11], a[80:83], v[128:131]
    ds_read_b128 a[88:91], v17 offset:12288
    v_mfma_f32_16x16x32_bf16 v[132:135], a[8:11], a[84:87], v[132:135]
    ds_read_b128 a[92:95], v17 offset:14336
    v_mfma_f32_16x16x32_bf16 v[156:159], a[12:15], a[84:87], v[156:159]
    ds_read_b128 a[96:99], v17 offset:16384
    v_mfma_f32_16x16x32_bf16 v[152:155], a[12:15], a[80:83], v[152:155]
    ds_read_b128 a[100:103], v17 offset:18432
    v_mfma_f32_16x16x32_bf16 v[148:151], a[12:15], a[76:79], v[148:151]
    ds_read_b128 a[104:107], v17 offset:20480
    buffer_load_dwordx4 v8, s[20:23], s60 offen offset:3072  lds
    v_mfma_f32_16x16x32_bf16 v[144:147], a[12:15], a[72:75], v[144:147]
    ds_read_b128 a[108:111], v17 offset:22528
    v_mfma_f32_16x16x32_bf16 v[140:143], a[12:15], a[68:71], v[140:143]
    v_mfma_f32_16x16x32_bf16 v[136:139], a[12:15], a[64:67], v[136:139]
    v_mfma_f32_16x16x32_bf16 v[160:163], a[16:19], a[64:67], v[160:163]
    v_mfma_f32_16x16x32_bf16 v[164:167], a[16:19], a[68:71], v[164:167]
    v_mfma_f32_16x16x32_bf16 v[168:171], a[16:19], a[72:75], v[168:171]
    s_add_u32 m0, s59, 12288
    v_mfma_f32_16x16x32_bf16 v[172:175], a[16:19], a[76:79], v[172:175]
    buffer_load_dwordx4 v5, s[20:23], s61 offen offset:0  lds
    v_mfma_f32_16x16x32_bf16 v[176:179], a[16:19], a[80:83], v[176:179]
    v_mfma_f32_16x16x32_bf16 v[180:183], a[16:19], a[84:87], v[180:183]
    v_mfma_f32_16x16x32_bf16 v[204:207], a[20:23], a[84:87], v[204:207]
    v_mfma_f32_16x16x32_bf16 v[200:203], a[20:23], a[80:83], v[200:203]
    v_mfma_f32_16x16x32_bf16 v[196:199], a[20:23], a[76:79], v[196:199]
    v_mfma_f32_16x16x32_bf16 v[192:195], a[20:23], a[72:75], v[192:195]
    buffer_load_dwordx4 v6, s[20:23], s61 offen offset:1024  lds
    v_mfma_f32_16x16x32_bf16 v[188:191], a[20:23], a[68:71], v[188:191]
    v_mfma_f32_16x16x32_bf16 v[184:187], a[20:23], a[64:67], v[184:187]
    v_mfma_f32_16x16x32_bf16 v[208:211], a[24:27], a[64:67], v[208:211]
    v_mfma_f32_16x16x32_bf16 v[212:215], a[24:27], a[68:71], v[212:215]
    v_mfma_f32_16x16x32_bf16 v[216:219], a[24:27], a[72:75], v[216:219]
    v_mfma_f32_16x16x32_bf16 v[220:223], a[24:27], a[76:79], v[220:223]
    buffer_load_dwordx4 v7, s[20:23], s61 offen offset:2048  lds
    v_mfma_f32_16x16x32_bf16 v[224:227], a[24:27], a[80:83], v[224:227]
    v_mfma_f32_16x16x32_bf16 v[228:231], a[24:27], a[84:87], v[228:231]
    v_mfma_f32_16x16x32_bf16 v[252:255], a[28:31], a[84:87], v[252:255]
    v_mfma_f32_16x16x32_bf16 v[248:251], a[28:31], a[80:83], v[248:251]
    v_mfma_f32_16x16x32_bf16 v[244:247], a[28:31], a[76:79], v[244:247]
    v_mfma_f32_16x16x32_bf16 v[240:243], a[28:31], a[72:75], v[240:243]
    v_mfma_f32_16x16x32_bf16 v[236:239], a[28:31], a[68:71], v[236:239]
    buffer_load_dwordx4 v8, s[20:23], s61 offen offset:3072  lds
    s_add_u32 s73, s73, 524288
    s_and_b32 s73, s73, 0x3fffff
    v_mfma_f32_16x16x32_bf16 v[232:235], a[28:31], a[64:67], v[232:235]
    s_waitcnt vmcnt(16) lgkmcnt(0)
    s_barrier
    s_waitcnt vmcnt(8)
    v_mfma_f32_16x16x32_bf16 v[64:67], a[32:35], a[88:91], v[64:67]
    ds_read_b64_tr_b16 a[0:1], v12 offset:0
    s_add_u32 s60, s73, s75
    s_or_b32 s61, s60, 131072
    s_add_u32 m0, s59, 16384
    s_nop 0
    buffer_load_dwordx4 v5, s[20:23], s60 offen offset:0  lds
    v_mfma_f32_16x16x32_bf16 v[68:71], a[32:35], a[92:95], v[68:71]
    ds_read_b64_tr_b16 a[2:3], v12 offset:1024
    v_mfma_f32_16x16x32_bf16 v[72:75], a[32:35], a[96:99], v[72:75]
    ds_read_b64_tr_b16 a[4:5], v12 offset:8
    buffer_load_dwordx4 v6, s[20:23], s60 offen offset:1024  lds
    v_mfma_f32_16x16x32_bf16 v[76:79], a[32:35], a[100:103], v[76:79]
    ds_read_b64_tr_b16 a[6:7], v12 offset:1032
    v_mfma_f32_16x16x32_bf16 v[80:83], a[32:35], a[104:107], v[80:83]
    ds_read_b64_tr_b16 a[8:9], v13 offset:0
    buffer_load_dwordx4 v7, s[20:23], s60 offen offset:2048  lds
    v_mfma_f32_16x16x32_bf16 v[84:87], a[32:35], a[108:111], v[84:87]
    ds_read_b64_tr_b16 a[10:11], v13 offset:1024
    v_mfma_f32_16x16x32_bf16 v[108:111], a[36:39], a[108:111], v[108:111]
    ds_read_b64_tr_b16 a[12:13], v13 offset:8
    buffer_load_dwordx4 v8, s[20:23], s60 offen offset:3072  lds
    v_mfma_f32_16x16x32_bf16 v[104:107], a[36:39], a[104:107], v[104:107]
    ds_read_b64_tr_b16 a[14:15], v13 offset:1032
    v_mfma_f32_16x16x32_bf16 v[100:103], a[36:39], a[100:103], v[100:103]
    ds_read_b64_tr_b16 a[16:17], v14 offset:0
    s_add_u32 m0, s59, 20480
    s_nop 0
    buffer_load_dwordx4 v5, s[20:23], s61 offen offset:0  lds
    v_mfma_f32_16x16x32_bf16 v[96:99], a[36:39], a[96:99], v[96:99]
    ds_read_b64_tr_b16 a[18:19], v14 offset:1024
    v_mfma_f32_16x16x32_bf16 v[92:95], a[36:39], a[92:95], v[92:95]
    ds_read_b64_tr_b16 a[20:21], v14 offset:8
    buffer_load_dwordx4 v6, s[20:23], s61 offen offset:1024  lds
    v_mfma_f32_16x16x32_bf16 v[88:91], a[36:39], a[88:91], v[88:91]
    ds_read_b64_tr_b16 a[22:23], v14 offset:1032
    v_mfma_f32_16x16x32_bf16 v[112:115], a[40:43], a[88:91], v[112:115]
    ds_read_b64_tr_b16 a[24:25], v15 offset:0
    buffer_load_dwordx4 v7, s[20:23], s61 offen offset:2048  lds
    v_mfma_f32_16x16x32_bf16 v[116:119], a[40:43], a[92:95], v[116:119]
    ds_read_b64_tr_b16 a[26:27], v15 offset:1024
    v_mfma_f32_16x16x32_bf16 v[120:123], a[40:43], a[96:99], v[120:123]
    ds_read_b64_tr_b16 a[28:29], v15 offset:8
    buffer_load_dwordx4 v8, s[20:23], s61 offen offset:3072  lds
    v_mfma_f32_16x16x32_bf16 v[124:127], a[40:43], a[100:103], v[124:127]
    ds_read_b64_tr_b16 a[30:31], v15 offset:1032
    v_mfma_f32_16x16x32_bf16 v[128:131], a[40:43], a[104:107], v[128:131]
    ds_read_b128 a[64:67], v16 offset:0
    s_mov_b32 s64, 16384
    s_add_u32 m0, s59, 24576
    s_nop 0
    buffer_load_dwordx4 v32, s[12:15], s64 offen offset:0 nt lds
    v_mfma_f32_16x16x32_bf16 v[132:135], a[40:43], a[108:111], v[132:135]
    ds_read_b128 a[68:71], v16 offset:2048
    v_mfma_f32_16x16x32_bf16 v[156:159], a[44:47], a[108:111], v[156:159]
    ds_read_b128 a[72:75], v16 offset:4096
    buffer_load_dwordx4 v33, s[12:15], s64 offen offset:1024 nt lds
    v_mfma_f32_16x16x32_bf16 v[152:155], a[44:47], a[104:107], v[152:155]
    ds_read_b128 a[76:79], v16 offset:6144
    v_mfma_f32_16x16x32_bf16 v[148:151], a[44:47], a[100:103], v[148:151]
    ds_read_b128 a[80:83], v16 offset:8192
    buffer_load_dwordx4 v34, s[12:15], s64 offen offset:2048 nt lds
    v_mfma_f32_16x16x32_bf16 v[144:147], a[44:47], a[96:99], v[144:147]
    ds_read_b128 a[84:87], v16 offset:10240
    v_mfma_f32_16x16x32_bf16 v[140:143], a[44:47], a[92:95], v[140:143]
    buffer_load_dwordx4 v35, s[12:15], s64 offen offset:3072 nt lds
    v_mfma_f32_16x16x32_bf16 v[136:139], a[44:47], a[88:91], v[136:139]
    v_mfma_f32_16x16x32_bf16 v[160:163], a[48:51], a[88:91], v[160:163]
    s_mov_b32 s64, 20480
    s_add_u32 m0, s59, 28672
    s_nop 0
    buffer_load_dwordx4 v32, s[12:15], s64 offen offset:0 nt lds
    v_mfma_f32_16x16x32_bf16 v[164:167], a[48:51], a[92:95], v[164:167]
    v_mfma_f32_16x16x32_bf16 v[168:171], a[48:51], a[96:99], v[168:171]
    buffer_load_dwordx4 v33, s[12:15], s64 offen offset:1024 nt lds
    v_mfma_f32_16x16x32_bf16 v[172:175], a[48:51], a[100:103], v[172:175]
    v_mfma_f32_16x16x32_bf16 v[176:179], a[48:51], a[104:107], v[176:179]
    buffer_load_dwordx4 v34, s[12:15], s64 offen offset:2048 nt lds
    v_mfma_f32_16x16x32_bf16 v[180:183], a[48:51], a[108:111], v[180:183]
    v_mfma_f32_16x16x32_bf16 v[204:207], a[52:55], a[108:111], v[204:207]
    buffer_load_dwordx4 v35, s[12:15], s64 offen offset:3072 nt lds
    v_mfma_f32_16x16x32_bf16 v[200:203], a[52:55], a[104:107], v[200:203]
    v_mfma_f32_16x16x32_bf16 v[196:199], a[52:55], a[100:103], v[196:199]
    v_mfma_f32_16x16x32_bf16 v[192:195], a[52:55], a[96:99], v[192:195]
    v_mfma_f32_16x16x32_bf16 v[188:191], a[52:55], a[92:95], v[188:191]
    v_mfma_f32_16x16x32_bf16 v[184:187], a[52:55], a[88:91], v[184:187]
    v_mfma_f32_16x16x32_bf16 v[208:211], a[56:59], a[88:91], v[208:211]
    v_mfma_f32_16x16x32_bf16 v[212:215], a[56:59], a[92:95], v[212:215]
    v_mfma_f32_16x16x32_bf16 v[216:219], a[56:59], a[96:99], v[216:219]
    v_mfma_f32_16x16x32_bf16 v[220:223], a[56:59], a[100:103], v[220:223]
    v_mfma_f32_16x16x32_bf16 v[224:227], a[56:59], a[104:107], v[224:227]
    v_mfma_f32_16x16x32_bf16 v[228:231], a[56:59], a[108:111], v[228:231]
    s_add_u32 m0, s66, 12288
    v_mfma_f32_16x16x32_bf16 v[252:255], a[60:63], a[108:111], v[252:255]
    buffer_load_dwordx4 v2, s[8:11], s62 offen offset:0  lds
    v_mfma_f32_16x16x32_bf16 v[248:251], a[60:63], a[104:107], v[248:251]
    v_mfma_f32_16x16x32_bf16 v[244:247], a[60:63], a[100:103], v[244:247]
    buffer_load_dwordx4 v3, s[8:11], s62 offen offset:1024  lds
    v_mfma_f32_16x16x32_bf16 v[240:243], a[60:63], a[96:99], v[240:243]
    v_mfma_f32_16x16x32_bf16 v[236:239], a[60:63], a[92:95], v[236:239]
    buffer_load_dwordx4 v4, s[8:11], s62 offen offset:2048  lds
    s_add_u32 s62, s62, 128
    s_and_b32 s62, s62, 1023
    v_mfma_f32_16x16x32_bf16 v[232:235], a[60:63], a[88:91], v[232:235]
    s_waitcnt lgkmcnt(0)
    s_waitcnt vmcnt(19)
    v_mfma_f32_16x16x32_bf16 v[64:67], a[0:3], a[64:67], v[64:67]
    ds_read_b64_tr_b16 a[32:33], v12 offset:8192
    v_mfma_f32_16x16x32_bf16 v[68:71], a[0:3], a[68:71], v[68:71]
    ds_read_b64_tr_b16 a[34:35], v12 offset:9216
    v_mfma_f32_16x16x32_bf16 v[72:75], a[0:3], a[72:75], v[72:75]
    ds_read_b64_tr_b16 a[36:37], v12 offset:8200
    v_mfma_f32_16x16x32_bf16 v[76:79], a[0:3], a[76:79], v[76:79]
    ds_read_b64_tr_b16 a[38:39], v12 offset:9224
    v_mfma_f32_16x16x32_bf16 v[80:83], a[0:3], a[80:83], v[80:83]
    ds_read_b64_tr_b16 a[40:41], v13 offset:8192
    v_mfma_f32_16x16x32_bf16 v[84:87], a[0:3], a[84:87], v[84:87]
    ds_read_b64_tr_b16 a[42:43], v13 offset:9216
    v_mfma_f32_16x16x32_bf16 v[108:111], a[4:7], a[84:87], v[108:111]
    ds_read_b64_tr_b16 a[44:45], v13 offset:8200
    v_mfma_f32_16x16x32_bf16 v[104:107], a[4:7], a[80:83], v[104:107]
    ds_read_b64_tr_b16 a[46:47], v13 offset:9224
    v_mfma_f32_16x16x32_bf16 v[100:103], a[4:7], a[76:79], v[100:103]
    ds_read_b64_tr_b16 a[48:49], v14 offset:8192
    v_mfma_f32_16x16x32_bf16 v[96:99], a[4:7], a[72:75], v[96:99]
    ds_read_b64_tr_b16 a[50:51], v14 offset:9216
    v_mfma_f32_16x16x32_bf16 v[92:95], a[4:7], a[68:71], v[92:95]
    ds_read_b64_tr_b16 a[52:53], v14 offset:8200
    v_mfma_f32_16x16x32_bf16 v[88:91], a[4:7], a[64:67], v[88:91]
    ds_read_b64_tr_b16 a[54:55], v14 offset:9224
    v_mfma_f32_16x16x32_bf16 v[112:115], a[8:11], a[64:67], v[112:115]
    ds_read_b64_tr_b16 a[56:57], v15 offset:8192
    v_mfma_f32_16x16x32_bf16 v[116:119], a[8:11], a[68:71], v[116:119]
    ds_read_b64_tr_b16 a[58:59], v15 offset:9216
    v_mfma_f32_16x16x32_bf16 v[120:123], a[8:11], a[72:75], v[120:123]
    ds_read_b64_tr_b16 a[60:61], v15 offset:8200
    v_mfma_f32_16x16x32_bf16 v[124:127], a[8:11], a[76:79], v[124:127]
    ds_read_b64_tr_b16 a[62:63], v15 offset:9224
    v_mfma_f32_16x16x32_bf16 v[128:131], a[8:11], a[80:83], v[128:131]
    ds_read_b128 a[88:91], v17 offset:0
    v_mfma_f32_16x16x32_bf16 v[132:135], a[8:11], a[84:87], v[132:135]
    ds_read_b128 a[92:95], v17 offset:2048
    v_mfma_f32_16x16x32_bf16 v[156:159], a[12:15], a[84:87], v[156:159]
    ds_read_b128 a[96:99], v17 offset:4096
    v_mfma_f32_16x16x32_bf16 v[152:155], a[12:15], a[80:83], v[152:155]
    ds_read_b128 a[100:103], v17 offset:6144
    v_mfma_f32_16x16x32_bf16 v[148:151], a[12:15], a[76:79], v[148:151]
    ds_read_b128 a[104:107], v17 offset:8192
    v_mfma_f32_16x16x32_bf16 v[144:147], a[12:15], a[72:75], v[144:147]
    ds_read_b128 a[108:111], v17 offset:10240
    v_mfma_f32_16x16x32_bf16 v[140:143], a[12:15], a[68:71], v[140:143]
    s_waitcnt vmcnt(3)
    ds_read_b128 a[176:179], v36 offset:24576
    v_mfma_f32_16x16x32_bf16 v[136:139], a[12:15], a[64:67], v[136:139]
    ds_read_b128 a[180:183], v37 offset:24576
    v_mfma_f32_16x16x32_bf16 v[160:163], a[16:19], a[64:67], v[160:163]
    ds_read_b128 a[184:187], v38 offset:24576
    v_mfma_f32_16x16x32_bf16 v[164:167], a[16:19], a[68:71], v[164:167]
    ds_read_b128 a[188:191], v39 offset:24576
    v_mfma_f32_16x16x32_bf16 v[168:171], a[16:19], a[72:75], v[168:171]
    ds_read_b128 a[192:195], v36 offset:28672
    v_mfma_f32_16x16x32_bf16 v[172:175], a[16:19], a[76:79], v[172:175]
    ds_read_b128 a[196:199], v37 offset:28672
    v_mfma_f32_16x16x32_bf16 v[176:179], a[16:19], a[80:83], v[176:179]
    ds_read_b128 a[200:203], v38 offset:28672
    v_mfma_f32_16x16x32_bf16 v[180:183], a[16:19], a[84:87], v[180:183]
    ds_read_b128 a[204:207], v39 offset:28672
    v_mfma_f32_16x16x32_bf16 v[204:207], a[20:23], a[84:87], v[204:207]
    v_mfma_f32_16x16x32_bf16 v[200:203], a[20:23], a[80:83], v[200:203]
    v_mfma_f32_16x16x32_bf16 v[196:199], a[20:23], a[76:79], v[196:199]
    v_mfma_f32_16x16x32_bf16 v[192:195], a[20:23], a[72:75], v[192:195]
    s_waitcnt lgkmcnt(0)
    v_mfma_f32_16x16x32_bf16 v[188:191], a[20:23], a[68:71], v[188:191]
    s_add_u32 s60, s73, s100
    s_or_b32 s61, s60, 131072
    s_add_u32 m0, s59, 24576
    s_nop 0
    buffer_load_dwordx4 v5, s[20:23], s60 offen offset:0  lds
    v_mfma_f32_16x16x32_bf16 v[184:187], a[20:23], a[64:67], v[184:187]
    buffer_load_dwordx4 v6, s[20:23], s60 offen offset:1024  lds
    v_mfma_f32_16x16x32_bf16 v[208:211], a[24:27], a[64:67], v[208:211]
    v_mfma_f32_16x16x32_bf16 v[212:215], a[24:27], a[68:71], v[212:215]
    buffer_load_dwordx4 v7, s[20:23], s60 offen offset:2048  lds
    v_mfma_f32_16x16x32_bf16 v[216:219], a[24:27], a[72:75], v[216:219]
    v_mfma_f32_16x16x32_bf16 v[220:223], a[24:27], a[76:79], v[220:223]
    buffer_load_dwordx4 v8, s[20:23], s60 offen offset:3072  lds
    v_mfma_f32_16x16x32_bf16 v[224:227], a[24:27], a[80:83], v[224:227]
    s_add_u32 m0, s59, 28672
    v_mfma_f32_16x16x32_bf16 v[228:231], a[24:27], a[84:87], v[228:231]
    buffer_load_dwordx4 v5, s[20:23], s61 offen offset:0  lds
    v_mfma_f32_16x16x32_bf16 v[252:255], a[28:31], a[84:87], v[252:255]
    v_mfma_f32_16x16x32_bf16 v[248:251], a[28:31], a[80:83], v[248:251]
    buffer_load_dwordx4 v6, s[20:23], s61 offen offset:1024  lds
    v_mfma_f32_16x16x32_bf16 v[244:247], a[28:31], a[76:79], v[244:247]
    v_mfma_f32_16x16x32_bf16 v[240:243], a[28:31], a[72:75], v[240:243]
    buffer_load_dwordx4 v7, s[20:23], s61 offen offset:2048  lds
    v_mfma_f32_16x16x32_bf16 v[236:239], a[28:31], a[68:71], v[236:239]
    v_mfma_f32_16x16x32_bf16 v[232:235], a[28:31], a[64:67], v[232:235]
    buffer_load_dwordx4 v8, s[20:23], s61 offen offset:3072  lds
    s_add_u32 s73, s73, 524288
    s_and_b32 s73, s73, 0x3fffff
    s_waitcnt vmcnt(8)
    s_barrier
    v_mfma_f32_16x16x32_bf16 v[64:67], a[32:35], a[88:91], v[64:67]
    ds_read_b64_tr_b16 a[0:1], v12 offset:16384
    v_mfma_f32_16x16x32_bf16 v[68:71], a[32:35], a[92:95], v[68:71]
    ds_read_b64_tr_b16 a[2:3], v12 offset:17408
    v_mfma_f32_16x16x32_bf16 v[72:75], a[32:35], a[96:99], v[72:75]
    ds_read_b64_tr_b16 a[4:5], v12 offset:16392
    s_mov_b32 s63, 0
    s_add_u32 m0, s59, 0
    s_nop 0
    buffer_load_dwordx4 v10, s[16:19], s63 offen offset:0 nt lds
    v_mfma_f32_16x16x32_bf16 v[76:79], a[32:35], a[100:103], v[76:79]
    ds_read_b64_tr_b16 a[6:7], v12 offset:17416
    v_mfma_f32_16x16x32_bf16 v[80:83], a[32:35], a[104:107], v[80:83]
    ds_read_b64_tr_b16 a[8:9], v13 offset:16384
    buffer_load_dwordx4 v11, s[16:19], s63 offen offset:1024 nt lds
    v_mfma_f32_16x16x32_bf16 v[84:87], a[32:35], a[108:111], v[84:87]
    ds_read_b64_tr_b16 a[10:11], v13 offset:17408
    v_mfma_f32_16x16x32_bf16 v[108:111], a[36:39], a[108:111], v[108:111]
    ds_read_b64_tr_b16 a[12:13], v13 offset:16392
    buffer_load_dwordx4 v10, s[16:19], s63 offen offset:2048 nt lds
    v_mfma_f32_16x16x32_bf16 v[104:107], a[36:39], a[104:107], v[104:107]
    ds_read_b64_tr_b16 a[14:15], v13 offset:17416
    v_mfma_f32_16x16x32_bf16 v[100:103], a[36:39], a[100:103], v[100:103]
    ds_read_b64_tr_b16 a[16:17], v14 offset:16384
    buffer_load_dwordx4 v11, s[16:19], s63 offen offset:3072 nt lds
    v_mfma_f32_16x16x32_bf16 v[96:99], a[36:39], a[96:99], v[96:99]
    ds_read_b64_tr_b16 a[18:19], v14 offset:17408
    v_mfma_f32_16x16x32_bf16 v[92:95], a[36:39], a[92:95], v[92:95]
    ds_read_b64_tr_b16 a[20:21], v14 offset:16392
    s_mov_b32 s63, 4096
    s_add_u32 m0, s59, 4096
    s_nop 0
    buffer_load_dwordx4 v10, s[16:19], s63 offen offset:0 nt lds
    v_mfma_f32_16x16x32_bf16 v[88:91], a[36:39], a[88:91], v[88:91]
    ds_read_b64_tr_b16 a[22:23], v14 offset:17416
    v_mfma_f32_16x16x32_bf16 v[112:115], a[40:43], a[88:91], v[112:115]
    ds_read_b64_tr_b16 a[24:25], v15 offset:16384
    buffer_load_dwordx4 v11, s[16:19], s63 offen offset:1024 nt lds
    v_mfma_f32_16x16x32_bf16 v[116:119], a[40:43], a[92:95], v[116:119]
    ds_read_b64_tr_b16 a[26:27], v15 offset:17408
    v_mfma_f32_16x16x32_bf16 v[120:123], a[40:43], a[96:99], v[120:123]
    ds_read_b64_tr_b16 a[28:29], v15 offset:16392
    buffer_load_dwordx4 v10, s[16:19], s63 offen offset:2048 nt lds
    v_mfma_f32_16x16x32_bf16 v[124:127], a[40:43], a[100:103], v[124:127]
    ds_read_b64_tr_b16 a[30:31], v15 offset:17416
    v_mfma_f32_16x16x32_bf16 v[128:131], a[40:43], a[104:107], v[128:131]
    ds_read_b128 a[64:67], v16 offset:12288
    buffer_load_dwordx4 v11, s[16:19], s63 offen offset:3072 nt lds
    v_mfma_f32_16x16x32_bf16 v[132:135], a[40:43], a[108:111], v[132:135]
    ds_read_b128 a[68:71], v16 offset:14336
    v_mfma_f32_16x16x32_bf16 v[156:159], a[44:47], a[108:111], v[156:159]
    ds_read_b128 a[72:75], v16 offset:16384
    v_mfma_f32_16x16x32_bf16 v[152:155], a[44:47], a[104:107], v[152:155]
    ds_read_b128 a[76:79], v16 offset:18432
    v_mfma_f32_16x16x32_bf16 v[148:151], a[44:47], a[100:103], v[148:151]
    ds_read_b128 a[80:83], v16 offset:20480
    v_mfma_f32_16x16x32_bf16 v[144:147], a[44:47], a[96:99], v[144:147]
    ds_read_b128 a[84:87], v16 offset:22528
    v_mfma_f32_16x16x32_bf16 v[140:143], a[44:47], a[92:95], v[140:143]
    v_mfma_f32_16x16x32_bf16 v[136:139], a[44:47], a[88:91], v[136:139]
    v_mfma_f32_16x16x32_bf16 v[160:163], a[48:51], a[88:91], v[160:163]
    v_mfma_f32_16x16x32_bf16 v[164:167], a[48:51], a[92:95], v[164:167]
    v_mfma_f32_16x16x32_bf16 v[168:171], a[48:51], a[96:99], v[168:171]
    v_mfma_f32_16x16x32_bf16 v[172:175], a[48:51], a[100:103], v[172:175]
    v_mfma_f32_16x16x32_bf16 v[176:179], a[48:51], a[104:107], v[176:179]
    v_mfma_f32_16x16x32_bf16 v[180:183], a[48:51], a[108:111], v[180:183]
    v_mfma_f32_16x16x32_bf16 v[204:207], a[52:55], a[108:111], v[204:207]
    v_mfma_f32_16x16x32_bf16 v[200:203], a[52:55], a[104:107], v[200:203]
    v_mfma_f32_16x16x32_bf16 v[196:199], a[52:55], a[100:103], v[196:199]
    v_mfma_f32_16x16x32_bf16 v[192:195], a[52:55], a[96:99], v[192:195]
    v_mfma_f32_16x16x32_bf16 v[188:191], a[52:55], a[92:95], v[188:191]
    v_mfma_f32_16x16x32_bf16 v[184:187], a[52:55], a[88:91], v[184:187]
    v_mfma_f32_16x16x32_bf16 v[208:211], a[56:59], a[88:91], v[208:211]
    v_mfma_f32_16x16x32_bf16 v[212:215], a[56:59], a[92:95], v[212:215]
    v_mfma_f32_16x16x32_bf16 v[216:219], a[56:59], a[96:99], v[216:219]
    v_mfma_f32_16x16x32_bf16 v[220:223], a[56:59], a[100:103], v[220:223]
    v_mfma_f32_16x16x32_bf16 v[224:227], a[56:59], a[104:107], v[224:227]
    v_mfma_f32_16x16x32_bf16 v[228:231], a[56:59], a[108:111], v[228:231]
    v_mfma_f32_16x16x32_bf16 v[252:255], a[60:63], a[108:111], v[252:255]
    v_mfma_f32_16x16x32_bf16 v[248:251], a[60:63], a[104:107], v[248:251]
    v_mfma_f32_16x16x32_bf16 v[244:247], a[60:63], a[100:103], v[244:247]
    v_mfma_f32_16x16x32_bf16 v[240:243], a[60:63], a[96:99], v[240:243]
    v_mfma_f32_16x16x32_bf16 v[236:239], a[60:63], a[92:95], v[236:239]
    v_mfma_f32_16x16x32_bf16 v[232:235], a[60:63], a[88:91], v[232:235]
    s_waitcnt lgkmcnt(0)
    s_waitcnt vmcnt(8)
    v_mfma_f32_16x16x32_bf16 v[64:67], a[0:3], a[64:67], v[64:67]
    ds_read_b64_tr_b16 a[32:33], v12 offset:24576
    v_mfma_f32_16x16x32_bf16 v[68:71], a[0:3], a[68:71], v[68:71]
    ds_read_b64_tr_b16 a[34:35], v12 offset:25600
    v_mfma_f32_16x16x32_bf16 v[72:75], a[0:3], a[72:75], v[72:75]
    ds_read_b64_tr_b16 a[36:37], v12 offset:24584
    v_mfma_f32_16x16x32_bf16 v[76:79], a[0:3], a[76:79], v[76:79]
    ds_read_b64_tr_b16 a[38:39], v12 offset:25608
    v_mfma_f32_16x16x32_bf16 v[80:83], a[0:3], a[80:83], v[80:83]
    ds_read_b64_tr_b16 a[40:41], v13 offset:24576
    v_mfma_f32_16x16x32_bf16 v[84:87], a[0:3], a[84:87], v[84:87]
    ds_read_b64_tr_b16 a[42:43], v13 offset:25600
    v_mfma_f32_16x16x32_bf16 v[108:111], a[4:7], a[84:87], v[108:111]
    ds_read_b64_tr_b16 a[44:45], v13 offset:24584
    v_mfma_f32_16x16x32_bf16 v[104:107], a[4:7], a[80:83], v[104:107]
    ds_read_b64_tr_b16 a[46:47], v13 offset:25608
    v_mfma_f32_16x16x32_bf16 v[100:103], a[4:7], a[76:79], v[100:103]
    ds_read_b64_tr_b16 a[48:49], v14 offset:24576
    v_mfma_f32_16x16x32_bf16 v[96:99], a[4:7], a[72:75], v[96:99]
    ds_read_b64_tr_b16 a[50:51], v14 offset:25600
    v_mfma_f32_16x16x32_bf16 v[92:95], a[4:7], a[68:71], v[92:95]
    ds_read_b64_tr_b16 a[52:53], v14 offset:24584
    v_mfma_f32_16x16x32_bf16 v[88:91], a[4:7], a[64:67], v[88:91]
    ds_read_b64_tr_b16 a[54:55], v14 offset:25608
    v_mfma_f32_16x16x32_bf16 v[112:115], a[8:11], a[64:67], v[112:115]
    ds_read_b64_tr_b16 a[56:57], v15 offset:24576
    v_mfma_f32_16x16x32_bf16 v[116:119], a[8:11], a[68:71], v[116:119]
    ds_read_b64_tr_b16 a[58:59], v15 offset:25600
    v_mfma_f32_16x16x32_bf16 v[120:123], a[8:11], a[72:75], v[120:123]
    ds_read_b64_tr_b16 a[60:61], v15 offset:24584
    v_mfma_f32_16x16x32_bf16 v[124:127], a[8:11], a[76:79], v[124:127]
    ds_read_b64_tr_b16 a[62:63], v15 offset:25608
    v_mfma_f32_16x16x32_bf16 v[128:131], a[8:11], a[80:83], v[128:131]
    ds_read_b128 a[88:91], v17 offset:12288
    v_mfma_f32_16x16x32_bf16 v[132:135], a[8:11], a[84:87], v[132:135]
    ds_read_b128 a[92:95], v17 offset:14336
    v_mfma_f32_16x16x32_bf16 v[156:159], a[12:15], a[84:87], v[156:159]
    ds_read_b128 a[96:99], v17 offset:16384
    v_mfma_f32_16x16x32_bf16 v[152:155], a[12:15], a[80:83], v[152:155]
    ds_read_b128 a[100:103], v17 offset:18432
    v_mfma_f32_16x16x32_bf16 v[148:151], a[12:15], a[76:79], v[148:151]
    ds_read_b128 a[104:107], v17 offset:20480
    v_mfma_f32_16x16x32_bf16 v[144:147], a[12:15], a[72:75], v[144:147]
    ds_read_b128 a[108:111], v17 offset:22528
    v_mfma_f32_16x16x32_bf16 v[140:143], a[12:15], a[68:71], v[140:143]
    v_mfma_f32_16x16x32_bf16 v[136:139], a[12:15], a[64:67], v[136:139]
    v_mfma_f32_16x16x32_bf16 v[160:163], a[16:19], a[64:67], v[160:163]
    v_mfma_f32_16x16x32_bf16 v[164:167], a[16:19], a[68:71], v[164:167]
    v_mfma_f32_16x16x32_bf16 v[168:171], a[16:19], a[72:75], v[168:171]
    v_mfma_f32_16x16x32_bf16 v[172:175], a[16:19], a[76:79], v[172:175]
    v_mfma_f32_16x16x32_bf16 v[176:179], a[16:19], a[80:83], v[176:179]
    v_mfma_f32_16x16x32_bf16 v[180:183], a[16:19], a[84:87], v[180:183]
    v_mfma_f32_16x16x32_bf16 v[204:207], a[20:23], a[84:87], v[204:207]
    v_mfma_f32_16x16x32_bf16 v[200:203], a[20:23], a[80:83], v[200:203]
    v_mfma_f32_16x16x32_bf16 v[196:199], a[20:23], a[76:79], v[196:199]
    v_mfma_f32_16x16x32_bf16 v[192:195], a[20:23], a[72:75], v[192:195]
    v_mfma_f32_16x16x32_bf16 v[188:191], a[20:23], a[68:71], v[188:191]
    v_mfma_f32_16x16x32_bf16 v[184:187], a[20:23], a[64:67], v[184:187]
    v_mfma_f32_16x16x32_bf16 v[208:211], a[24:27], a[64:67], v[208:211]
    v_mfma_f32_16x16x32_bf16 v[212:215], a[24:27], a[68:71], v[212:215]
    v_mfma_f32_16x16x32_bf16 v[216:219], a[24:27], a[72:75], v[216:219]
    v_mfma_f32_16x16x32_bf16 v[220:223], a[24:27], a[76:79], v[220:223]
    v_mfma_f32_16x16x32_bf16 v[224:227], a[24:27], a[80:83], v[224:227]
    v_mfma_f32_16x16x32_bf16 v[228:231], a[24:27], a[84:87], v[228:231]
    v_mfma_f32_16x16x32_bf16 v[252:255], a[28:31], a[84:87], v[252:255]
    v_mfma_f32_16x16x32_bf16 v[248:251], a[28:31], a[80:83], v[248:251]
    v_mfma_f32_16x16x32_bf16 v[244:247], a[28:31], a[76:79], v[244:247]
    v_mfma_f32_16x16x32_bf16 v[240:243], a[28:31], a[72:75], v[240:243]
    v_mfma_f32_16x16x32_bf16 v[236:239], a[28:31], a[68:71], v[236:239]
    v_mfma_f32_16x16x32_bf16 v[232:235], a[28:31], a[64:67], v[232:235]
    s_waitcnt lgkmcnt(0)
    s_barrier
    v_mfma_f32_16x16x32_bf16 v[64:67], a[32:35], a[88:91], v[64:67]
    v_mfma_f32_16x16x32_bf16 v[68:71], a[32:35], a[92:95], v[68:71]
    v_mfma_f32_16x16x32_bf16 v[72:75], a[32:35], a[96:99], v[72:75]
    s_mov_b32 s63, 8192
    s_add_u32 m0, s59, 8192
    s_nop 0
    buffer_load_dwordx4 v10, s[16:19], s63 offen offset:0 nt lds
    v_mfma_f32_16x16x32_bf16 v[76:79], a[32:35], a[100:103], v[76:79]
    v_mfma_f32_16x16x32_bf16 v[80:83], a[32:35], a[104:107], v[80:83]
    buffer_load_dwordx4 v11, s[16:19], s63 offen offset:1024 nt lds
    v_mfma_f32_16x16x32_bf16 v[84:87], a[32:35], a[108:111], v[84:87]
    v_mfma_f32_16x16x32_bf16 v[108:111], a[36:39], a[108:111], v[108:111]
    buffer_load_dwordx4 v10, s[16:19], s63 offen offset:2048 nt lds
    v_mfma_f32_16x16x32_bf16 v[104:107], a[36:39], a[104:107], v[104:107]
    v_mfma_f32_16x16x32_bf16 v[100:103], a[36:39], a[100:103], v[100:103]
    buffer_load_dwordx4 v11, s[16:19], s63 offen offset:3072 nt lds
    v_mfma_f32_16x16x32_bf16 v[96:99], a[36:39], a[96:99], v[96:99]
    v_mfma_f32_16x16x32_bf16 v[92:95], a[36:39], a[92:95], v[92:95]
    s_mov_b32 s63, 12288
    s_add_u32 m0, s59, 12288
    s_nop 0
    buffer_load_dwordx4 v10, s[16:19], s63 offen offset:0 nt lds
    v_mfma_f32_16x16x32_bf16 v[88:91], a[36:39], a[88:91], v[88:91]
    v_mfma_f32_16x16x32_bf16 v[112:115], a[40:43], a[88:91], v[112:115]
    buffer_load_dwordx4 v11, s[16:19], s63 offen offset:1024 nt lds
    v_mfma_f32_16x16x32_bf16 v[116:119], a[40:43], a[92:95], v[116:119]
    v_mfma_f32_16x16x32_bf16 v[120:123], a[40:43], a[96:99], v[120:123]
    buffer_load_dwordx4 v10, s[16:19], s63 offen offset:2048 nt lds
    v_cvt_pk_bf16_f32 v84, v84, v85
    v_cvt_pk_bf16_f32 v85, v86, v87
    v_mfma_f32_16x16x32_bf16 v[124:127], a[40:43], a[100:103], v[124:127]
    v_cvt_pk_bf16_f32 v86, v108, v109
    v_cvt_pk_bf16_f32 v87, v110, v111
    v_mfma_f32_16x16x32_bf16 v[128:131], a[40:43], a[104:107], v[128:131]
    buffer_load_dwordx4 v11, s[16:19], s63 offen offset:3072 nt lds
    v_cvt_pk_bf16_f32 v80, v80, v81
    v_cvt_pk_bf16_f32 v81, v82, v83
    v_mfma_f32_16x16x32_bf16 v[132:135], a[40:43], a[108:111], v[132:135]
    v_cvt_pk_bf16_f32 v82, v104, v105
    v_cvt_pk_bf16_f32 v83, v106, v107
    v_mfma_f32_16x16x32_bf16 v[156:159], a[44:47], a[108:111], v[156:159]
    v_cvt_pk_bf16_f32 v76, v76, v77
    v_cvt_pk_bf16_f32 v77, v78, v79
    v_mfma_f32_16x16x32_bf16 v[152:155], a[44:47], a[104:107], v[152:155]
    v_cvt_pk_bf16_f32 v78, v100, v101
    v_cvt_pk_bf16_f32 v79, v102, v103
    v_mfma_f32_16x16x32_bf16 v[148:151], a[44:47], a[100:103], v[148:151]
    v_cvt_pk_bf16_f32 v72, v72, v73
    v_cvt_pk_bf16_f32 v73, v74, v75
    v_mfma_f32_16x16x32_bf16 v[144:147], a[44:47], a[96:99], v[144:147]
    v_cvt_pk_bf16_f32 v74, v96, v97
    v_cvt_pk_bf16_f32 v75, v98, v99
    v_mfma_f32_16x16x32_bf16 v[140:143], a[44:47], a[92:95], v[140:143]
    v_cvt_pk_bf16_f32 v68, v68, v69
    v_cvt_pk_bf16_f32 v69, v70, v71
    v_mfma_f32_16x16x32_bf16 v[136:139], a[44:47], a[88:91], v[136:139]
    v_cvt_pk_bf16_f32 v70, v92, v93
    v_cvt_pk_bf16_f32 v71, v94, v95
    v_mfma_f32_16x16x32_bf16 v[160:163], a[48:51], a[88:91], v[160:163]
    v_cvt_pk_bf16_f32 v64, v64, v65
    v_cvt_pk_bf16_f32 v65, v66, v67
    v_mfma_f32_16x16x32_bf16 v[164:167], a[48:51], a[92:95], v[164:167]
    v_cvt_pk_bf16_f32 v66, v88, v89
    v_cvt_pk_bf16_f32 v67, v90, v91
    v_mfma_f32_16x16x32_bf16 v[168:171], a[48:51], a[96:99], v[168:171]
    v_cvt_pk_bf16_f32 v132, v132, v133
    v_cvt_pk_bf16_f32 v133, v134, v135
    v_mfma_f32_16x16x32_bf16 v[172:175], a[48:51], a[100:103], v[172:175]
    v_cvt_pk_bf16_f32 v134, v156, v157
    v_cvt_pk_bf16_f32 v135, v158, v159
    v_mfma_f32_16x16x32_bf16 v[176:179], a[48:51], a[104:107], v[176:179]
    v_cvt_pk_bf16_f32 v128, v128, v129
    v_cvt_pk_bf16_f32 v129, v130, v131
    v_mfma_f32_16x16x32_bf16 v[180:183], a[48:51], a[108:111], v[180:183]
    v_cvt_pk_bf16_f32 v130, v152, v153
    v_cvt_pk_bf16_f32 v131, v154, v155
    v_mfma_f32_16x16x32_bf16 v[204:207], a[52:55], a[108:111], v[204:207]
    v_cvt_pk_bf16_f32 v124, v124, v125
    v_cvt_pk_bf16_f32 v125, v126, v127
    v_mfma_f32_16x16x32_bf16 v[200:203], a[52:55], a[104:107], v[200:203]
    v_cvt_pk_bf16_f32 v126, v148, v149
    v_cvt_pk_bf16_f32 v127, v150, v151
    v_mfma_f32_16x16x32_bf16 v[196:199], a[52:55], a[100:103], v[196:199]
    v_cvt_pk_bf16_f32 v120, v120, v121
    v_cvt_pk_bf16_f32 v121, v122, v123
    v_mfma_f32_16x16x32_bf16 v[192:195], a[52:55], a[96:99], v[192:195]
    v_cvt_pk_bf16_f32 v122, v144, v145
    v_cvt_pk_bf16_f32 v123, v146, v147
    v_mfma_f32_16x16x32_bf16 v[188:191], a[52:55], a[92:95], v[188:191]
    v_cvt_pk_bf16_f32 v116, v116, v117
    v_cvt_pk_bf16_f32 v117, v118, v119
    v_mfma_f32_16x16x32_bf16 v[184:187], a[52:55], a[88:91], v[184:187]
    v_cvt_pk_bf16_f32 v118, v140, v141
    v_cvt_pk_bf16_f32 v119, v142, v143
    v_mfma_f32_16x16x32_bf16 v[208:211], a[56:59], a[88:91], v[208:211]
    v_cvt_pk_bf16_f32 v112, v112, v113
    v_cvt_pk_bf16_f32 v113, v114, v115
    v_mfma_f32_16x16x32_bf16 v[212:215], a[56:59], a[92:95], v[212:215]
    v_cvt_pk_bf16_f32 v114, v136, v137
    v_cvt_pk_bf16_f32 v115, v138, v139
    v_mfma_f32_16x16x32_bf16 v[216:219], a[56:59], a[96:99], v[216:219]
    v_cvt_pk_bf16_f32 v180, v180, v181
    v_cvt_pk_bf16_f32 v181, v182, v183
    v_cvt_pk_bf16_f32 v182, v204, v205
    v_mfma_f32_16x16x32_bf16 v[220:223], a[56:59], a[100:103], v[220:223]
    v_cvt_pk_bf16_f32 v183, v206, v207
    v_cvt_pk_bf16_f32 v176, v176, v177
    v_cvt_pk_bf16_f32 v177, v178, v179
    v_mfma_f32_16x16x32_bf16 v[224:227], a[56:59], a[104:107], v[224:227]
    v_cvt_pk_bf16_f32 v178, v200, v201
    v_cvt_pk_bf16_f32 v179, v202, v203
    v_mfma_f32_16x16x32_bf16 v[228:231], a[56:59], a[108:111], v[228:231]
    v_cvt_pk_bf16_f32 v172, v172, v173
    v_cvt_pk_bf16_f32 v173, v174, v175
    v_cvt_pk_bf16_f32 v174, v196, v197
    v_mfma_f32_16x16x32_bf16 v[252:255], a[60:63], a[108:111], v[252:255]
    v_cvt_pk_bf16_f32 v175, v198, v199
    v_cvt_pk_bf16_f32 v168, v168, v169
    v_cvt_pk_bf16_f32 v169, v170, v171
    v_mfma_f32_16x16x32_bf16 v[248:251], a[60:63], a[104:107], v[248:251]
    v_cvt_pk_bf16_f32 v170, v192, v193
    v_cvt_pk_bf16_f32 v171, v194, v195
    v_mfma_f32_16x16x32_bf16 v[244:247], a[60:63], a[100:103], v[244:247]
    v_cvt_pk_bf16_f32 v164, v164, v165
    v_cvt_pk_bf16_f32 v165, v166, v167
    v_cvt_pk_bf16_f32 v166, v188, v189
    v_mfma_f32_16x16x32_bf16 v[240:243], a[60:63], a[96:99], v[240:243]
    v_cvt_pk_bf16_f32 v167, v190, v191
    v_cvt_pk_bf16_f32 v160, v160, v161
    v_cvt_pk_bf16_f32 v161, v162, v163
    v_mfma_f32_16x16x32_bf16 v[236:239], a[60:63], a[92:95], v[236:239]
    v_cvt_pk_bf16_f32 v162, v184, v185
    v_cvt_pk_bf16_f32 v163, v186, v187
    v_mfma_f32_16x16x32_bf16 v[232:235], a[60:63], a[88:91], v[232:235]
L_join:
    v_mov_b32 v12, 0x3f803f80
    v_accvgpr_write_b32 a96, v12
    v_accvgpr_write_b32 a97, v12
    v_accvgpr_write_b32 a98, v12
    v_accvgpr_write_b32 a99, v12
    v_cvt_pk_bf16_f32 v208, v208, v209
    v_cvt_pk_bf16_f32 v209, v210, v211
    s_nop 0
    v_cvt_pk_bf16_f32 v210, v232, v233
    v_cvt_pk_bf16_f32 v211, v234, v235
    v_mfma_f32_16x16x32_bf16 v[88:91], a[112:115], v[64:67], 0
    v_cvt_pk_bf16_f32 v228, v228, v229
    v_mfma_f32_16x16x32_bf16 v[92:95], a[128:131], v[64:67], 0
    v_cvt_pk_bf16_f32 v229, v230, v231
    v_mfma_f32_16x16x32_bf16 v[96:99], a[144:147], v[64:67], 0
    v_cvt_pk_bf16_f32 v230, v252, v253
    v_mfma_f32_16x16x32_bf16 v[100:103], a[160:163], v[64:67], 0
    s_mov_b32 s63, 16384
    s_add_u32 m0, s59, 16384
    s_nop 0
    buffer_load_dwordx4 v10, s[16:19], s63 offen offset:0 nt lds
    v_mfma_f32_16x16x32_bf16 v[104:107], a[176:179], v[64:67], 0
    v_cvt_pk_bf16_f32 v231, v254, v255
    v_mfma_f32_16x16x32_bf16 v[108:111], a[192:195], v[64:67], 0
    v_cvt_pk_bf16_f32 v224, v224, v225
    buffer_load_dwordx4 v11, s[16:19], s63 offen offset:1024 nt lds
    v_mfma_f32_16x16x32_bf16 v[88:91], a[116:119], v[112:115], v[88:91]
    v_cvt_pk_bf16_f32 v225, v226, v227
    v_mfma_f32_16x16x32_bf16 v[92:95], a[132:135], v[112:115], v[92:95]
    v_cvt_pk_bf16_f32 v226, v248, v249
    v_mfma_f32_16x16x32_bf16 v[96:99], a[148:151], v[112:115], v[96:99]
    v_cvt_pk_bf16_f32 v227, v250, v251
    v_mfma_f32_16x16x32_bf16 v[100:103], a[164:167], v[112:115], v[100:103]
    buffer_load_dwordx4 v10, s[16:19], s63 offen offset:2048 nt lds
    v_mfma_f32_16x16x32_bf16 v[104:107], a[180:183], v[112:115], v[104:107]
    v_cvt_pk_bf16_f32 v220, v220, v221
    v_mfma_f32_16x16x32_bf16 v[108:111], a[196:199], v[112:115], v[108:111]
    v_cvt_pk_bf16_f32 v221, v222, v223
    buffer_load_dwordx4 v11, s[16:19], s63 offen offset:3072 nt lds
    v_mfma_f32_16x16x32_bf16 v[88:91], a[120:123], v[160:163], v[88:91]
    v_cvt_pk_bf16_f32 v222, v244, v245
    v_mfma_f32_16x16x32_bf16 v[92:95], a[136:139], v[160:163], v[92:95]
    v_cvt_pk_bf16_f32 v223, v246, v247
    v_mfma_f32_16x16x32_bf16 v[96:99], a[152:155], v[160:163], v[96:99]
    v_cvt_pk_bf16_f32 v216, v216, v217
    v_mfma_f32_16x16x32_bf16 v[100:103], a[168:171], v[160:163], v[100:103]
    s_mov_b32 s63, 20480
    s_add_u32 m0, s59, 20480
    s_nop 0
    buffer_load_dwordx4 v10, s[16:19], s63 offen offset:0 nt lds
    v_mfma_f32_16x16x32_bf16 v[104:107], a[184:187], v[160:163], v[104:107]
    v_cvt_pk_bf16_f32 v217, v218, v219
    v_mfma_f32_16x16x32_bf16 v[108:111], a[200:203], v[160:163], v[108:111]
    v_cvt_pk_bf16_f32 v218, v240, v241
    buffer_load_dwordx4 v11, s[16:19], s63 offen offset:1024 nt lds
    v_mfma_f32_16x16x32_bf16 v[88:91], a[124:127], v[208:211], v[88:91]
    v_cvt_pk_bf16_f32 v219, v242, v243
    v_mfma_f32_16x16x32_bf16 v[92:95], a[140:143], v[208:211], v[92:95]
    v_cvt_pk_bf16_f32 v212, v212, v213
    v_mfma_f32_16x16x32_bf16 v[96:99], a[156:159], v[208:211], v[96:99]
    v_cvt_pk_bf16_f32 v213, v214, v215
    v_mfma_f32_16x16x32_bf16 v[100:103], a[172:175], v[208:211], v[100:103]
    buffer_load_dwordx4 v10, s[16:19], s63 offen offset:2048 nt lds
    v_mfma_f32_16x16x32_bf16 v[104:107], a[188:191], v[208:211], v[104:107]
    v_cvt_pk_bf16_f32 v214, v236, v237
    v_mfma_f32_16x16x32_bf16 v[108:111], a[204:207], v[208:211], v[108:111]
    v_cvt_pk_bf16_f32 v215, v238, v239
    buffer_load_dwordx4 v11, s[16:19], s63 offen offset:3072 nt lds
    s_cmp_eq_u32 s54, 0
    s_cbranch_scc0 L_hs_skip
    s_lshl_b32 s3, s41, 3
    s_add_u32 s3, s3, 0
    v_mov_b32 v29, 1
    v_mov_b32 v30, s3
    s_mov_b64 exec, 1
    buffer_atomic_add v29, v30, s[36:39], 0 offen sc1
    s_mov_b64 exec, -1
L_hs_skip:
    v_mfma_f32_16x16x32_bf16 v[136:139], a[112:115], v[68:71], 0
    v_max3_f32 v12, v88, v89, v90
    v_max3_f32 v12, v12, v91, v92
    v_max3_f32 v12, v12, v93, v94
    v_mfma_f32_16x16x32_bf16 v[140:143], a[128:131], v[68:71], 0
    v_max3_f32 v12, v12, v95, v96
    v_max3_f32 v12, v12, v97, v98
    v_max3_f32 v12, v12, v99, v100
    v_mfma_f32_16x16x32_bf16 v[144:147], a[144:147], v[68:71], 0
    v_max3_f32 v12, v12, v101, v102
    v_max3_f32 v12, v12, v103, v104
    v_max3_f32 v12, v12, v105, v106
    v_mfma_f32_16x16x32_bf16 v[148:151], a[160:163], v[68:71], 0
    v_max3_f32 v12, v12, v107, v108
    v_max3_f32 v12, v12, v109, v110
    v_max_f32 v12, v12, v111
    v_mov_b32 v13, v12
    v_mfma_f32_16x16x32_bf16 v[152:155], a[176:179], v[68:71], 0
    s_nop 0
    v_permlane32_swap_b32 v12, v13
    v_max_f32 v12, v12, v13
    v_mov_b32 v13, v12
    v_mfma_f32_16x16x32_bf16 v[156:159], a[192:195], v[68:71], 0
    s_nop 0
    v_permlane16_swap_b32 v12, v13
    v_max_f32 v12, v12, v13
    v_mul_f32 v12, s71, v12
    v_mfma_f32_16x16x32_bf16 v[136:139], a[116:119], v[116:119], v[136:139]
    v_fma_f32 v88, v88, s71, -v12
    v_fma_f32 v89, v89, s71, -v12
    v_fma_f32 v90, v90, s71, -v12
    v_fma_f32 v91, v91, s71, -v12
    v_mfma_f32_16x16x32_bf16 v[140:143], a[132:135], v[116:119], v[140:143]
    v_fma_f32 v92, v92, s71, -v12
    v_fma_f32 v93, v93, s71, -v12
    v_fma_f32 v94, v94, s71, -v12
    v_mfma_f32_16x16x32_bf16 v[144:147], a[148:151], v[116:119], v[144:147]
    v_fma_f32 v95, v95, s71, -v12
    v_fma_f32 v96, v96, s71, -v12
    v_fma_f32 v97, v97, s71, -v12
    v_mfma_f32_16x16x32_bf16 v[148:151], a[164:167], v[116:119], v[148:151]
    v_fma_f32 v98, v98, s71, -v12
    v_fma_f32 v99, v99, s71, -v12
    v_fma_f32 v100, v100, s71, -v12
    v_mfma_f32_16x16x32_bf16 v[152:155], a[180:183], v[116:119], v[152:155]
    v_fma_f32 v101, v101, s71, -v12
    v_fma_f32 v102, v102, s71, -v12
    v_fma_f32 v103, v103, s71, -v12
    v_fma_f32 v104, v104, s71, -v12
    v_mfma_f32_16x16x32_bf16 v[156:159], a[196:199], v[116:119], v[156:159]
    v_fma_f32 v105, v105, s71, -v12
    v_fma_f32 v106, v106, s71, -v12
    v_fma_f32 v107, v107, s71, -v12
    v_mfma_f32_16x16x32_bf16 v[136:139], a[120:123], v[164:167], v[136:139]
    v_fma_f32 v108, v108, s71, -v12
    v_fma_f32 v109, v109, s71, -v12
    v_fma_f32 v110, v110, s71, -v12
    v_mfma_f32_16x16x32_bf16 v[140:143], a[136:139], v[164:167], v[140:143]
    v_fma_f32 v111, v111, s71, -v12
    v_exp_f32 v88, v88
    v_exp_f32 v89, v89
    v_exp_f32 v90, v90
    v_mfma_f32_16x16x32_bf16 v[144:147], a[152:155], v[164:167], v[144:147]
    v_exp_f32 v91, v91
    v_exp_f32 v92, v92
    v_exp_f32 v93, v93
    v_mfma_f32_16x16x32_bf16 v[148:151], a[168:171], v[164:167], v[148:151]
    v_exp_f32 v94, v94
    v_exp_f32 v95, v95
    v_exp_f32 v96, v96
    v_mfma_f32_16x16x32_bf16 v[152:155], a[184:187], v[164:167], v[152:155]
    v_exp_f32 v97, v97
    v_exp_f32 v98, v98
    v_exp_f32 v99, v99
    v_mfma_f32_16x16x32_bf16 v[156:159], a[200:203], v[164:167], v[156:159]
    v_exp_f32 v100, v100
    v_exp_f32 v101, v101
    v_exp_f32 v102, v102
    v_exp_f32 v103, v103
    v_mfma_f32_16x16x32_bf16 v[136:139], a[124:127], v[212:215], v[136:139]
    v_exp_f32 v104, v104
    v_exp_f32 v105, v105
    v_exp_f32 v106, v106
    v_mfma_f32_16x16x32_bf16 v[140:143], a[140:143], v[212:215], v[140:143]
    v_exp_f32 v107, v107
    v_exp_f32 v108, v108
    v_exp_f32 v109, v109
    v_mfma_f32_16x16x32_bf16 v[144:147], a[156:159], v[212:215], v[144:147]
    v_exp_f32 v110, v110
    v_exp_f32 v111, v111
    v_cvt_pk_bf16_f32 v64, v88, v89
    v_cvt_pk_bf16_f32 v65, v90, v91
    v_mfma_f32_16x16x32_bf16 v[148:151], a[172:175], v[212:215], v[148:151]
    v_cvt_pk_bf16_f32 v66, v92, v93
    v_cvt_pk_bf16_f32 v67, v94, v95
    v_cvt_pk_bf16_f32 v112, v96, v97
    v_mfma_f32_16x16x32_bf16 v[152:155], a[188:191], v[212:215], v[152:155]
    v_cvt_pk_bf16_f32 v113, v98, v99
    v_cvt_pk_bf16_f32 v114, v100, v101
    v_cvt_pk_bf16_f32 v115, v102, v103
    v_mfma_f32_16x16x32_bf16 v[156:159], a[204:207], v[212:215], v[156:159]
    v_cvt_pk_bf16_f32 v160, v104, v105
    v_cvt_pk_bf16_f32 v161, v106, v107
    v_cvt_pk_bf16_f32 v162, v108, v109
    v_cvt_pk_bf16_f32 v163, v110, v111
    v_mfma_f32_16x16x32_bf16 v[88:91], a[112:115], v[72:75], 0
    v_max3_f32 v12, v136, v137, v138
    v_max3_f32 v12, v12, v139, v140
    v_max3_f32 v12, v12, v141, v142
    v_mfma_f32_16x16x32_bf16 v[92:95], a[128:131], v[72:75], 0
    v_max3_f32 v12, v12, v143, v144
    v_max3_f32 v12, v12, v145, v146
    v_max3_f32 v12, v12, v147, v148
    v_mfma_f32_16x16x32_bf16 v[96:99], a[144:147], v[72:75], 0
    v_max3_f32 v12, v12, v149, v150
    v_max3_f32 v12, v12, v151, v152
    v_max3_f32 v12, v12, v153, v154
    v_mfma_f32_16x16x32_bf16 v[100:103], a[160:163], v[72:75], 0
    v_max3_f32 v12, v12, v155, v156
    v_max3_f32 v12, v12, v157, v158
    v_max_f32 v12, v12, v159
    v_mov_b32 v13, v12
    v_mfma_f32_16x16x32_bf16 v[104:107], a[176:179], v[72:75], 0
    s_nop 0
    v_permlane32_swap_b32 v12, v13
    v_max_f32 v12, v12, v13
    v_mov_b32 v13, v12
    v_mfma_f32_16x16x32_bf16 v[108:111], a[192:195], v[72:75], 0
    s_nop 0
    v_permlane16_swap_b32 v12, v13
    v_max_f32 v12, v12, v13
    v_mul_f32 v12, s71, v12
    v_mfma_f32_16x16x32_bf16 v[88:91], a[116:119], v[120:123], v[88:91]
    v_fma_f32 v136, v136, s71, -v12
    v_fma_f32 v137, v137, s71, -v12
    v_fma_f32 v138, v138, s71, -v12
    v_fma_f32 v139, v139, s71, -v12
    v_mfma_f32_16x16x32_bf16 v[92:95], a[132:135], v[120:123], v[92:95]
    v_fma_f32 v140, v140, s71, -v12
    v_fma_f32 v141, v141, s71, -v12
    v_fma_f32 v142, v142, s71, -v12
    v_mfma_f32_16x16x32_bf16 v[96:99], a[148:151], v[120:123], v[96:99]
    v_fma_f32 v143, v143, s71, -v12
    v_fma_f32 v144, v144, s71, -v12
    v_fma_f32 v145, v145, s71, -v12
    v_mfma_f32_16x16x32_bf16 v[100:103], a[164:167], v[120:123], v[100:103]
    v_fma_f32 v146, v146, s71, -v12
    v_fma_f32 v147, v147, s71, -v12
    v_fma_f32 v148, v148, s71, -v12
    v_mfma_f32_16x16x32_bf16 v[104:107], a[180:183], v[120:123], v[104:107]
    v_fma_f32 v149, v149, s71, -v12
    v_fma_f32 v150, v150, s71, -v12
    v_fma_f32 v151, v151, s71, -v12
    v_fma_f32 v152, v152, s71, -v12
    v_mfma_f32_16x16x32_bf16 v[108:111], a[196:199], v[120:123], v[108:111]
    v_fma_f32 v153, v153, s71, -v12
    v_fma_f32 v154, v154, s71, -v12
    v_fma_f32 v155, v155, s71, -v12
    v_mfma_f32_16x16x32_bf16 v[88:91], a[120:123], v[168:171], v[88:91]
    v_fma_f32 v156, v156, s71, -v12
    v_fma_f32 v157, v157, s71, -v12
    v_fma_f32 v158, v158, s71, -v12
    v_mfma_f32_16x16x32_bf16 v[92:95], a[136:139], v[168:171], v[92:95]
    v_fma_f32 v159, v159, s71, -v12
    v_exp_f32 v136, v136
    v_exp_f32 v137, v137
    v_exp_f32 v138, v138
    v_mfma_f32_16x16x32_bf16 v[96:99], a[152:155], v[168:171], v[96:99]
    v_exp_f32 v139, v139
    v_exp_f32 v140, v140
    v_exp_f32 v141, v141
    v_mfma_f32_16x16x32_bf16 v[100:103], a[168:171], v[168:171], v[100:103]
    v_exp_f32 v142, v142
    v_exp_f32 v143, v143
    v_exp_f32 v144, v144
    v_mfma_f32_16x16x32_bf16 v[104:107], a[184:187], v[168:171], v[104:107]
    v_exp_f32 v145, v145
    v_exp_f32 v146, v146
    v_exp_f32 v147, v147
    v_mfma_f32_16x16x32_bf16 v[108:111], a[200:203], v[168:171], v[108:111]
    v_exp_f32 v148, v148
    v_exp_f32 v149, v149
    v_exp_f32 v150, v150
    v_exp_f32 v151, v151
    v_mfma_f32_16x16x32_bf16 v[88:91], a[124:127], v[216:219], v[88:91]
    v_exp_f32 v152, v152
    v_exp_f32 v153, v153
    v_exp_f32 v154, v154
    v_mfma_f32_16x16x32_bf16 v[92:95], a[140:143], v[216:219], v[92:95]
    v_exp_f32 v155, v155
    v_exp_f32 v156, v156
    v_exp_f32 v157, v157
    v_mfma_f32_16x16x32_bf16 v[96:99], a[156:159], v[216:219], v[96:99]
    v_exp_f32 v158, v158
    v_exp_f32 v159, v159
    v_cvt_pk_bf16_f32 v68, v136, v137
    v_cvt_pk_bf16_f32 v69, v138, v139
    v_mfma_f32_16x16x32_bf16 v[100:103], a[172:175], v[216:219], v[100:103]
    v_cvt_pk_bf16_f32 v70, v140, v141
    v_cvt_pk_bf16_f32 v71, v142, v143
    v_cvt_pk_bf16_f32 v116, v144, v145
    v_mfma_f32_16x16x32_bf16 v[104:107], a[188:191], v[216:219], v[104:107]
    v_cvt_pk_bf16_f32 v117, v146, v147
    v_cvt_pk_bf16_f32 v118, v148, v149
    v_cvt_pk_bf16_f32 v119, v150, v151
    v_mfma_f32_16x16x32_bf16 v[108:111], a[204:207], v[216:219], v[108:111]
    v_cvt_pk_bf16_f32 v164, v152, v153
    v_cvt_pk_bf16_f32 v165, v154, v155
    v_cvt_pk_bf16_f32 v166, v156, v157
    v_cvt_pk_bf16_f32 v167, v158, v159
    v_mfma_f32_16x16x32_bf16 v[136:139], a[112:115], v[76:79], 0
    v_max3_f32 v12, v88, v89, v90
    v_max3_f32 v12, v12, v91, v92
    v_max3_f32 v12, v12, v93, v94
    v_mfma_f32_16x16x32_bf16 v[140:143], a[128:131], v[76:79], 0
    v_max3_f32 v12, v12, v95, v96
    v_max3_f32 v12, v12, v97, v98
    v_max3_f32 v12, v12, v99, v100
    v_mfma_f32_16x16x32_bf16 v[144:147], a[144:147], v[76:79], 0
    v_max3_f32 v12, v12, v101, v102
    v_max3_f32 v12, v12, v103, v104
    v_max3_f32 v12, v12, v105, v106
    v_mfma_f32_16x16x32_bf16 v[148:151], a[160:163], v[76:79], 0
    v_max3_f32 v12, v12, v107, v108
    v_max3_f32 v12, v12, v109, v110
    v_max_f32 v12, v12, v111
    v_mov_b32 v13, v12
    v_mfma_f32_16x16x32_bf16 v[152:155], a[176:179], v[76:79], 0
    s_nop 0
    v_permlane32_swap_b32 v12, v13
    v_max_f32 v12, v12, v13
    v_mov_b32 v13, v12
    v_mfma_f32_16x16x32_bf16 v[156:159], a[192:195], v[76:79], 0
    s_nop 0
    v_permlane16_swap_b32 v12, v13
    v_max_f32 v12, v12, v13
    v_mul_f32 v12, s71, v12
    v_mfma_f32_16x16x32_bf16 v[136:139], a[116:119], v[124:127], v[136:139]
    v_fma_f32 v88, v88, s71, -v12
    v_fma_f32 v89, v89, s71, -v12
    v_fma_f32 v90, v90, s71, -v12
    v_fma_f32 v91, v91, s71, -v12
    v_mfma_f32_16x16x32_bf16 v[140:143], a[132:135], v[124:127], v[140:143]
    v_fma_f32 v92, v92, s71, -v12
    v_fma_f32 v93, v93, s71, -v12
    v_fma_f32 v94, v94, s71, -v12
    v_mfma_f32_16x16x32_bf16 v[144:147], a[148:151], v[124:127], v[144:147]
    v_fma_f32 v95, v95, s71, -v12
    v_fma_f32 v96, v96, s71, -v12
    v_fma_f32 v97, v97, s71, -v12
    v_mfma_f32_16x16x32_bf16 v[148:151], a[164:167], v[124:127], v[148:151]
    v_fma_f32 v98, v98, s71, -v12
    v_fma_f32 v99, v99, s71, -v12
    v_fma_f32 v100, v100, s71, -v12
    v_mfma_f32_16x16x32_bf16 v[152:155], a[180:183], v[124:127], v[152:155]
    v_fma_f32 v101, v101, s71, -v12
    v_fma_f32 v102, v102, s71, -v12
    v_fma_f32 v103, v103, s71, -v12
    v_fma_f32 v104, v104, s71, -v12
    v_mfma_f32_16x16x32_bf16 v[156:159], a[196:199], v[124:127], v[156:159]
    v_fma_f32 v105, v105, s71, -v12
    v_fma_f32 v106, v106, s71, -v12
    v_fma_f32 v107, v107, s71, -v12
    v_mfma_f32_16x16x32_bf16 v[136:139], a[120:123], v[172:175], v[136:139]
    v_fma_f32 v108, v108, s71, -v12
    v_fma_f32 v109, v109, s71, -v12
    v_fma_f32 v110, v110, s71, -v12
    v_mfma_f32_16x16x32_bf16 v[140:143], a[136:139], v[172:175], v[140:143]
    v_fma_f32 v111, v111, s71, -v12
    v_exp_f32 v88, v88
    v_exp_f32 v89, v89
    v_exp_f32 v90, v90
    v_mfma_f32_16x16x32_bf16 v[144:147], a[152:155], v[172:175], v[144:147]
    v_exp_f32 v91, v91
    v_exp_f32 v92, v92
    v_exp_f32 v93, v93
    v_mfma_f32_16x16x32_bf16 v[148:151], a[168:171], v[172:175], v[148:151]
    v_exp_f32 v94, v94
    v_exp_f32 v95, v95
    v_exp_f32 v96, v96
    v_mfma_f32_16x16x32_bf16 v[152:155], a[184:187], v[172:175], v[152:155]
    v_exp_f32 v97, v97
    v_exp_f32 v98, v98
    v_exp_f32 v99, v99
    v_mfma_f32_16x16x32_bf16 v[156:159], a[200:203], v[172:175], v[156:159]
    v_exp_f32 v100, v100
    v_exp_f32 v101, v101
    v_exp_f32 v102, v102
    v_exp_f32 v103, v103
    v_mfma_f32_16x16x32_bf16 v[136:139], a[124:127], v[220:223], v[136:139]
    v_exp_f32 v104, v104
    v_exp_f32 v105, v105
    v_exp_f32 v106, v106
    v_mfma_f32_16x16x32_bf16 v[140:143], a[140:143], v[220:223], v[140:143]
    v_exp_f32 v107, v107
    v_exp_f32 v108, v108
    v_exp_f32 v109, v109
    v_mfma_f32_16x16x32_bf16 v[144:147], a[156:159], v[220:223], v[144:147]
    v_exp_f32 v110, v110
    v_exp_f32 v111, v111
    v_cvt_pk_bf16_f32 v72, v88, v89
    v_cvt_pk_bf16_f32 v73, v90, v91
    v_mfma_f32_16x16x32_bf16 v[148:151], a[172:175], v[220:223], v[148:151]
    v_cvt_pk_bf16_f32 v74, v92, v93
    v_cvt_pk_bf16_f32 v75, v94, v95
    v_cvt_pk_bf16_f32 v120, v96, v97
    v_mfma_f32_16x16x32_bf16 v[152:155], a[188:191], v[220:223], v[152:155]
    v_cvt_pk_bf16_f32 v121, v98, v99
    v_cvt_pk_bf16_f32 v122, v100, v101
    v_cvt_pk_bf16_f32 v123, v102, v103
    v_mfma_f32_16x16x32_bf16 v[156:159], a[204:207], v[220:223], v[156:159]
    v_cvt_pk_bf16_f32 v168, v104, v105
    v_cvt_pk_bf16_f32 v169, v106, v107
    v_cvt_pk_bf16_f32 v170, v108, v109
    v_cvt_pk_bf16_f32 v171, v110, v111
    v_mfma_f32_16x16x32_bf16 v[88:91], a[112:115], v[80:83], 0
    v_max3_f32 v12, v136, v137, v138
    v_max3_f32 v12, v12, v139, v140
    v_max3_f32 v12, v12, v141, v142
    v_mfma_f32_16x16x32_bf16 v[92:95], a[128:131], v[80:83], 0
    v_max3_f32 v12, v12, v143, v144
    v_max3_f32 v12, v12, v145, v146
    v_max3_f32 v12, v12, v147, v148
    v_max3_f32 v12, v12, v149, v150
    v_mfma_f32_16x16x32_bf16 v[96:99], a[144:147], v[80:83], 0
    s_add_u32 s68, s72, 0
    s_and_b32 s68, s68, 3
    s_lshl_b32 s68, s68, 8
    s_add_u32 s65, s68, 0
    v_max3_f32 v12, v12, v151, v152
    v_max3_f32 v12, v12, v153, v154
    v_max3_f32 v12, v12, v155, v156
    v_mfma_f32_16x16x32_bf16 v[100:103], a[160:163], v[80:83], 0
    v_max3_f32 v12, v12, v157, v158
    v_max_f32 v12, v12, v159
    v_mov_b32 v13, v12
    s_nop 1
    v_permlane32_swap_b32 v12, v13
    s_add_u32 m0, s59, 24584
    v_mfma_f32_16x16x32_bf16 v[104:107], a[176:179], v[80:83], 0
    buffer_load_dwordx4 v22, s[24:27], s65 offen  lds
    v_max_f32 v12, v12, v13
    v_mov_b32 v13, v12
    v_mfma_f32_16x16x32_bf16 v[108:111], a[192:195], v[80:83], 0
    s_nop 0
    v_permlane16_swap_b32 v12, v13
    v_max_f32 v12, v12, v13
    v_mul_f32 v12, s71, v12
    v_fma_f32 v136, v136, s71, -v12
    s_add_u32 m0, s67, 0
    v_mfma_f32_16x16x32_bf16 v[88:91], a[116:119], v[128:131], v[88:91]
    buffer_load_dwordx4 v23, s[24:27], s65 offen  lds
    v_fma_f32 v137, v137, s71, -v12
    v_fma_f32 v138, v138, s71, -v12
    v_fma_f32 v139, v139, s71, -v12
    v_mfma_f32_16x16x32_bf16 v[92:95], a[132:135], v[128:131], v[92:95]
    v_fma_f32 v140, v140, s71, -v12
    v_fma_f32 v141, v141, s71, -v12
    v_fma_f32 v142, v142, s71, -v12
    v_fma_f32 v143, v143, s71, -v12
    v_mfma_f32_16x16x32_bf16 v[96:99], a[148:151], v[128:131], v[96:99]
    s_add_u32 s65, s68, 32768
    v_fma_f32 v144, v144, s71, -v12
    v_fma_f32 v145, v145, s71, -v12
    v_fma_f32 v146, v146, s71, -v12
    v_mfma_f32_16x16x32_bf16 v[100:103], a[164:167], v[128:131], v[100:103]
    v_fma_f32 v147, v147, s71, -v12
    v_fma_f32 v148, v148, s71, -v12
    v_fma_f32 v149, v149, s71, -v12
    s_add_u32 m0, s59, 25608
    v_mfma_f32_16x16x32_bf16 v[104:107], a[180:183], v[128:131], v[104:107]
    buffer_load_dwordx4 v22, s[24:27], s65 offen  lds
    v_fma_f32 v150, v150, s71, -v12
    v_fma_f32 v151, v151, s71, -v12
    v_fma_f32 v152, v152, s71, -v12
    v_mfma_f32_16x16x32_bf16 v[108:111], a[196:199], v[128:131], v[108:111]
    v_fma_f32 v153, v153, s71, -v12
    v_fma_f32 v154, v154, s71, -v12
    v_fma_f32 v155, v155, s71, -v12
    v_fma_f32 v156, v156, s71, -v12
    s_add_u32 m0, s67, 1024
    v_mfma_f32_16x16x32_bf16 v[88:91], a[120:123], v[176:179], v[88:91]
    buffer_load_dwordx4 v23, s[24:27], s65 offen  lds
    v_fma_f32 v157, v157, s71, -v12
    v_fma_f32 v158, v158, s71, -v12
    v_fma_f32 v159, v159, s71, -v12
    v_mfma_f32_16x16x32_bf16 v[92:95], a[136:139], v[176:179], v[92:95]
    v_exp_f32 v136, v136
    v_exp_f32 v137, v137
    v_exp_f32 v138, v138
    v_exp_f32 v139, v139
    v_mfma_f32_16x16x32_bf16 v[96:99], a[152:155], v[176:179], v[96:99]
    s_add_u32 s65, s68, 65536
    v_exp_f32 v140, v140
    v_exp_f32 v141, v141
    v_mfma_f32_16x16x32_bf16 v[100:103], a[168:171], v[176:179], v[100:103]
    v_exp_f32 v142, v142
    v_exp_f32 v143, v143
    v_exp_f32 v144, v144
    v_exp_f32 v145, v145
    s_add_u32 m0, s59, 26632
    v_mfma_f32_16x16x32_bf16 v[104:107], a[184:187], v[176:179], v[104:107]
    buffer_load_dwordx4 v22, s[24:27], s65 offen  lds
    v_exp_f32 v146, v146
    v_exp_f32 v147, v147
    v_exp_f32 v148, v148
    v_mfma_f32_16x16x32_bf16 v[108:111], a[200:203], v[176:179], v[108:111]
    v_exp_f32 v149, v149
    v_exp_f32 v150, v150
    v_exp_f32 v151, v151
    v_exp_f32 v152, v152
    s_add_u32 m0, s67, 2048
    v_mfma_f32_16x16x32_bf16 v[88:91], a[124:127], v[224:227], v[88:91]
    buffer_load_dwordx4 v23, s[24:27], s65 offen  lds
    v_exp_f32 v153, v153
    v_exp_f32 v154, v154
    v_exp_f32 v155, v155
    v_mfma_f32_16x16x32_bf16 v[92:95], a[140:143], v[224:227], v[92:95]
    v_exp_f32 v156, v156
    v_exp_f32 v157, v157
    v_exp_f32 v158, v158
    v_mfma_f32_16x16x32_bf16 v[96:99], a[156:159], v[224:227], v[96:99]
    s_add_u32 s65, s68, 98304
    v_exp_f32 v159, v159
    v_cvt_pk_bf16_f32 v76, v136, v137
    v_cvt_pk_bf16_f32 v77, v138, v139
    v_mfma_f32_16x16x32_bf16 v[100:103], a[172:175], v[224:227], v[100:103]
    v_cvt_pk_bf16_f32 v78, v140, v141
    v_cvt_pk_bf16_f32 v79, v142, v143
    v_cvt_pk_bf16_f32 v124, v144, v145
    v_cvt_pk_bf16_f32 v125, v146, v147
    s_add_u32 m0, s59, 27656
    v_mfma_f32_16x16x32_bf16 v[104:107], a[188:191], v[224:227], v[104:107]
    buffer_load_dwordx4 v22, s[24:27], s65 offen  lds
    v_cvt_pk_bf16_f32 v126, v148, v149
    v_cvt_pk_bf16_f32 v127, v150, v151
    v_cvt_pk_bf16_f32 v172, v152, v153
    v_mfma_f32_16x16x32_bf16 v[108:111], a[204:207], v[224:227], v[108:111]
    v_cvt_pk_bf16_f32 v173, v154, v155
    v_cvt_pk_bf16_f32 v174, v156, v157
    v_cvt_pk_bf16_f32 v175, v158, v159
    s_add_u32 m0, s67, 3072
    s_nop 0
    buffer_load_dwordx4 v23, s[24:27], s65 offen  lds
    s_waitcnt vmcnt(8)
    v_mfma_f32_16x16x32_bf16 v[136:139], a[112:115], v[84:87], 0
    v_max3_f32 v12, v88, v89, v90
    v_max3_f32 v12, v12, v91, v92
    v_xor_b32 v29, 0, v18
    ds_read_b64_tr_b16 a[0:1], v29 offset:0
    v_max3_f32 v12, v12, v93, v94
    v_max3_f32 v12, v12, v95, v96
    v_mfma_f32_16x16x32_bf16 v[140:143], a[128:131], v[84:87], 0
    ds_read_b64_tr_b16 a[2:3], v29 offset:4096
    v_max3_f32 v12, v12, v97, v98
    ds_read_b64_tr_b16 a[4:5], v29 offset:8192
    v_max3_f32 v12, v12, v99, v100
    v_max3_f32 v12, v12, v101, v102
    ds_read_b64_tr_b16 a[6:7], v29 offset:12288
    v_mfma_f32_16x16x32_bf16 v[144:147], a[144:147], v[84:87], 0
    v_max3_f32 v12, v12, v103, v104
    v_max3_f32 v12, v12, v105, v106
    ds_read_b64_tr_b16 a[8:9], v29 offset:16384
    v_max3_f32 v12, v12, v107, v108
    s_add_u32 s65, s68, 131072
    ds_read_b64_tr_b16 a[10:11], v29 offset:20480
    v_mfma_f32_16x16x32_bf16 v[148:151], a[160:163], v[84:87], 0
    v_max3_f32 v12, v12, v109, v110
    v_max_f32 v12, v12, v111
    v_xor_b32 v30, 32, v18
    ds_read_b64_tr_b16 a[12:13], v30 offset:0
    v_mov_b32 v13, v12
    s_nop 1
    v_permlane32_swap_b32 v12, v13
    v_mfma_f32_16x16x32_bf16 v[152:155], a[176:179], v[84:87], 0
    ds_read_b64_tr_b16 a[14:15], v30 offset:4096
    v_max_f32 v12, v12, v13
    ds_read_b64_tr_b16 a[16:17], v30 offset:8192
    v_mov_b32 v13, v12
    s_nop 1
    v_permlane16_swap_b32 v12, v13
    ds_read_b64_tr_b16 a[18:19], v30 offset:12288
    v_mfma_f32_16x16x32_bf16 v[156:159], a[192:195], v[84:87], 0
    v_max_f32 v12, v12, v13
    v_mul_f32 v12, s71, v12
    s_add_u32 m0, s59, 28680
    s_nop 0
    buffer_load_dwordx4 v22, s[24:27], s65 offen  lds
    ds_read_b64_tr_b16 a[20:21], v30 offset:16384
    v_fma_f32 v88, v88, s71, -v12
    ds_read_b64_tr_b16 a[22:23], v30 offset:20480
    v_mfma_f32_16x16x32_bf16 v[136:139], a[116:119], v[132:135], v[136:139]
    v_fma_f32 v89, v89, s71, -v12
    v_fma_f32 v90, v90, s71, -v12
    v_xor_b32 v29, 64, v18
    ds_read_b64_tr_b16 a[24:25], v29 offset:0
    v_fma_f32 v91, v91, s71, -v12
    v_fma_f32 v92, v92, s71, -v12
    v_mfma_f32_16x16x32_bf16 v[140:143], a[132:135], v[132:135], v[140:143]
    ds_read_b64_tr_b16 a[26:27], v29 offset:4096
    v_fma_f32 v93, v93, s71, -v12
    ds_read_b64_tr_b16 a[28:29], v29 offset:8192
    v_fma_f32 v94, v94, s71, -v12
    v_fma_f32 v95, v95, s71, -v12
    ds_read_b64_tr_b16 a[30:31], v29 offset:12288
    s_add_u32 m0, s67, 4096
    v_mfma_f32_16x16x32_bf16 v[144:147], a[148:151], v[132:135], v[144:147]
    buffer_load_dwordx4 v23, s[24:27], s65 offen  lds
    v_fma_f32 v96, v96, s71, -v12
    ds_read_b64_tr_b16 a[32:33], v29 offset:16384
    v_fma_f32 v97, v97, s71, -v12
    v_fma_f32 v98, v98, s71, -v12
    ds_read_b64_tr_b16 a[34:35], v29 offset:20480
    v_mfma_f32_16x16x32_bf16 v[148:151], a[164:167], v[132:135], v[148:151]
    v_fma_f32 v99, v99, s71, -v12
    v_fma_f32 v100, v100, s71, -v12
    v_xor_b32 v30, 96, v18
    ds_read_b64_tr_b16 a[36:37], v30 offset:0
    v_fma_f32 v101, v101, s71, -v12
    ds_read_b64_tr_b16 a[38:39], v30 offset:4096
    v_mfma_f32_16x16x32_bf16 v[152:155], a[180:183], v[132:135], v[152:155]
    v_fma_f32 v102, v102, s71, -v12
    v_fma_f32 v103, v103, s71, -v12
    ds_read_b64_tr_b16 a[40:41], v30 offset:8192
    v_fma_f32 v104, v104, s71, -v12
    s_add_u32 s65, s68, 163840
    v_fma_f32 v105, v105, s71, -v12
    v_mfma_f32_16x16x32_bf16 v[156:159], a[196:199], v[132:135], v[156:159]
    ds_read_b64_tr_b16 a[42:43], v30 offset:12288
    v_fma_f32 v106, v106, s71, -v12
    ds_read_b64_tr_b16 a[44:45], v30 offset:16384
    v_fma_f32 v107, v107, s71, -v12
    v_fma_f32 v108, v108, s71, -v12
    ds_read_b64_tr_b16 a[46:47], v30 offset:20480
    v_mfma_f32_16x16x32_bf16 v[136:139], a[120:123], v[180:183], v[136:139]
    v_fma_f32 v109, v109, s71, -v12
    v_fma_f32 v110, v110, s71, -v12
    v_xor_b32 v29, 128, v18
    ds_read_b64_tr_b16 a[48:49], v29 offset:0
    v_fma_f32 v111, v111, s71, -v12
    ds_read_b64_tr_b16 a[50:51], v29 offset:4096
    v_mfma_f32_16x16x32_bf16 v[140:143], a[136:139], v[180:183], v[140:143]
    v_exp_f32 v88, v88
    v_exp_f32 v89, v89
    s_add_u32 m0, s59, 29704
    s_nop 0
    buffer_load_dwordx4 v22, s[24:27], s65 offen  lds
    ds_read_b64_tr_b16 a[52:53], v29 offset:8192
    v_exp_f32 v90, v90
    v_exp_f32 v91, v91
    v_mfma_f32_16x16x32_bf16 v[144:147], a[152:155], v[180:183], v[144:147]
    ds_read_b64_tr_b16 a[54:55], v29 offset:12288
    v_exp_f32 v92, v92
    ds_read_b64_tr_b16 a[56:57], v29 offset:16384
    v_exp_f32 v93, v93
    v_exp_f32 v94, v94
    ds_read_b64_tr_b16 a[58:59], v29 offset:20480
    v_mfma_f32_16x16x32_bf16 v[148:151], a[168:171], v[180:183], v[148:151]
    v_exp_f32 v95, v95
    v_exp_f32 v96, v96
    v_xor_b32 v30, 160, v18
    ds_read_b64_tr_b16 a[60:61], v30 offset:0
    v_exp_f32 v97, v97
    ds_read_b64_tr_b16 a[62:63], v30 offset:4096
    s_add_u32 m0, s67, 5120
    v_mfma_f32_16x16x32_bf16 v[152:155], a[184:187], v[180:183], v[152:155]
    buffer_load_dwordx4 v23, s[24:27], s65 offen  lds
    v_exp_f32 v98, v98
    v_exp_f32 v99, v99
    ds_read_b64_tr_b16 a[64:65], v30 offset:8192
    v_exp_f32 v100, v100
    ds_read_b64_tr_b16 a[66:67], v30 offset:12288
    v_mfma_f32_16x16x32_bf16 v[156:159], a[200:203], v[180:183], v[156:159]
    v_exp_f32 v101, v101
    v_exp_f32 v102, v102
    ds_read_b64_tr_b16 a[68:69], v30 offset:16384
    v_exp_f32 v103, v103
    v_exp_f32 v104, v104
    ds_read_b64_tr_b16 a[70:71], v30 offset:20480
    v_mfma_f32_16x16x32_bf16 v[136:139], a[124:127], v[228:231], v[136:139]
    v_exp_f32 v105, v105
    v_xor_b32 v29, 192, v18
    ds_read_b64_tr_b16 a[72:73], v29 offset:0
    v_exp_f32 v106, v106
    s_add_u32 s65, s68, 196608
    v_exp_f32 v107, v107
    v_mfma_f32_16x16x32_bf16 v[140:143], a[140:143], v[228:231], v[140:143]
    ds_read_b64_tr_b16 a[74:75], v29 offset:4096
    v_exp_f32 v108, v108
    v_exp_f32 v109, v109
    ds_read_b64_tr_b16 a[76:77], v29 offset:8192
    v_exp_f32 v110, v110
    ds_read_b64_tr_b16 a[78:79], v29 offset:12288
    v_mfma_f32_16x16x32_bf16 v[144:147], a[156:159], v[228:231], v[144:147]
    v_exp_f32 v111, v111
    v_cvt_pk_bf16_f32 v80, v88, v89
    ds_read_b64_tr_b16 a[80:81], v29 offset:16384
    v_cvt_pk_bf16_f32 v81, v90, v91
    v_cvt_pk_bf16_f32 v82, v92, v93
    ds_read_b64_tr_b16 a[82:83], v29 offset:20480
    v_mfma_f32_16x16x32_bf16 v[148:151], a[172:175], v[228:231], v[148:151]
    v_cvt_pk_bf16_f32 v83, v94, v95
    s_add_u32 m0, s59, 30728
    s_nop 0
    buffer_load_dwordx4 v22, s[24:27], s65 offen  lds
    v_xor_b32 v30, 224, v18
    ds_read_b64_tr_b16 a[84:85], v30 offset:0
    v_cvt_pk_bf16_f32 v128, v96, v97
    v_cvt_pk_bf16_f32 v129, v98, v99
    v_mfma_f32_16x16x32_bf16 v[152:155], a[188:191], v[228:231], v[152:155]
    ds_read_b64_tr_b16 a[86:87], v30 offset:4096
    v_cvt_pk_bf16_f32 v130, v100, v101
    v_cvt_pk_bf16_f32 v131, v102, v103
    ds_read_b64_tr_b16 a[88:89], v30 offset:8192
    v_cvt_pk_bf16_f32 v176, v104, v105
    ds_read_b64_tr_b16 a[90:91], v30 offset:12288
    v_mfma_f32_16x16x32_bf16 v[156:159], a[204:207], v[228:231], v[156:159]
    v_cvt_pk_bf16_f32 v177, v106, v107
    v_cvt_pk_bf16_f32 v178, v108, v109
    ds_read_b64_tr_b16 a[92:93], v30 offset:16384
    v_cvt_pk_bf16_f32 v179, v110, v111
    ds_read_b64_tr_b16 a[94:95], v30 offset:20480
    s_add_u32 m0, s67, 6144
    s_nop 0
    buffer_load_dwordx4 v23, s[24:27], s65 offen  lds
    s_waitcnt lgkmcnt(0)
    v_mfma_f32_16x16x32_bf16 v[4:7], a[96:99], v[64:67], 0
    v_max3_f32 v12, v136, v137, v138
    v_max3_f32 v12, v12, v139, v140
    v_max3_f32 v12, v12, v141, v142
    v_mfma_f32_16x16x32_bf16 v[184:187], a[0:3], v[64:67], 0
    v_max3_f32 v12, v12, v143, v144
    v_max3_f32 v12, v12, v145, v146
    v_max3_f32 v12, v12, v147, v148
    v_mfma_f32_16x16x32_bf16 v[188:191], a[12:15], v[64:67], 0
    v_max3_f32 v12, v12, v149, v150
    v_max3_f32 v12, v12, v151, v152
    v_max3_f32 v12, v12, v153, v154
    v_mfma_f32_16x16x32_bf16 v[192:195], a[24:27], v[64:67], 0
    v_max3_f32 v12, v12, v155, v156
    v_max3_f32 v12, v12, v157, v158
    v_max_f32 v12, v12, v159
    v_mfma_f32_16x16x32_bf16 v[196:199], a[36:39], v[64:67], 0
    v_mov_b32 v13, v12
    s_nop 1
    v_permlane32_swap_b32 v12, v13
    v_max_f32 v12, v12, v13
    v_mfma_f32_16x16x32_bf16 v[200:203], a[48:51], v[64:67], 0
    v_mov_b32 v13, v12
    s_nop 1
    v_permlane16_swap_b32 v12, v13
    v_max_f32 v12, v12, v13
    v_mfma_f32_16x16x32_bf16 v[204:207], a[60:63], v[64:67], 0
    v_mul_f32 v12, s71, v12
    v_fma_f32 v136, v136, s71, -v12
    v_fma_f32 v137, v137, s71, -v12
    v_mfma_f32_16x16x32_bf16 v[56:59], a[72:75], v[64:67], 0
    v_fma_f32 v138, v138, s71, -v12
    v_fma_f32 v139, v139, s71, -v12
    v_fma_f32 v140, v140, s71, -v12
    v_mfma_f32_16x16x32_bf16 v[60:63], a[84:87], v[64:67], 0
    v_fma_f32 v141, v141, s71, -v12
    v_fma_f32 v142, v142, s71, -v12
    v_fma_f32 v143, v143, s71, -v12
    v_mfma_f32_16x16x32_bf16 v[4:7], a[96:99], v[112:115], v[4:7]
    v_fma_f32 v144, v144, s71, -v12
    v_fma_f32 v145, v145, s71, -v12
    v_fma_f32 v146, v146, s71, -v12
    v_mfma_f32_16x16x32_bf16 v[184:187], a[4:7], v[112:115], v[184:187]
    v_fma_f32 v147, v147, s71, -v12
    v_fma_f32 v148, v148, s71, -v12
    v_fma_f32 v149, v149, s71, -v12
    v_mfma_f32_16x16x32_bf16 v[188:191], a[16:19], v[112:115], v[188:191]
    v_fma_f32 v150, v150, s71, -v12
    v_fma_f32 v151, v151, s71, -v12
    v_fma_f32 v152, v152, s71, -v12
    v_mfma_f32_16x16x32_bf16 v[192:195], a[28:31], v[112:115], v[192:195]
    v_fma_f32 v153, v153, s71, -v12
    v_fma_f32 v154, v154, s71, -v12
    v_fma_f32 v155, v155, s71, -v12
    v_mfma_f32_16x16x32_bf16 v[196:199], a[40:43], v[112:115], v[196:199]
    v_fma_f32 v156, v156, s71, -v12
    s_lshl_b32 s3, s56, 5
    s_lshl_b32 s63, s54, 3
    s_add_u32 s3, s3, s63
    s_lshl_b32 s63, s57, 9
    s_add_u32 s3, s3, s63
    s_lshl_b32 s3, s3, 10
    v_lshrrev_b32 v29, 3, v1
    v_lshlrev_b32 v29, 10, v29
    v_and_b32 v30, 7, v1
    v_lshl_add_u32 v29, v30, 7, v29
    v_add_u32 v29, s3, v29
    v_fma_f32 v157, v157, s71, -v12
    v_mfma_f32_16x16x32_bf16 v[200:203], a[52:55], v[112:115], v[200:203]
    v_fma_f32 v158, v158, s71, -v12
    v_fma_f32 v159, v159, s71, -v12
    v_exp_f32 v136, v136
    v_mfma_f32_16x16x32_bf16 v[204:207], a[64:67], v[112:115], v[204:207]
    v_exp_f32 v137, v137
    v_exp_f32 v138, v138
    v_exp_f32 v139, v139
    v_mfma_f32_16x16x32_bf16 v[56:59], a[76:79], v[112:115], v[56:59]
    v_exp_f32 v140, v140
    v_exp_f32 v141, v141
    v_exp_f32 v142, v142
    v_mfma_f32_16x16x32_bf16 v[60:63], a[88:91], v[112:115], v[60:63]
    v_exp_f32 v143, v143
    v_exp_f32 v144, v144
    v_exp_f32 v145, v145
    v_mfma_f32_16x16x32_bf16 v[4:7], a[96:99], v[160:163], v[4:7]
    v_exp_f32 v146, v146
    v_exp_f32 v147, v147
    v_exp_f32 v148, v148
    v_mfma_f32_16x16x32_bf16 v[184:187], a[8:11], v[160:163], v[184:187]
    v_exp_f32 v149, v149
    v_exp_f32 v150, v150
    v_exp_f32 v151, v151
    v_mfma_f32_16x16x32_bf16 v[188:191], a[20:23], v[160:163], v[188:191]
    v_exp_f32 v152, v152
    v_exp_f32 v153, v153
    v_exp_f32 v154, v154
    v_mfma_f32_16x16x32_bf16 v[192:195], a[32:35], v[160:163], v[192:195]
    v_exp_f32 v155, v155
    v_exp_f32 v156, v156
    v_exp_f32 v157, v157
    v_mfma_f32_16x16x32_bf16 v[196:199], a[44:47], v[160:163], v[196:199]
    v_exp_f32 v158, v158
    v_exp_f32 v159, v159
    v_cvt_pk_bf16_f32 v84, v136, v137
    v_mfma_f32_16x16x32_bf16 v[200:203], a[56:59], v[160:163], v[200:203]
    v_cvt_pk_bf16_f32 v85, v138, v139
    v_cvt_pk_bf16_f32 v86, v140, v141
    v_cvt_pk_bf16_f32 v87, v142, v143
    v_mfma_f32_16x16x32_bf16 v[204:207], a[68:71], v[160:163], v[204:207]
    v_cvt_pk_bf16_f32 v132, v144, v145
    v_cvt_pk_bf16_f32 v133, v146, v147
    v_cvt_pk_bf16_f32 v134, v148, v149
    v_mfma_f32_16x16x32_bf16 v[56:59], a[80:83], v[160:163], v[56:59]
    v_cvt_pk_bf16_f32 v135, v150, v151
    v_cvt_pk_bf16_f32 v180, v152, v153
    v_cvt_pk_bf16_f32 v181, v154, v155
    v_mfma_f32_16x16x32_bf16 v[60:63], a[92:95], v[160:163], v[60:63]
    v_cvt_pk_bf16_f32 v182, v156, v157
    v_cvt_pk_bf16_f32 v183, v158, v159
    buffer_load_dword v31, v29, s[24:27], 0 offen
    v_mfma_f32_16x16x32_bf16 v[8:11], a[96:99], v[68:71], 0
    v_mfma_f32_16x16x32_bf16 v[232:235], a[0:3], v[68:71], 0
    v_mfma_f32_16x16x32_bf16 v[236:239], a[12:15], v[68:71], 0
    v_mfma_f32_16x16x32_bf16 v[240:243], a[24:27], v[68:71], 0
    v_mfma_f32_16x16x32_bf16 v[244:247], a[36:39], v[68:71], 0
    v_mfma_f32_16x16x32_bf16 v[248:251], a[48:51], v[68:71], 0
    v_mfma_f32_16x16x32_bf16 v[252:255], a[60:63], v[68:71], 0
    v_rcp_f32 v15, v4
    s_nop 0
    v_mul_f32 v184, v15, v184
    v_mfma_f32_16x16x32_bf16 v[48:51], a[72:75], v[68:71], 0
    v_mul_f32 v185, v15, v185
    v_mul_f32 v186, v15, v186
    v_mul_f32 v187, v15, v187
    v_mfma_f32_16x16x32_bf16 v[52:55], a[84:87], v[68:71], 0
    v_mul_f32 v188, v15, v188
    v_mul_f32 v189, v15, v189
    v_mfma_f32_16x16x32_bf16 v[8:11], a[96:99], v[116:119], v[8:11]
    v_mul_f32 v190, v15, v190
    v_mul_f32 v191, v15, v191
    v_cvt_pk_bf16_f32 v32, v184, v185
    v_mfma_f32_16x16x32_bf16 v[232:235], a[4:7], v[116:119], v[232:235]
    v_cvt_pk_bf16_f32 v33, v186, v187
    v_cvt_pk_bf16_f32 v34, v188, v189
    v_mfma_f32_16x16x32_bf16 v[236:239], a[16:19], v[116:119], v[236:239]
    v_cvt_pk_bf16_f32 v35, v190, v191
    ds_write_b128 v19, v[32:35] offset:0
    v_mul_f32 v192, v15, v192
    v_mfma_f32_16x16x32_bf16 v[240:243], a[28:31], v[116:119], v[240:243]
    v_mul_f32 v193, v15, v193
    v_mul_f32 v194, v15, v194
    v_mfma_f32_16x16x32_bf16 v[244:247], a[40:43], v[116:119], v[244:247]
    v_mul_f32 v195, v15, v195
    v_mul_f32 v196, v15, v196
    v_mul_f32 v197, v15, v197
    v_mfma_f32_16x16x32_bf16 v[248:251], a[52:55], v[116:119], v[248:251]
    v_mul_f32 v198, v15, v198
    v_mul_f32 v199, v15, v199
    v_mfma_f32_16x16x32_bf16 v[252:255], a[64:67], v[116:119], v[252:255]
    v_cvt_pk_bf16_f32 v36, v192, v193
    v_cvt_pk_bf16_f32 v37, v194, v195
    v_cvt_pk_bf16_f32 v38, v196, v197
    v_mfma_f32_16x16x32_bf16 v[48:51], a[76:79], v[116:119], v[48:51]
    v_cvt_pk_bf16_f32 v39, v198, v199
    ds_write_b128 v19, v[36:39] offset:6144
    v_mfma_f32_16x16x32_bf16 v[52:55], a[88:91], v[116:119], v[52:55]
    v_mul_f32 v200, v15, v200
    v_mul_f32 v201, v15, v201
    v_mul_f32 v202, v15, v202
    v_mfma_f32_16x16x32_bf16 v[8:11], a[96:99], v[164:167], v[8:11]
    v_mul_f32 v203, v15, v203
    v_mul_f32 v204, v15, v204
    v_mfma_f32_16x16x32_bf16 v[232:235], a[8:11], v[164:167], v[232:235]
    v_mul_f32 v205, v15, v205
    v_mul_f32 v206, v15, v206
    v_mul_f32 v207, v15, v207
    v_mfma_f32_16x16x32_bf16 v[236:239], a[20:23], v[164:167], v[236:239]
    v_cvt_pk_bf16_f32 v40, v200, v201
    v_cvt_pk_bf16_f32 v41, v202, v203
    v_mfma_f32_16x16x32_bf16 v[240:243], a[32:35], v[164:167], v[240:243]
    v_cvt_pk_bf16_f32 v42, v204, v205
    v_cvt_pk_bf16_f32 v43, v206, v207
    ds_write_b128 v19, v[40:43] offset:12288
    v_mfma_f32_16x16x32_bf16 v[244:247], a[44:47], v[164:167], v[244:247]
    v_mul_f32 v56, v15, v56
    v_mul_f32 v57, v15, v57
    v_mfma_f32_16x16x32_bf16 v[248:251], a[56:59], v[164:167], v[248:251]
    v_mul_f32 v58, v15, v58
    v_mul_f32 v59, v15, v59
    v_mul_f32 v60, v15, v60
    v_mfma_f32_16x16x32_bf16 v[252:255], a[68:71], v[164:167], v[252:255]
    v_mul_f32 v61, v15, v61
    v_mul_f32 v62, v15, v62
    v_mfma_f32_16x16x32_bf16 v[48:51], a[80:83], v[164:167], v[48:51]
    v_mul_f32 v63, v15, v63
    v_cvt_pk_bf16_f32 v44, v56, v57
    v_cvt_pk_bf16_f32 v45, v58, v59
    v_mfma_f32_16x16x32_bf16 v[52:55], a[92:95], v[164:167], v[52:55]
    v_cvt_pk_bf16_f32 v46, v60, v61
    v_cvt_pk_bf16_f32 v47, v62, v63
    ds_write_b128 v19, v[44:47] offset:18432
    v_mfma_f32_16x16x32_bf16 v[4:7], a[96:99], v[72:75], 0
    v_mfma_f32_16x16x32_bf16 v[184:187], a[0:3], v[72:75], 0
    v_mfma_f32_16x16x32_bf16 v[188:191], a[12:15], v[72:75], 0
    v_mfma_f32_16x16x32_bf16 v[192:195], a[24:27], v[72:75], 0
    v_mfma_f32_16x16x32_bf16 v[196:199], a[36:39], v[72:75], 0
    v_mfma_f32_16x16x32_bf16 v[200:203], a[48:51], v[72:75], 0
    v_mfma_f32_16x16x32_bf16 v[204:207], a[60:63], v[72:75], 0
    v_rcp_f32 v15, v8
    s_nop 0
    v_mul_f32 v232, v15, v232
    v_mfma_f32_16x16x32_bf16 v[56:59], a[72:75], v[72:75], 0
    v_mul_f32 v233, v15, v233
    v_mul_f32 v234, v15, v234
    v_mul_f32 v235, v15, v235
    v_mfma_f32_16x16x32_bf16 v[60:63], a[84:87], v[72:75], 0
    v_mul_f32 v236, v15, v236
    v_mul_f32 v237, v15, v237
    v_mfma_f32_16x16x32_bf16 v[4:7], a[96:99], v[120:123], v[4:7]
    v_mul_f32 v238, v15, v238
    v_mul_f32 v239, v15, v239
    v_cvt_pk_bf16_f32 v32, v232, v233
    v_mfma_f32_16x16x32_bf16 v[184:187], a[4:7], v[120:123], v[184:187]
    v_cvt_pk_bf16_f32 v33, v234, v235
    v_cvt_pk_bf16_f32 v34, v236, v237
    v_mfma_f32_16x16x32_bf16 v[188:191], a[16:19], v[120:123], v[188:191]
    v_cvt_pk_bf16_f32 v35, v238, v239
    ds_write_b128 v19, v[32:35] offset:1024
    v_mul_f32 v240, v15, v240
    v_mfma_f32_16x16x32_bf16 v[192:195], a[28:31], v[120:123], v[192:195]
    v_mul_f32 v241, v15, v241
    v_mul_f32 v242, v15, v242
    v_mfma_f32_16x16x32_bf16 v[196:199], a[40:43], v[120:123], v[196:199]
    v_mul_f32 v243, v15, v243
    v_mul_f32 v244, v15, v244
    v_mul_f32 v245, v15, v245
    v_mfma_f32_16x16x32_bf16 v[200:203], a[52:55], v[120:123], v[200:203]
    v_mul_f32 v246, v15, v246
    v_mul_f32 v247, v15, v247
    v_mfma_f32_16x16x32_bf16 v[204:207], a[64:67], v[120:123], v[204:207]
    v_cvt_pk_bf16_f32 v36, v240, v241
    v_cvt_pk_bf16_f32 v37, v242, v243
    v_cvt_pk_bf16_f32 v38, v244, v245
    v_mfma_f32_16x16x32_bf16 v[56:59], a[76:79], v[120:123], v[56:59]
    v_cvt_pk_bf16_f32 v39, v246, v247
    ds_write_b128 v19, v[36:39] offset:7168
    v_mfma_f32_16x16x32_bf16 v[60:63], a[88:91], v[120:123], v[60:63]
    v_mul_f32 v248, v15, v248
    v_mul_f32 v249, v15, v249
    v_mul_f32 v250, v15, v250
    v_mfma_f32_16x16x32_bf16 v[4:7], a[96:99], v[168:171], v[4:7]
    v_mul_f32 v251, v15, v251
    v_mul_f32 v252, v15, v252
    v_mfma_f32_16x16x32_bf16 v[184:187], a[8:11], v[168:171], v[184:187]
    v_mul_f32 v253, v15, v253
    v_mul_f32 v254, v15, v254
    v_mul_f32 v255, v15, v255
    v_mfma_f32_16x16x32_bf16 v[188:191], a[20:23], v[168:171], v[188:191]
    v_cvt_pk_bf16_f32 v40, v248, v249
    v_cvt_pk_bf16_f32 v41, v250, v251
    v_mfma_f32_16x16x32_bf16 v[192:195], a[32:35], v[168:171], v[192:195]
    v_cvt_pk_bf16_f32 v42, v252, v253
    v_cvt_pk_bf16_f32 v43, v254, v255
    ds_write_b128 v19, v[40:43] offset:13312
    v_mfma_f32_16x16x32_bf16 v[196:199], a[44:47], v[168:171], v[196:199]
    v_mul_f32 v48, v15, v48
    v_mul_f32 v49, v15, v49
    v_mfma_f32_16x16x32_bf16 v[200:203], a[56:59], v[168:171], v[200:203]
    v_mul_f32 v50, v15, v50
    v_mul_f32 v51, v15, v51
    v_mul_f32 v52, v15, v52
    v_mfma_f32_16x16x32_bf16 v[204:207], a[68:71], v[168:171], v[204:207]
    v_mul_f32 v53, v15, v53
    v_mul_f32 v54, v15, v54
    v_mfma_f32_16x16x32_bf16 v[56:59], a[80:83], v[168:171], v[56:59]
    v_mul_f32 v55, v15, v55
    v_cvt_pk_bf16_f32 v44, v48, v49
    v_cvt_pk_bf16_f32 v45, v50, v51
    v_mfma_f32_16x16x32_bf16 v[60:63], a[92:95], v[168:171], v[60:63]
    v_cvt_pk_bf16_f32 v46, v52, v53
    v_cvt_pk_bf16_f32 v47, v54, v55
    ds_write_b128 v19, v[44:47] offset:19456
    v_mfma_f32_16x16x32_bf16 v[8:11], a[96:99], v[76:79], 0
    v_mfma_f32_16x16x32_bf16 v[232:235], a[0:3], v[76:79], 0
    v_mfma_f32_16x16x32_bf16 v[236:239], a[12:15], v[76:79], 0
    v_mfma_f32_16x16x32_bf16 v[240:243], a[24:27], v[76:79], 0
    v_mfma_f32_16x16x32_bf16 v[244:247], a[36:39], v[76:79], 0
    v_mfma_f32_16x16x32_bf16 v[248:251], a[48:51], v[76:79], 0
    v_mfma_f32_16x16x32_bf16 v[252:255], a[60:63], v[76:79], 0
    v_rcp_f32 v15, v4
    s_nop 0
    v_mul_f32 v184, v15, v184
    v_mfma_f32_16x16x32_bf16 v[48:51], a[72:75], v[76:79], 0
    v_mul_f32 v185, v15, v185
    v_mul_f32 v186, v15, v186
    v_mul_f32 v187, v15, v187
    v_mfma_f32_16x16x32_bf16 v[52:55], a[84:87], v[76:79], 0
    v_mul_f32 v188, v15, v188
    v_mul_f32 v189, v15, v189
    v_mfma_f32_16x16x32_bf16 v[8:11], a[96:99], v[124:127], v[8:11]
    v_mul_f32 v190, v15, v190
    v_mul_f32 v191, v15, v191
    v_cvt_pk_bf16_f32 v32, v184, v185
    v_mfma_f32_16x16x32_bf16 v[232:235], a[4:7], v[124:127], v[232:235]
    v_cvt_pk_bf16_f32 v33, v186, v187
    v_cvt_pk_bf16_f32 v34, v188, v189
    v_mfma_f32_16x16x32_bf16 v[236:239], a[16:19], v[124:127], v[236:239]
    v_cvt_pk_bf16_f32 v35, v190, v191
    ds_write_b128 v19, v[32:35] offset:2048
    v_mul_f32 v192, v15, v192
    v_mfma_f32_16x16x32_bf16 v[240:243], a[28:31], v[124:127], v[240:243]
    v_mul_f32 v193, v15, v193
    v_mul_f32 v194, v15, v194
    v_mfma_f32_16x16x32_bf16 v[244:247], a[40:43], v[124:127], v[244:247]
    v_mul_f32 v195, v15, v195
    v_mul_f32 v196, v15, v196
    v_mul_f32 v197, v15, v197
    v_mfma_f32_16x16x32_bf16 v[248:251], a[52:55], v[124:127], v[248:251]
    v_mul_f32 v198, v15, v198
    v_mul_f32 v199, v15, v199
    v_mfma_f32_16x16x32_bf16 v[252:255], a[64:67], v[124:127], v[252:255]
    v_cvt_pk_bf16_f32 v36, v192, v193
    v_cvt_pk_bf16_f32 v37, v194, v195
    v_cvt_pk_bf16_f32 v38, v196, v197
    v_mfma_f32_16x16x32_bf16 v[48:51], a[76:79], v[124:127], v[48:51]
    v_cvt_pk_bf16_f32 v39, v198, v199
    ds_write_b128 v19, v[36:39] offset:8192
    v_mfma_f32_16x16x32_bf16 v[52:55], a[88:91], v[124:127], v[52:55]
    v_mul_f32 v200, v15, v200
    v_mul_f32 v201, v15, v201
    v_mul_f32 v202, v15, v202
    v_mfma_f32_16x16x32_bf16 v[8:11], a[96:99], v[172:175], v[8:11]
    v_mul_f32 v203, v15, v203
    v_mul_f32 v204, v15, v204
    v_mfma_f32_16x16x32_bf16 v[232:235], a[8:11], v[172:175], v[232:235]
    v_mul_f32 v205, v15, v205
    v_mul_f32 v206, v15, v206
    v_mul_f32 v207, v15, v207
    v_mfma_f32_16x16x32_bf16 v[236:239], a[20:23], v[172:175], v[236:239]
    v_cvt_pk_bf16_f32 v40, v200, v201
    v_cvt_pk_bf16_f32 v41, v202, v203
    v_mfma_f32_16x16x32_bf16 v[240:243], a[32:35], v[172:175], v[240:243]
    v_cvt_pk_bf16_f32 v42, v204, v205
    v_cvt_pk_bf16_f32 v43, v206, v207
    ds_write_b128 v19, v[40:43] offset:14336
    v_mfma_f32_16x16x32_bf16 v[244:247], a[44:47], v[172:175], v[244:247]
    v_mul_f32 v56, v15, v56
    v_mul_f32 v57, v15, v57
    v_mfma_f32_16x16x32_bf16 v[248:251], a[56:59], v[172:175], v[248:251]
    v_mul_f32 v58, v15, v58
    v_mul_f32 v59, v15, v59
    v_mul_f32 v60, v15, v60
    v_mfma_f32_16x16x32_bf16 v[252:255], a[68:71], v[172:175], v[252:255]
    v_mul_f32 v61, v15, v61
    v_mul_f32 v62, v15, v62
    v_mfma_f32_16x16x32_bf16 v[48:51], a[80:83], v[172:175], v[48:51]
    v_mul_f32 v63, v15, v63
    v_cvt_pk_bf16_f32 v44, v56, v57
    v_cvt_pk_bf16_f32 v45, v58, v59
    v_mfma_f32_16x16x32_bf16 v[52:55], a[92:95], v[172:175], v[52:55]
    v_cvt_pk_bf16_f32 v46, v60, v61
    v_cvt_pk_bf16_f32 v47, v62, v63
    ds_write_b128 v19, v[44:47] offset:20480
    v_mfma_f32_16x16x32_bf16 v[4:7], a[96:99], v[80:83], 0
    v_mfma_f32_16x16x32_bf16 v[184:187], a[0:3], v[80:83], 0
    v_mfma_f32_16x16x32_bf16 v[188:191], a[12:15], v[80:83], 0
    v_mfma_f32_16x16x32_bf16 v[192:195], a[24:27], v[80:83], 0
    v_mfma_f32_16x16x32_bf16 v[196:199], a[36:39], v[80:83], 0
    v_mfma_f32_16x16x32_bf16 v[200:203], a[48:51], v[80:83], 0
    v_mfma_f32_16x16x32_bf16 v[204:207], a[60:63], v[80:83], 0
    v_rcp_f32 v15, v8
    s_nop 0
    v_mul_f32 v232, v15, v232
    v_mfma_f32_16x16x32_bf16 v[56:59], a[72:75], v[80:83], 0
    v_mul_f32 v233, v15, v233
    v_mul_f32 v234, v15, v234
    v_mul_f32 v235, v15, v235
    v_mfma_f32_16x16x32_bf16 v[60:63], a[84:87], v[80:83], 0
    v_mul_f32 v236, v15, v236
    v_mul_f32 v237, v15, v237
    v_mfma_f32_16x16x32_bf16 v[4:7], a[96:99], v[128:131], v[4:7]
    v_mul_f32 v238, v15, v238
    v_mul_f32 v239, v15, v239
    v_cvt_pk_bf16_f32 v32, v232, v233
    v_mfma_f32_16x16x32_bf16 v[184:187], a[4:7], v[128:131], v[184:187]
    v_cvt_pk_bf16_f32 v33, v234, v235
    v_cvt_pk_bf16_f32 v34, v236, v237
    v_mfma_f32_16x16x32_bf16 v[188:191], a[16:19], v[128:131], v[188:191]
    v_cvt_pk_bf16_f32 v35, v238, v239
    ds_write_b128 v19, v[32:35] offset:3072
    v_mul_f32 v240, v15, v240
    v_mfma_f32_16x16x32_bf16 v[192:195], a[28:31], v[128:131], v[192:195]
    v_mul_f32 v241, v15, v241
    v_mul_f32 v242, v15, v242
    v_mfma_f32_16x16x32_bf16 v[196:199], a[40:43], v[128:131], v[196:199]
    v_mul_f32 v243, v15, v243
    v_mul_f32 v244, v15, v244
    v_mul_f32 v245, v15, v245
    v_mfma_f32_16x16x32_bf16 v[200:203], a[52:55], v[128:131], v[200:203]
    v_mul_f32 v246, v15, v246
    v_mul_f32 v247, v15, v247
    v_mfma_f32_16x16x32_bf16 v[204:207], a[64:67], v[128:131], v[204:207]
    v_cvt_pk_bf16_f32 v36, v240, v241
    v_cvt_pk_bf16_f32 v37, v242, v243
    v_cvt_pk_bf16_f32 v38, v244, v245
    v_mfma_f32_16x16x32_bf16 v[56:59], a[76:79], v[128:131], v[56:59]
    v_cvt_pk_bf16_f32 v39, v246, v247
    ds_write_b128 v19, v[36:39] offset:9216
    v_mfma_f32_16x16x32_bf16 v[60:63], a[88:91], v[128:131], v[60:63]
    v_mul_f32 v248, v15, v248
    v_mul_f32 v249, v15, v249
    v_mul_f32 v250, v15, v250
    v_mfma_f32_16x16x32_bf16 v[4:7], a[96:99], v[176:179], v[4:7]
    v_mul_f32 v251, v15, v251
    v_mul_f32 v252, v15, v252
    v_mfma_f32_16x16x32_bf16 v[184:187], a[8:11], v[176:179], v[184:187]
    v_mul_f32 v253, v15, v253
    v_mul_f32 v254, v15, v254
    v_mul_f32 v255, v15, v255
    v_mfma_f32_16x16x32_bf16 v[188:191], a[20:23], v[176:179], v[188:191]
    v_cvt_pk_bf16_f32 v40, v248, v249
    v_cvt_pk_bf16_f32 v41, v250, v251
    v_mfma_f32_16x16x32_bf16 v[192:195], a[32:35], v[176:179], v[192:195]
    v_cvt_pk_bf16_f32 v42, v252, v253
    v_cvt_pk_bf16_f32 v43, v254, v255
    ds_write_b128 v19, v[40:43] offset:15360
    v_mfma_f32_16x16x32_bf16 v[196:199], a[44:47], v[176:179], v[196:199]
    v_mul_f32 v48, v15, v48
    v_mul_f32 v49, v15, v49
    v_mfma_f32_16x16x32_bf16 v[200:203], a[56:59], v[176:179], v[200:203]
    v_mul_f32 v50, v15, v50
    v_mul_f32 v51, v15, v51
    v_mul_f32 v52, v15, v52
    v_mfma_f32_16x16x32_bf16 v[204:207], a[68:71], v[176:179], v[204:207]
    v_mul_f32 v53, v15, v53
    v_mul_f32 v54, v15, v54
    v_mfma_f32_16x16x32_bf16 v[56:59], a[80:83], v[176:179], v[56:59]
    v_mul_f32 v55, v15, v55
    v_cvt_pk_bf16_f32 v44, v48, v49
    v_cvt_pk_bf16_f32 v45, v50, v51
    v_mfma_f32_16x16x32_bf16 v[60:63], a[92:95], v[176:179], v[60:63]
    v_cvt_pk_bf16_f32 v46, v52, v53
    v_cvt_pk_bf16_f32 v47, v54, v55
    ds_write_b128 v19, v[44:47] offset:21504
    v_mfma_f32_16x16x32_bf16 v[8:11], a[96:99], v[84:87], 0
    v_mfma_f32_16x16x32_bf16 v[232:235], a[0:3], v[84:87], 0
    v_mfma_f32_16x16x32_bf16 v[236:239], a[12:15], v[84:87], 0
    v_mfma_f32_16x16x32_bf16 v[240:243], a[24:27], v[84:87], 0
    v_mfma_f32_16x16x32_bf16 v[244:247], a[36:39], v[84:87], 0
    v_mfma_f32_16x16x32_bf16 v[248:251], a[48:51], v[84:87], 0
    v_mfma_f32_16x16x32_bf16 v[252:255], a[60:63], v[84:87], 0
    v_rcp_f32 v15, v4
    s_nop 0
    v_mul_f32 v184, v15, v184
    v_mfma_f32_16x16x32_bf16 v[48:51], a[72:75], v[84:87], 0
    v_mul_f32 v185, v15, v185
    v_mul_f32 v186, v15, v186
    v_mul_f32 v187, v15, v187
    v_mfma_f32_16x16x32_bf16 v[52:55], a[84:87], v[84:87], 0
    v_mul_f32 v188, v15, v188
    v_mul_f32 v189, v15, v189
    v_mfma_f32_16x16x32_bf16 v[8:11], a[96:99], v[132:135], v[8:11]
    v_mul_f32 v190, v15, v190
    v_mul_f32 v191, v15, v191
    v_cvt_pk_bf16_f32 v32, v184, v185
    v_mfma_f32_16x16x32_bf16 v[232:235], a[4:7], v[132:135], v[232:235]
    v_cvt_pk_bf16_f32 v33, v186, v187
    v_cvt_pk_bf16_f32 v34, v188, v189
    v_mfma_f32_16x16x32_bf16 v[236:239], a[16:19], v[132:135], v[236:239]
    v_cvt_pk_bf16_f32 v35, v190, v191
    ds_write_b128 v19, v[32:35] offset:4096
    v_mul_f32 v192, v15, v192
    v_mfma_f32_16x16x32_bf16 v[240:243], a[28:31], v[132:135], v[240:243]
    v_mul_f32 v193, v15, v193
    v_mul_f32 v194, v15, v194
    v_mfma_f32_16x16x32_bf16 v[244:247], a[40:43], v[132:135], v[244:247]
    v_mul_f32 v195, v15, v195
    v_mul_f32 v196, v15, v196
    v_mul_f32 v197, v15, v197
    v_mfma_f32_16x16x32_bf16 v[248:251], a[52:55], v[132:135], v[248:251]
    v_mul_f32 v198, v15, v198
    v_mul_f32 v199, v15, v199
    v_mfma_f32_16x16x32_bf16 v[252:255], a[64:67], v[132:135], v[252:255]
    v_cvt_pk_bf16_f32 v36, v192, v193
    v_cvt_pk_bf16_f32 v37, v194, v195
    v_cvt_pk_bf16_f32 v38, v196, v197
    v_mfma_f32_16x16x32_bf16 v[48:51], a[76:79], v[132:135], v[48:51]
    v_cvt_pk_bf16_f32 v39, v198, v199
    ds_write_b128 v19, v[36:39] offset:10240
    v_mfma_f32_16x16x32_bf16 v[52:55], a[88:91], v[132:135], v[52:55]
    v_mul_f32 v200, v15, v200
    v_mul_f32 v201, v15, v201
    v_mul_f32 v202, v15, v202
    v_mfma_f32_16x16x32_bf16 v[8:11], a[96:99], v[180:183], v[8:11]
    v_mul_f32 v203, v15, v203
    v_mul_f32 v204, v15, v204
    v_mfma_f32_16x16x32_bf16 v[232:235], a[8:11], v[180:183], v[232:235]
    v_mul_f32 v205, v15, v205
    v_mul_f32 v206, v15, v206
    v_mul_f32 v207, v15, v207
    v_mfma_f32_16x16x32_bf16 v[236:239], a[20:23], v[180:183], v[236:239]
    v_cvt_pk_bf16_f32 v40, v200, v201
    v_cvt_pk_bf16_f32 v41, v202, v203
    v_mfma_f32_16x16x32_bf16 v[240:243], a[32:35], v[180:183], v[240:243]
    v_cvt_pk_bf16_f32 v42, v204, v205
    v_cvt_pk_bf16_f32 v43, v206, v207
    ds_write_b128 v19, v[40:43] offset:16384
    v_mfma_f32_16x16x32_bf16 v[244:247], a[44:47], v[180:183], v[244:247]
    v_mul_f32 v56, v15, v56
    v_mul_f32 v57, v15, v57
    v_mfma_f32_16x16x32_bf16 v[248:251], a[56:59], v[180:183], v[248:251]
    v_mul_f32 v58, v15, v58
    v_mul_f32 v59, v15, v59
    v_mul_f32 v60, v15, v60
    v_mfma_f32_16x16x32_bf16 v[252:255], a[68:71], v[180:183], v[252:255]
    v_mul_f32 v61, v15, v61
    v_mul_f32 v62, v15, v62
    v_mfma_f32_16x16x32_bf16 v[48:51], a[80:83], v[180:183], v[48:51]
    v_mul_f32 v63, v15, v63
    v_cvt_pk_bf16_f32 v44, v56, v57
    v_cvt_pk_bf16_f32 v45, v58, v59
    v_mfma_f32_16x16x32_bf16 v[52:55], a[92:95], v[180:183], v[52:55]
    v_cvt_pk_bf16_f32 v46, v60, v61
    v_cvt_pk_bf16_f32 v47, v62, v63
    ds_write_b128 v19, v[44:47] offset:22528
    v_rcp_f32 v15, v8
    s_nop 0
    v_mul_f32 v232, v15, v232
    v_mul_f32 v233, v15, v233
    v_mul_f32 v234, v15, v234
    v_mul_f32 v235, v15, v235
    v_mul_f32 v236, v15, v236
    v_mul_f32 v237, v15, v237
    v_mul_f32 v238, v15, v238
    v_mul_f32 v239, v15, v239
    v_cvt_pk_bf16_f32 v32, v232, v233
    v_cvt_pk_bf16_f32 v33, v234, v235
    v_cvt_pk_bf16_f32 v34, v236, v237
    v_cvt_pk_bf16_f32 v35, v238, v239
    ds_write_b128 v19, v[32:35] offset:5120
    v_mul_f32 v240, v15, v240
    v_mul_f32 v241, v15, v241
    v_mul_f32 v242, v15, v242
    v_mul_f32 v243, v15, v243
    v_mul_f32 v244, v15, v244
    v_mul_f32 v245, v15, v245
    v_mul_f32 v246, v15, v246
    v_mul_f32 v247, v15, v247
    v_cvt_pk_bf16_f32 v36, v240, v241
    v_cvt_pk_bf16_f32 v37, v242, v243
    v_cvt_pk_bf16_f32 v38, v244, v245
    v_cvt_pk_bf16_f32 v39, v246, v247
    ds_write_b128 v19, v[36:39] offset:11264
    v_mul_f32 v248, v15, v248
    v_mul_f32 v249, v15, v249
    v_mul_f32 v250, v15, v250
    v_mul_f32 v251, v15, v251
    v_mul_f32 v252, v15, v252
    v_mul_f32 v253, v15, v253
    v_mul_f32 v254, v15, v254
    v_mul_f32 v255, v15, v255
    v_cvt_pk_bf16_f32 v40, v248, v249
    v_cvt_pk_bf16_f32 v41, v250, v251
    v_cvt_pk_bf16_f32 v42, v252, v253
    v_cvt_pk_bf16_f32 v43, v254, v255
    ds_write_b128 v19, v[40:43] offset:17408
    v_mul_f32 v48, v15, v48
    v_mul_f32 v49, v15, v49
    v_mul_f32 v50, v15, v50
    v_mul_f32 v51, v15, v51
    v_mul_f32 v52, v15, v52
    v_mul_f32 v53, v15, v53
    v_mul_f32 v54, v15, v54
    v_mul_f32 v55, v15, v55
    v_cvt_pk_bf16_f32 v44, v48, v49
    v_cvt_pk_bf16_f32 v45, v50, v51
    v_cvt_pk_bf16_f32 v46, v52, v53
    v_cvt_pk_bf16_f32 v47, v54, v55
    ds_write_b128 v19, v[44:47] offset:23552
    s_lshl_b32 s3, s41, 3
    s_add_u32 s3, s3, 0
    v_mov_b32 v30, s3
    v_mov_b32 v3, 1
    buffer_load_dword v29, v30, s[36:39], 0 offen sc1
    s_waitcnt vmcnt(14)
    ds_read_b64_tr_b16 v[240:241], v24 offset:0
    ds_read_b64_tr_b16 v[242:243], v24 offset:512
    ds_read_b64_tr_b16 v[244:245], v24 offset:8
    ds_read_b64_tr_b16 v[246:247], v24 offset:520
    s_waitcnt lgkmcnt(4)
    s_barrier
    ds_read_b128 v[64:67], v20 offset:0
    ds_read_b128 v[68:71], v20 offset:1024
    ds_read_b128 v[72:75], v20 offset:2048
    ds_read_b128 v[76:79], v20 offset:3072
    ds_read_b128 v[80:83], v20 offset:4096
    ds_read_b128 v[84:87], v20 offset:5120
    ds_read_b128 v[112:115], v20 offset:6144
    ds_read_b128 v[116:119], v20 offset:7168
    ds_read_b128 v[120:123], v20 offset:8192
    ds_read_b128 v[124:127], v20 offset:9216
    ds_read_b128 v[128:131], v20 offset:10240
    ds_read_b128 v[132:135], v20 offset:11264
    s_waitcnt lgkmcnt(6)
    s_waitcnt vmcnt(12)
    v_mfma_f32_16x16x32_bf16 v[88:91], v[240:243], v[64:67], 0
    ds_read_b64_tr_b16 v[248:249], v24 offset:1024
    v_mfma_f32_16x16x32_bf16 v[92:95], v[240:243], v[68:71], 0
    ds_read_b64_tr_b16 v[250:251], v24 offset:1536
    v_mfma_f32_16x16x32_bf16 v[96:99], v[240:243], v[72:75], 0
    ds_read_b64_tr_b16 v[252:253], v24 offset:1032
    v_mfma_f32_16x16x32_bf16 v[100:103], v[240:243], v[76:79], 0
    ds_read_b64_tr_b16 v[254:255], v24 offset:1544
    v_mfma_f32_16x16x32_bf16 v[104:107], v[240:243], v[80:83], 0
    ds_read_b128 v[160:163], v20 offset:12288
    v_mfma_f32_16x16x32_bf16 v[108:111], v[240:243], v[84:87], 0
    ds_read_b128 v[164:167], v20 offset:13312
    v_mfma_f32_16x16x32_bf16 v[156:159], v[244:247], v[84:87], 0
    ds_read_b128 v[168:171], v20 offset:14336
    v_mfma_f32_16x16x32_bf16 v[152:155], v[244:247], v[80:83], 0
    ds_read_b128 v[172:175], v20 offset:15360
    s_add_u32 s65, s68, 229376
    v_mfma_f32_16x16x32_bf16 v[148:151], v[244:247], v[76:79], 0
    ds_read_b128 v[176:179], v20 offset:16384
    s_add_u32 m0, s59, 24584
    s_nop 0
    buffer_load_dwordx4 v22, s[24:27], s65 offen  lds
    v_mfma_f32_16x16x32_bf16 v[144:147], v[244:247], v[72:75], 0
    ds_read_b128 v[180:183], v20 offset:17408
    s_add_u32 m0, s67, 0
    s_nop 0
    buffer_load_dwordx4 v23, s[24:27], s65 offen  lds
    v_mfma_f32_16x16x32_bf16 v[140:143], v[244:247], v[68:71], 0
    v_mfma_f32_16x16x32_bf16 v[136:139], v[244:247], v[64:67], 0
    s_waitcnt lgkmcnt(6)
    s_waitcnt vmcnt(12)
    v_mfma_f32_16x16x32_bf16 v[88:91], v[248:251], v[112:115], v[88:91]
    ds_read_b64_tr_b16 v[240:241], v24 offset:2048
    v_mfma_f32_16x16x32_bf16 v[92:95], v[248:251], v[116:119], v[92:95]
    ds_read_b64_tr_b16 v[242:243], v24 offset:2560
    v_mfma_f32_16x16x32_bf16 v[96:99], v[248:251], v[120:123], v[96:99]
    ds_read_b64_tr_b16 v[244:245], v24 offset:2056
    v_mfma_f32_16x16x32_bf16 v[100:103], v[248:251], v[124:127], v[100:103]
    ds_read_b64_tr_b16 v[246:247], v24 offset:2568
    v_mfma_f32_16x16x32_bf16 v[104:107], v[248:251], v[128:131], v[104:107]
    ds_read_b128 v[208:211], v20 offset:18432
    v_mfma_f32_16x16x32_bf16 v[108:111], v[248:251], v[132:135], v[108:111]
    ds_read_b128 v[212:215], v20 offset:19456
    v_mfma_f32_16x16x32_bf16 v[156:159], v[252:255], v[132:135], v[156:159]
    ds_read_b128 v[216:219], v20 offset:20480
    v_mfma_f32_16x16x32_bf16 v[152:155], v[252:255], v[128:131], v[152:155]
    ds_read_b128 v[220:223], v20 offset:21504
    s_add_u32 s65, s68, 262144
    v_mfma_f32_16x16x32_bf16 v[148:151], v[252:255], v[124:127], v[148:151]
    ds_read_b128 v[224:227], v20 offset:22528
    s_add_u32 m0, s59, 25608
    s_nop 0
    buffer_load_dwordx4 v22, s[24:27], s65 offen  lds
    v_mfma_f32_16x16x32_bf16 v[144:147], v[252:255], v[120:123], v[144:147]
    ds_read_b128 v[228:231], v20 offset:23552
    s_add_u32 m0, s67, 1024
    s_nop 0
    buffer_load_dwordx4 v23, s[24:27], s65 offen  lds
    v_mfma_f32_16x16x32_bf16 v[140:143], v[252:255], v[116:119], v[140:143]
    v_mfma_f32_16x16x32_bf16 v[136:139], v[252:255], v[112:115], v[136:139]
    s_waitcnt lgkmcnt(6)
    s_waitcnt vmcnt(12)
    v_mfma_f32_16x16x32_bf16 v[88:91], v[240:243], v[160:163], v[88:91]
    ds_read_b64_tr_b16 v[248:249], v24 offset:3072
    v_mfma_f32_16x16x32_bf16 v[92:95], v[240:243], v[164:167], v[92:95]
    ds_read_b64_tr_b16 v[250:251], v24 offset:3584
    v_mfma_f32_16x16x32_bf16 v[96:99], v[240:243], v[168:171], v[96:99]
    ds_read_b64_tr_b16 v[252:253], v24 offset:3080
    v_mfma_f32_16x16x32_bf16 v[100:103], v[240:243], v[172:175], v[100:103]
    ds_read_b64_tr_b16 v[254:255], v24 offset:3592
    v_mfma_f32_16x16x32_bf16 v[104:107], v[240:243], v[176:179], v[104:107]
    ds_read_b128 v[184:187], v20 offset:32768
    v_mfma_f32_16x16x32_bf16 v[108:111], v[240:243], v[180:183], v[108:111]
    ds_read_b128 v[188:191], v20 offset:33792
    v_mfma_f32_16x16x32_bf16 v[156:159], v[244:247], v[180:183], v[156:159]
    ds_read_b128 v[192:195], v20 offset:34816
    v_mfma_f32_16x16x32_bf16 v[152:155], v[244:247], v[176:179], v[152:155]
    ds_read_b128 v[196:199], v20 offset:35840
    s_add_u32 s65, s68, 294912
    v_mfma_f32_16x16x32_bf16 v[148:151], v[244:247], v[172:175], v[148:151]
    ds_read_b128 v[200:203], v20 offset:36864
    s_add_u32 m0, s59, 26632
    s_nop 0
    buffer_load_dwordx4 v22, s[24:27], s65 offen  lds
    v_mfma_f32_16x16x32_bf16 v[144:147], v[244:247], v[168:171], v[144:147]
    ds_read_b128 v[204:207], v20 offset:37888
    s_add_u32 m0, s67, 2048
    s_nop 0
    buffer_load_dwordx4 v23, s[24:27], s65 offen  lds
    v_mfma_f32_16x16x32_bf16 v[140:143], v[244:247], v[164:167], v[140:143]
    v_mfma_f32_16x16x32_bf16 v[136:139], v[244:247], v[160:163], v[136:139]
    s_waitcnt lgkmcnt(6)
    s_waitcnt vmcnt(12)
    v_mfma_f32_16x16x32_bf16 v[88:91], v[248:251], v[208:211], v[88:91]
    ds_read_b64_tr_b16 v[240:241], v24 offset:4096
    v_mfma_f32_16x16x32_bf16 v[92:95], v[248:251], v[212:215], v[92:95]
    ds_read_b64_tr_b16 v[242:243], v24 offset:4608
    v_mfma_f32_16x16x32_bf16 v[96:99], v[248:251], v[216:219], v[96:99]
    ds_read_b64_tr_b16 v[244:245], v24 offset:4104
    v_mfma_f32_16x16x32_bf16 v[100:103], v[248:251], v[220:223], v[100:103]
    ds_read_b64_tr_b16 v[246:247], v24 offset:4616
    v_mfma_f32_16x16x32_bf16 v[104:107], v[248:251], v[224:227], v[104:107]
    ds_read_b128 v[232:235], v20 offset:38912
    v_mfma_f32_16x16x32_bf16 v[108:111], v[248:251], v[228:231], v[108:111]
    ds_read_b128 v[236:239], v20 offset:39936
    v_mfma_f32_16x16x32_bf16 v[156:159], v[252:255], v[228:231], v[156:159]
    ds_read_b128 a[0:3], v20 offset:40960
    v_mfma_f32_16x16x32_bf16 v[152:155], v[252:255], v[224:227], v[152:155]
    ds_read_b128 a[4:7], v20 offset:41984
    s_add_u32 s65, s68, 327680
    v_mfma_f32_16x16x32_bf16 v[148:151], v[252:255], v[220:223], v[148:151]
    ds_read_b128 a[8:11], v20 offset:43008
    s_add_u32 m0, s59, 27656
    s_nop 0
    buffer_load_dwordx4 v22, s[24:27], s65 offen  lds
    v_mfma_f32_16x16x32_bf16 v[144:147], v[252:255], v[216:219], v[144:147]
    ds_read_b128 a[12:15], v20 offset:44032
    s_add_u32 m0, s67, 3072
    s_nop 0
    buffer_load_dwordx4 v23, s[24:27], s65 offen  lds
    v_mfma_f32_16x16x32_bf16 v[140:143], v[252:255], v[212:215], v[140:143]
    v_mfma_f32_16x16x32_bf16 v[136:139], v[252:255], v[208:211], v[136:139]
    s_waitcnt lgkmcnt(6)
    s_waitcnt vmcnt(12)
    v_mfma_f32_16x16x32_bf16 v[88:91], v[240:243], v[184:187], v[88:91]
    ds_read_b64_tr_b16 v[248:249], v24 offset:5120
    v_mfma_f32_16x16x32_bf16 v[92:95], v[240:243], v[188:191], v[92:95]
    ds_read_b64_tr_b16 v[250:251], v24 offset:5632
    v_mfma_f32_16x16x32_bf16 v[96:99], v[240:243], v[192:195], v[96:99]
    ds_read_b64_tr_b16 v[252:253], v24 offset:5128
    v_mfma_f32_16x16x32_bf16 v[100:103], v[240:243], v[196:199], v[100:103]
    ds_read_b64_tr_b16 v[254:255], v24 offset:5640
    v_mfma_f32_16x16x32_bf16 v[104:107], v[240:243], v[200:203], v[104:107]
    ds_read_b128 a[16:19], v20 offset:45056
    v_mfma_f32_16x16x32_bf16 v[108:111], v[240:243], v[204:207], v[108:111]
    ds_read_b128 a[20:23], v20 offset:46080
    v_mfma_f32_16x16x32_bf16 v[156:159], v[244:247], v[204:207], v[156:159]
    ds_read_b128 a[24:27], v20 offset:47104
    v_mfma_f32_16x16x32_bf16 v[152:155], v[244:247], v[200:203], v[152:155]
    ds_read_b128 a[28:31], v20 offset:48128
    s_add_u32 s65, s68, 360448
    v_mfma_f32_16x16x32_bf16 v[148:151], v[244:247], v[196:199], v[148:151]
    ds_read_b128 a[32:35], v20 offset:49152
    s_add_u32 m0, s59, 28680
    s_nop 0
    buffer_load_dwordx4 v22, s[24:27], s65 offen  lds
    v_mfma_f32_16x16x32_bf16 v[144:147], v[244:247], v[192:195], v[144:147]
    ds_read_b128 a[36:39], v20 offset:50176
    s_add_u32 m0, s67, 4096
    s_nop 0
    buffer_load_dwordx4 v23, s[24:27], s65 offen  lds
    v_mfma_f32_16x16x32_bf16 v[140:143], v[244:247], v[188:191], v[140:143]
    v_mfma_f32_16x16x32_bf16 v[136:139], v[244:247], v[184:187], v[136:139]
    s_waitcnt lgkmcnt(6)
    s_waitcnt vmcnt(12)
    v_mfma_f32_16x16x32_bf16 v[88:91], v[248:251], v[232:235], v[88:91]
    ds_read_b64_tr_b16 v[240:241], v24 offset:6144
    v_mfma_f32_16x16x32_bf16 v[92:95], v[248:251], v[236:239], v[92:95]
    ds_read_b64_tr_b16 v[242:243], v24 offset:6656
    v_mfma_f32_16x16x32_bf16 v[96:99], v[248:251], a[0:3], v[96:99]
    ds_read_b64_tr_b16 v[244:245], v24 offset:6152
    v_mfma_f32_16x16x32_bf16 v[100:103], v[248:251], a[4:7], v[100:103]
    ds_read_b64_tr_b16 v[246:247], v24 offset:6664
    v_mfma_f32_16x16x32_bf16 v[104:107], v[248:251], a[8:11], v[104:107]
    ds_read_b128 a[40:43], v20 offset:51200
    v_mfma_f32_16x16x32_bf16 v[108:111], v[248:251], a[12:15], v[108:111]
    ds_read_b128 a[44:47], v20 offset:52224
    v_mfma_f32_16x16x32_bf16 v[156:159], v[252:255], a[12:15], v[156:159]
    ds_read_b128 a[48:51], v20 offset:53248
    v_mfma_f32_16x16x32_bf16 v[152:155], v[252:255], a[8:11], v[152:155]
    ds_read_b128 a[52:55], v20 offset:54272
    s_add_u32 s65, s68, 393216
    v_mfma_f32_16x16x32_bf16 v[148:151], v[252:255], a[4:7], v[148:151]
    ds_read_b128 a[56:59], v20 offset:55296
    s_add_u32 m0, s59, 29704
    s_nop 0
    buffer_load_dwordx4 v22, s[24:27], s65 offen  lds
    v_mfma_f32_16x16x32_bf16 v[144:147], v[252:255], a[0:3], v[144:147]
    ds_read_b128 a[60:63], v20 offset:56320
    s_add_u32 m0, s67, 5120
    s_nop 0
    buffer_load_dwordx4 v23, s[24:27], s65 offen  lds
    v_mfma_f32_16x16x32_bf16 v[140:143], v[252:255], v[236:239], v[140:143]
    v_mfma_f32_16x16x32_bf16 v[136:139], v[252:255], v[232:235], v[136:139]
    s_waitcnt lgkmcnt(6)
    s_waitcnt vmcnt(10)
    v_mfma_f32_16x16x32_bf16 v[88:91], v[240:243], a[16:19], v[88:91]
    ds_read_b64_tr_b16 v[248:249], v24 offset:0
    v_mfma_f32_16x16x32_bf16 v[92:95], v[240:243], a[20:23], v[92:95]
    ds_read_b64_tr_b16 v[250:251], v24 offset:512
    v_mfma_f32_16x16x32_bf16 v[96:99], v[240:243], a[24:27], v[96:99]
    ds_read_b64_tr_b16 v[252:253], v24 offset:8
    v_mfma_f32_16x16x32_bf16 v[100:103], v[240:243], a[28:31], v[100:103]
    ds_read_b64_tr_b16 v[254:255], v24 offset:520
    v_mfma_f32_16x16x32_bf16 v[104:107], v[240:243], a[32:35], v[104:107]
    ds_read_b128 a[64:67], v21 offset:0
    v_mfma_f32_16x16x32_bf16 v[108:111], v[240:243], a[36:39], v[108:111]
    ds_read_b128 a[68:71], v21 offset:1024
    v_mfma_f32_16x16x32_bf16 v[156:159], v[244:247], a[36:39], v[156:159]
    ds_read_b128 a[72:75], v21 offset:2048
    v_mfma_f32_16x16x32_bf16 v[152:155], v[244:247], a[32:35], v[152:155]
    ds_read_b128 a[76:79], v21 offset:3072
    s_add_u32 s65, s68, 425984
    v_mfma_f32_16x16x32_bf16 v[148:151], v[244:247], a[28:31], v[148:151]
    ds_read_b128 a[80:83], v21 offset:4096
    s_add_u32 m0, s59, 30728
    s_nop 0
    buffer_load_dwordx4 v22, s[24:27], s65 offen  lds
    v_mfma_f32_16x16x32_bf16 v[144:147], v[244:247], a[24:27], v[144:147]
    ds_read_b128 a[84:87], v21 offset:5120
    s_add_u32 m0, s67, 6144
    s_nop 0
    buffer_load_dwordx4 v23, s[24:27], s65 offen  lds
    v_mfma_f32_16x16x32_bf16 v[140:143], v[244:247], a[20:23], v[140:143]
    v_mfma_f32_16x16x32_bf16 v[136:139], v[244:247], a[16:19], v[136:139]
    s_waitcnt lgkmcnt(6)
    s_waitcnt vmcnt(10)
    v_mfma_f32_16x16x32_bf16 v[88:91], v[248:251], a[40:43], v[88:91]
    ds_read_b64_tr_b16 v[240:241], v24 offset:1024
    v_mfma_f32_16x16x32_bf16 v[92:95], v[248:251], a[44:47], v[92:95]
    ds_read_b64_tr_b16 v[242:243], v24 offset:1536
    v_mfma_f32_16x16x32_bf16 v[96:99], v[248:251], a[48:51], v[96:99]
    ds_read_b64_tr_b16 v[244:245], v24 offset:1032
    v_mfma_f32_16x16x32_bf16 v[100:103], v[248:251], a[52:55], v[100:103]
    ds_read_b64_tr_b16 v[246:247], v24 offset:1544
    v_mfma_f32_16x16x32_bf16 v[104:107], v[248:251], a[56:59], v[104:107]
    ds_read_b128 a[88:91], v21 offset:6144
    v_mfma_f32_16x16x32_bf16 v[108:111], v[248:251], a[60:63], v[108:111]
    ds_read_b128 a[92:95], v21 offset:7168
    v_mfma_f32_16x16x32_bf16 v[156:159], v[252:255], a[60:63], v[156:159]
    ds_read_b128 a[96:99], v21 offset:8192
    v_mfma_f32_16x16x32_bf16 v[152:155], v[252:255], a[56:59], v[152:155]
    ds_read_b128 a[100:103], v21 offset:9216
    s_add_u32 s65, s68, 458752
    v_mfma_f32_16x16x32_bf16 v[148:151], v[252:255], a[52:55], v[148:151]
    ds_read_b128 a[104:107], v21 offset:10240
    s_add_u32 m0, s59, 24584
    s_nop 0
    buffer_load_dwordx4 v22, s[24:27], s65 offen  lds
    v_mfma_f32_16x16x32_bf16 v[144:147], v[252:255], a[48:51], v[144:147]
    ds_read_b128 a[108:111], v21 offset:11264
    s_add_u32 m0, s67, 0
    s_nop 0
    buffer_load_dwordx4 v23, s[24:27], s65 offen  lds
    v_mfma_f32_16x16x32_bf16 v[140:143], v[252:255], a[44:47], v[140:143]
    v_mfma_f32_16x16x32_bf16 v[136:139], v[252:255], a[40:43], v[136:139]
    s_waitcnt lgkmcnt(6)
    s_waitcnt vmcnt(10)
    v_mfma_f32_16x16x32_bf16 v[88:91], v[240:243], a[64:67], v[88:91]
    ds_read_b64_tr_b16 v[248:249], v24 offset:2048
    v_mfma_f32_16x16x32_bf16 v[92:95], v[240:243], a[68:71], v[92:95]
    ds_read_b64_tr_b16 v[250:251], v24 offset:2560
    v_mfma_f32_16x16x32_bf16 v[96:99], v[240:243], a[72:75], v[96:99]
    ds_read_b64_tr_b16 v[252:253], v24 offset:2056
    v_mfma_f32_16x16x32_bf16 v[100:103], v[240:243], a[76:79], v[100:103]
    ds_read_b64_tr_b16 v[254:255], v24 offset:2568
    v_mfma_f32_16x16x32_bf16 v[104:107], v[240:243], a[80:83], v[104:107]
    ds_read_b128 a[112:115], v21 offset:12288
    v_mfma_f32_16x16x32_bf16 v[108:111], v[240:243], a[84:87], v[108:111]
    ds_read_b128 a[116:119], v21 offset:13312
    v_mfma_f32_16x16x32_bf16 v[156:159], v[244:247], a[84:87], v[156:159]
    ds_read_b128 a[120:123], v21 offset:14336
    v_mfma_f32_16x16x32_bf16 v[152:155], v[244:247], a[80:83], v[152:155]
    ds_read_b128 a[124:127], v21 offset:15360
    s_add_u32 s65, s68, 491520
    v_mfma_f32_16x16x32_bf16 v[148:151], v[244:247], a[76:79], v[148:151]
    ds_read_b128 a[128:131], v21 offset:16384
    s_add_u32 m0, s59, 25608
    s_nop 0
    buffer_load_dwordx4 v22, s[24:27], s65 offen  lds
    v_mfma_f32_16x16x32_bf16 v[144:147], v[244:247], a[72:75], v[144:147]
    ds_read_b128 a[132:135], v21 offset:17408
    s_add_u32 m0, s67, 1024
    s_nop 0
    buffer_load_dwordx4 v23, s[24:27], s65 offen  lds
    v_mfma_f32_16x16x32_bf16 v[140:143], v[244:247], a[68:71], v[140:143]
    v_mfma_f32_16x16x32_bf16 v[136:139], v[244:247], a[64:67], v[136:139]
    s_waitcnt lgkmcnt(6)
    s_waitcnt vmcnt(10)
    v_mfma_f32_16x16x32_bf16 v[88:91], v[248:251], a[88:91], v[88:91]
    ds_read_b64_tr_b16 v[240:241], v24 offset:3072
    v_mfma_f32_16x16x32_bf16 v[92:95], v[248:251], a[92:95], v[92:95]
    ds_read_b64_tr_b16 v[242:243], v24 offset:3584
    v_mfma_f32_16x16x32_bf16 v[96:99], v[248:251], a[96:99], v[96:99]
    ds_read_b64_tr_b16 v[244:245], v24 offset:3080
    v_mfma_f32_16x16x32_bf16 v[100:103], v[248:251], a[100:103], v[100:103]
    ds_read_b64_tr_b16 v[246:247], v24 offset:3592
    v_mfma_f32_16x16x32_bf16 v[104:107], v[248:251], a[104:107], v[104:107]
    ds_read_b128 a[136:139], v21 offset:18432
    v_mfma_f32_16x16x32_bf16 v[108:111], v[248:251], a[108:111], v[108:111]
    ds_read_b128 a[140:143], v21 offset:19456
    v_mfma_f32_16x16x32_bf16 v[156:159], v[252:255], a[108:111], v[156:159]
    ds_read_b128 a[144:147], v21 offset:20480
    v_mfma_f32_16x16x32_bf16 v[152:155], v[252:255], a[104:107], v[152:155]
    ds_read_b128 a[148:151], v21 offset:21504
    s_add_u32 s68, s72, 1
    s_and_b32 s68, s68, 3
    s_lshl_b32 s68, s68, 8
    s_add_u32 s65, s68, 0
    v_mfma_f32_16x16x32_bf16 v[148:151], v[252:255], a[100:103], v[148:151]
    ds_read_b128 a[152:155], v21 offset:22528
    s_add_u32 m0, s59, 26632
    s_nop 0
    buffer_load_dwordx4 v22, s[24:27], s65 offen  lds
    v_mfma_f32_16x16x32_bf16 v[144:147], v[252:255], a[96:99], v[144:147]
    ds_read_b128 a[156:159], v21 offset:23552
    s_add_u32 m0, s67, 2048
    s_nop 0
    buffer_load_dwordx4 v23, s[24:27], s65 offen  lds
    v_mfma_f32_16x16x32_bf16 v[140:143], v[252:255], a[92:95], v[140:143]
    v_mfma_f32_16x16x32_bf16 v[136:139], v[252:255], a[88:91], v[136:139]
    s_waitcnt lgkmcnt(6)
    s_waitcnt vmcnt(10)
    v_mfma_f32_16x16x32_bf16 v[88:91], v[240:243], a[112:115], v[88:91]
    ds_read_b64_tr_b16 v[248:249], v24 offset:4096
    v_mfma_f32_16x16x32_bf16 v[92:95], v[240:243], a[116:119], v[92:95]
    ds_read_b64_tr_b16 v[250:251], v24 offset:4608
    v_mfma_f32_16x16x32_bf16 v[96:99], v[240:243], a[120:123], v[96:99]
    ds_read_b64_tr_b16 v[252:253], v24 offset:4104
    v_mfma_f32_16x16x32_bf16 v[100:103], v[240:243], a[124:127], v[100:103]
    ds_read_b64_tr_b16 v[254:255], v24 offset:4616
    v_mfma_f32_16x16x32_bf16 v[104:107], v[240:243], a[128:131], v[104:107]
    ds_read_b128 a[160:163], v21 offset:32768
    v_mfma_f32_16x16x32_bf16 v[108:111], v[240:243], a[132:135], v[108:111]
    ds_read_b128 a[164:167], v21 offset:33792
    v_mfma_f32_16x16x32_bf16 v[156:159], v[244:247], a[132:135], v[156:159]
    ds_read_b128 a[168:171], v21 offset:34816
    v_mfma_f32_16x16x32_bf16 v[152:155], v[244:247], a[128:131], v[152:155]
    ds_read_b128 a[172:175], v21 offset:35840
    s_add_u32 s65, s68, 32768
    v_mfma_f32_16x16x32_bf16 v[148:151], v[244:247], a[124:127], v[148:151]
    ds_read_b128 a[176:179], v21 offset:36864
    s_add_u32 m0, s59, 27656
    s_nop 0
    buffer_load_dwordx4 v22, s[24:27], s65 offen  lds
    v_mfma_f32_16x16x32_bf16 v[144:147], v[244:247], a[120:123], v[144:147]
    ds_read_b128 a[180:183], v21 offset:37888
    s_add_u32 m0, s67, 3072
    s_nop 0
    buffer_load_dwordx4 v23, s[24:27], s65 offen  lds
    v_mfma_f32_16x16x32_bf16 v[140:143], v[244:247], a[116:119], v[140:143]
    v_mfma_f32_16x16x32_bf16 v[136:139], v[244:247], a[112:115], v[136:139]
    s_waitcnt lgkmcnt(6)
    s_waitcnt vmcnt(10)
    v_mfma_f32_16x16x32_bf16 v[88:91], v[248:251], a[136:139], v[88:91]
    ds_read_b64_tr_b16 v[240:241], v24 offset:5120
    v_mfma_f32_16x16x32_bf16 v[92:95], v[248:251], a[140:143], v[92:95]
    ds_read_b64_tr_b16 v[242:243], v24 offset:5632
    v_mfma_f32_16x16x32_bf16 v[96:99], v[248:251], a[144:147], v[96:99]
    ds_read_b64_tr_b16 v[244:245], v24 offset:5128
    v_mfma_f32_16x16x32_bf16 v[100:103], v[248:251], a[148:151], v[100:103]
    ds_read_b64_tr_b16 v[246:247], v24 offset:5640
    v_mfma_f32_16x16x32_bf16 v[104:107], v[248:251], a[152:155], v[104:107]
    ds_read_b128 a[184:187], v21 offset:38912
    v_mfma_f32_16x16x32_bf16 v[108:111], v[248:251], a[156:159], v[108:111]
    ds_read_b128 a[188:191], v21 offset:39936
    v_mfma_f32_16x16x32_bf16 v[156:159], v[252:255], a[156:159], v[156:159]
    ds_read_b128 a[192:195], v21 offset:40960
    v_mfma_f32_16x16x32_bf16 v[152:155], v[252:255], a[152:155], v[152:155]
    ds_read_b128 a[196:199], v21 offset:41984
    s_add_u32 s65, s68, 65536
    v_mfma_f32_16x16x32_bf16 v[148:151], v[252:255], a[148:151], v[148:151]
    ds_read_b128 a[200:203], v21 offset:43008
    s_add_u32 m0, s59, 28680
    s_nop 0
    buffer_load_dwordx4 v22, s[24:27], s65 offen  lds
    v_mfma_f32_16x16x32_bf16 v[144:147], v[252:255], a[144:147], v[144:147]
    ds_read_b128 a[204:207], v21 offset:44032
    s_add_u32 m0, s67, 4096
    s_nop 0
    buffer_load_dwordx4 v23, s[24:27], s65 offen  lds
    v_mfma_f32_16x16x32_bf16 v[140:143], v[252:255], a[140:143], v[140:143]
    v_mfma_f32_16x16x32_bf16 v[136:139], v[252:255], a[136:139], v[136:139]
    s_waitcnt lgkmcnt(6)
    s_waitcnt vmcnt(10)
    v_readfirstlane_b32 s3, v29
    s_mov_b32 s43, 0
L_hs_spin:
    s_nop 2
    s_cmp_ge_u32 s3, 8
    s_cbranch_scc1 L_hs_ok
    s_add_u32 s43, s43, 1
    s_cmp_ge_u32 s43, 200000
    s_cbranch_scc1 L_hs_ok
    buffer_load_dword v29, v30, s[36:39], 0 offen sc1
    s_waitcnt vmcnt(0)
    v_readfirstlane_b32 s3, v29
    s_branch L_hs_spin
L_hs_ok:
    v_mfma_f32_16x16x32_bf16 v[88:91], v[240:243], a[160:163], v[88:91]
    ds_read_b64_tr_b16 v[248:249], v24 offset:6144
    v_mfma_f32_16x16x32_bf16 v[92:95], v[240:243], a[164:167], v[92:95]
    ds_read_b64_tr_b16 v[250:251], v24 offset:6656
    v_mfma_f32_16x16x32_bf16 v[96:99], v[240:243], a[168:171], v[96:99]
    ds_read_b64_tr_b16 v[252:253], v24 offset:6152
    v_mfma_f32_16x16x32_bf16 v[100:103], v[240:243], a[172:175], v[100:103]
    ds_read_b64_tr_b16 v[254:255], v24 offset:6664
    v_mfma_f32_16x16x32_bf16 v[104:107], v[240:243], a[176:179], v[104:107]
    ds_read_b128 a[208:211], v21 offset:45056
    v_mfma_f32_16x16x32_bf16 v[108:111], v[240:243], a[180:183], v[108:111]
    ds_read_b128 a[212:215], v21 offset:46080
    v_mfma_f32_16x16x32_bf16 v[156:159], v[244:247], a[180:183], v[156:159]
    ds_read_b128 a[216:219], v21 offset:47104
    v_mfma_f32_16x16x32_bf16 v[152:155], v[244:247], a[176:179], v[152:155]
    ds_read_b128 a[220:223], v21 offset:48128
    s_add_u32 s65, s68, 98304
    v_mfma_f32_16x16x32_bf16 v[148:151], v[244:247], a[172:175], v[148:151]
    ds_read_b128 a[224:227], v21 offset:49152
    s_add_u32 m0, s59, 29704
    s_nop 0
    buffer_load_dwordx4 v22, s[24:27], s65 offen  lds
    v_mfma_f32_16x16x32_bf16 v[144:147], v[244:247], a[168:171], v[144:147]
    ds_read_b128 a[228:231], v21 offset:50176
    s_add_u32 m0, s67, 5120
    s_nop 0
    buffer_load_dwordx4 v23, s[24:27], s65 offen  lds
    v_mfma_f32_16x16x32_bf16 v[140:143], v[244:247], a[164:167], v[140:143]
    v_mfma_f32_16x16x32_bf16 v[136:139], v[244:247], a[160:163], v[136:139]
    s_waitcnt lgkmcnt(6)
    s_waitcnt vmcnt(10)
    v_mfma_f32_16x16x32_bf16 v[88:91], v[248:251], a[184:187], v[88:91]
    ds_read_b64_tr_b16 v[240:241], v24 offset:0
    v_mfma_f32_16x16x32_bf16 v[92:95], v[248:251], a[188:191], v[92:95]
    ds_read_b64_tr_b16 v[242:243], v24 offset:512
    v_mfma_f32_16x16x32_bf16 v[96:99], v[248:251], a[192:195], v[96:99]
    ds_read_b64_tr_b16 v[244:245], v24 offset:8
    v_mfma_f32_16x16x32_bf16 v[100:103], v[248:251], a[196:199], v[100:103]
    ds_read_b64_tr_b16 v[246:247], v24 offset:520
    v_mfma_f32_16x16x32_bf16 v[104:107], v[248:251], a[200:203], v[104:107]
    ds_read_b128 a[232:235], v21 offset:51200
    v_mfma_f32_16x16x32_bf16 v[108:111], v[248:251], a[204:207], v[108:111]
    ds_read_b128 a[236:239], v21 offset:52224
    v_mfma_f32_16x16x32_bf16 v[156:159], v[252:255], a[204:207], v[156:159]
    ds_read_b128 a[240:243], v21 offset:53248
    v_mfma_f32_16x16x32_bf16 v[152:155], v[252:255], a[200:203], v[152:155]
    ds_read_b128 a[244:247], v21 offset:54272
    s_add_u32 s65, s68, 131072
    v_mfma_f32_16x16x32_bf16 v[148:151], v[252:255], a[196:199], v[148:151]
    ds_read_b128 a[248:251], v21 offset:55296
    s_add_u32 m0, s59, 30728
    s_nop 0
    buffer_load_dwordx4 v22, s[24:27], s65 offen  lds
    v_mfma_f32_16x16x32_bf16 v[144:147], v[252:255], a[192:195], v[144:147]
    ds_read_b128 a[252:255], v21 offset:56320
    s_add_u32 m0, s67, 6144
    s_nop 0
    buffer_load_dwordx4 v23, s[24:27], s65 offen  lds
    v_mfma_f32_16x16x32_bf16 v[140:143], v[252:255], a[188:191], v[140:143]
    v_mfma_f32_16x16x32_bf16 v[136:139], v[252:255], a[184:187], v[136:139]
    s_waitcnt lgkmcnt(6)
    s_waitcnt vmcnt(10)
    v_mfma_f32_16x16x32_bf16 v[88:91], v[240:243], a[208:211], v[88:91]
    ds_read_b64_tr_b16 v[248:249], v24 offset:1024
    s_mul_i32 s3, s54, 48
    v_min_u32 v29, 47, v1
    v_mfma_f32_16x16x32_bf16 v[92:95], v[240:243], a[212:215], v[92:95]
    ds_read_b64_tr_b16 v[250:251], v24 offset:1536
    v_add_u32 v29, s3, v29
    v_lshrrev_b32 v30, 6, v29
    v_mfma_f32_16x16x32_bf16 v[96:99], v[240:243], a[216:219], v[96:99]
    ds_read_b64_tr_b16 v[252:253], v24 offset:1032
    s_and_b32 s3, s57, 1
    s_mul_i32 s3, s3, 3
    v_mfma_f32_16x16x32_bf16 v[100:103], v[240:243], a[220:223], v[100:103]
    ds_read_b64_tr_b16 v[254:255], v24 offset:1544
    v_add_u32 v30, s3, v30
    v_mfma_f32_16x16x32_bf16 v[104:107], v[240:243], a[224:227], v[104:107]
    s_add_u32 s65, s68, 163840
    v_lshlrev_b32 v30, 4, v30
    v_and_b32 v2, 15, v29
    v_mfma_f32_16x16x32_bf16 v[108:111], v[240:243], a[228:231], v[108:111]
    v_add_u32 v30, v30, v2
    s_mul_i32 s3, s56, 96
    s_add_u32 m0, s59, 24584
    v_mfma_f32_16x16x32_bf16 v[156:159], v[244:247], a[228:231], v[156:159]
    buffer_load_dwordx4 v22, s[24:27], s65 offen  lds
    v_add_u32 v30, s3, v30
    v_lshlrev_b32 v30, 11, v30
    v_mfma_f32_16x16x32_bf16 v[152:155], v[244:247], a[224:227], v[152:155]
    v_bfe_u32 v29, v29, 4, 2
    v_mfma_f32_16x16x32_bf16 v[148:151], v[244:247], a[220:223], v[148:151]
    v_lshl_add_u32 v30, v29, 4, v30
    s_lshl_b32 s3, s55, 10
    s_add_u32 m0, s67, 0
    v_mfma_f32_16x16x32_bf16 v[144:147], v[244:247], a[216:219], v[144:147]
    buffer_load_dwordx4 v23, s[24:27], s65 offen  lds
    s_lshr_b32 s63, s57, 1
    s_lshl_b32 s63, s63, 6
    v_mfma_f32_16x16x32_bf16 v[140:143], v[244:247], a[212:215], v[140:143]
    s_add_u32 s3, s3, s63
    v_add_u32 v2, s3, v30
    v_mfma_f32_16x16x32_bf16 v[136:139], v[244:247], a[208:211], v[136:139]
    s_mov_b32 s44, 0xffff0000
    s_waitcnt lgkmcnt(0)
    s_waitcnt vmcnt(10)
    v_mfma_f32_16x16x32_bf16 v[88:91], v[248:251], a[232:235], v[88:91]
    ds_read_b64_tr_b16 v[240:241], v24 offset:2048
    v_mfma_f32_16x16x32_bf16 v[92:95], v[248:251], a[236:239], v[92:95]
    ds_read_b64_tr_b16 v[242:243], v24 offset:2560
    v_mfma_f32_16x16x32_bf16 v[96:99], v[248:251], a[240:243], v[96:99]
    ds_read_b64_tr_b16 v[244:245], v24 offset:2056
    v_mfma_f32_16x16x32_bf16 v[100:103], v[248:251], a[244:247], v[100:103]
    ds_read_b64_tr_b16 v[246:247], v24 offset:2568
    v_mfma_f32_16x16x32_bf16 v[104:107], v[248:251], a[248:251], v[104:107]
    s_add_u32 s65, s68, 196608
    v_mfma_f32_16x16x32_bf16 v[108:111], v[248:251], a[252:255], v[108:111]
    s_add_u32 m0, s59, 25608
    v_mfma_f32_16x16x32_bf16 v[156:159], v[252:255], a[252:255], v[156:159]
    buffer_load_dwordx4 v22, s[24:27], s65 offen  lds
    v_mfma_f32_16x16x32_bf16 v[152:155], v[252:255], a[248:251], v[152:155]
    v_mfma_f32_16x16x32_bf16 v[148:151], v[252:255], a[244:247], v[148:151]
    s_add_u32 m0, s67, 1024
    v_mfma_f32_16x16x32_bf16 v[144:147], v[252:255], a[240:243], v[144:147]
    buffer_load_dwordx4 v23, s[24:27], s65 offen  lds
    v_mfma_f32_16x16x32_bf16 v[140:143], v[252:255], a[236:239], v[140:143]
    v_mfma_f32_16x16x32_bf16 v[136:139], v[252:255], a[232:235], v[136:139]
    s_waitcnt lgkmcnt(0)
    s_add_u32 s69, s72, 0
    s_and_b32 s69, s69, 3
    s_mul_i32 s69, s69, 24576
    s_add_u32 s70, s69, 4096
    v_cvt_pk_bf16_f32 v108, v108, v109
    v_cvt_pk_bf16_f32 v109, v110, v111
    v_cvt_pk_bf16_f32 v110, v156, v157
    v_cvt_pk_bf16_f32 v111, v158, v159
    buffer_store_dwordx4 v[108:111], v28, s[28:31], s70 offen offset:1024 sc0 sc1
    v_cvt_pk_bf16_f32 v104, v104, v105
    v_cvt_pk_bf16_f32 v105, v106, v107
    v_cvt_pk_bf16_f32 v106, v152, v153
    v_cvt_pk_bf16_f32 v107, v154, v155
    buffer_store_dwordx4 v[104:107], v28, s[28:31], s70 offen offset:0 sc0 sc1
    v_cvt_pk_bf16_f32 v100, v100, v101
    v_cvt_pk_bf16_f32 v101, v102, v103
    v_cvt_pk_bf16_f32 v102, v148, v149
    v_cvt_pk_bf16_f32 v103, v150, v151
    buffer_store_dwordx4 v[100:103], v28, s[28:31], s69 offen offset:3072 sc0 sc1
    v_cvt_pk_bf16_f32 v96, v96, v97
    v_cvt_pk_bf16_f32 v97, v98, v99
    v_cvt_pk_bf16_f32 v98, v144, v145
    v_cvt_pk_bf16_f32 v99, v146, v147
    buffer_store_dwordx4 v[96:99], v28, s[28:31], s69 offen offset:2048 sc0 sc1
    v_cvt_pk_bf16_f32 v92, v92, v93
    v_cvt_pk_bf16_f32 v93, v94, v95
    v_cvt_pk_bf16_f32 v94, v140, v141
    v_cvt_pk_bf16_f32 v95, v142, v143
    buffer_store_dwordx4 v[92:95], v28, s[28:31], s69 offen offset:1024 sc0 sc1
    v_cvt_pk_bf16_f32 v88, v88, v89
    v_cvt_pk_bf16_f32 v89, v90, v91
    v_cvt_pk_bf16_f32 v90, v136, v137
    v_cvt_pk_bf16_f32 v91, v138, v139
    buffer_store_dwordx4 v[88:91], v28, s[28:31], s69 offen offset:0 sc0 sc1
    s_waitcnt vmcnt(16)
    s_nop 0
    v_mfma_f32_16x16x32_bf16 v[88:91], v[240:243], v[64:67], 0
    ds_read_b64_tr_b16 v[248:249], v24 offset:3072
    v_mfma_f32_16x16x32_bf16 v[92:95], v[240:243], v[68:71], 0
    ds_read_b64_tr_b16 v[250:251], v24 offset:3584
    v_mfma_f32_16x16x32_bf16 v[96:99], v[240:243], v[72:75], 0
    ds_read_b64_tr_b16 v[252:253], v24 offset:3080
    v_mfma_f32_16x16x32_bf16 v[100:103], v[240:243], v[76:79], 0
    ds_read_b64_tr_b16 v[254:255], v24 offset:3592
    v_mfma_f32_16x16x32_bf16 v[104:107], v[240:243], v[80:83], 0
    s_add_u32 s65, s68, 229376
    v_mfma_f32_16x16x32_bf16 v[108:111], v[240:243], v[84:87], 0
    s_add_u32 m0, s59, 26632
    v_mfma_f32_16x16x32_bf16 v[156:159], v[244:247], v[84:87], 0
    buffer_load_dwordx4 v22, s[24:27], s65 offen  lds
    v_mfma_f32_16x16x32_bf16 v[152:155], v[244:247], v[80:83], 0
    v_mfma_f32_16x16x32_bf16 v[148:151], v[244:247], v[76:79], 0
    s_add_u32 m0, s67, 2048
    v_mfma_f32_16x16x32_bf16 v[144:147], v[244:247], v[72:75], 0
    buffer_load_dwordx4 v23, s[24:27], s65 offen  lds
    v_mfma_f32_16x16x32_bf16 v[140:143], v[244:247], v[68:71], 0
    v_mfma_f32_16x16x32_bf16 v[136:139], v[244:247], v[64:67], 0
    s_waitcnt lgkmcnt(0)
    s_waitcnt vmcnt(16)
    v_mfma_f32_16x16x32_bf16 v[88:91], v[248:251], v[112:115], v[88:91]
    ds_read_b64_tr_b16 v[240:241], v24 offset:4096
    v_mfma_f32_16x16x32_bf16 v[92:95], v[248:251], v[116:119], v[92:95]
    ds_read_b64_tr_b16 v[242:243], v24 offset:4608
    v_mfma_f32_16x16x32_bf16 v[96:99], v[248:251], v[120:123], v[96:99]
    ds_read_b64_tr_b16 v[244:245], v24 offset:4104
    v_mfma_f32_16x16x32_bf16 v[100:103], v[248:251], v[124:127], v[100:103]
    ds_read_b64_tr_b16 v[246:247], v24 offset:4616
    v_mfma_f32_16x16x32_bf16 v[104:107], v[248:251], v[128:131], v[104:107]
    s_add_u32 s65, s68, 262144
    v_mfma_f32_16x16x32_bf16 v[108:111], v[248:251], v[132:135], v[108:111]
    s_add_u32 m0, s59, 27656
    v_mfma_f32_16x16x32_bf16 v[156:159], v[252:255], v[132:135], v[156:159]
    buffer_load_dwordx4 v22, s[24:27], s65 offen  lds
    v_mfma_f32_16x16x32_bf16 v[152:155], v[252:255], v[128:131], v[152:155]
    v_mfma_f32_16x16x32_bf16 v[148:151], v[252:255], v[124:127], v[148:151]
    s_add_u32 m0, s67, 3072
    v_mfma_f32_16x16x32_bf16 v[144:147], v[252:255], v[120:123], v[144:147]
    buffer_load_dwordx4 v23, s[24:27], s65 offen  lds
    v_mfma_f32_16x16x32_bf16 v[140:143], v[252:255], v[116:119], v[140:143]
    v_mfma_f32_16x16x32_bf16 v[136:139], v[252:255], v[112:115], v[136:139]
    s_waitcnt lgkmcnt(0)
    s_waitcnt vmcnt(16)
    v_mfma_f32_16x16x32_bf16 v[88:91], v[240:243], v[160:163], v[88:91]
    ds_read_b64_tr_b16 v[248:249], v24 offset:5120
    v_mfma_f32_16x16x32_bf16 v[92:95], v[240:243], v[164:167], v[92:95]
    ds_read_b64_tr_b16 v[250:251], v24 offset:5632
    v_mfma_f32_16x16x32_bf16 v[96:99], v[240:243], v[168:171], v[96:99]
    ds_read_b64_tr_b16 v[252:253], v24 offset:5128
    v_mfma_f32_16x16x32_bf16 v[100:103], v[240:243], v[172:175], v[100:103]
    ds_read_b64_tr_b16 v[254:255], v24 offset:5640
    v_mfma_f32_16x16x32_bf16 v[104:107], v[240:243], v[176:179], v[104:107]
    s_add_u32 s65, s68, 294912
    v_mfma_f32_16x16x32_bf16 v[108:111], v[240:243], v[180:183], v[108:111]
    s_add_u32 m0, s59, 28680
    v_mfma_f32_16x16x32_bf16 v[156:159], v[244:247], v[180:183], v[156:159]
    buffer_load_dwordx4 v22, s[24:27], s65 offen  lds
    v_mfma_f32_16x16x32_bf16 v[152:155], v[244:247], v[176:179], v[152:155]
    v_mfma_f32_16x16x32_bf16 v[148:151], v[244:247], v[172:175], v[148:151]
    s_add_u32 m0, s67, 4096
    v_mfma_f32_16x16x32_bf16 v[144:147], v[244:247], v[168:171], v[144:147]
    buffer_load_dwordx4 v23, s[24:27], s65 offen  lds
    v_mfma_f32_16x16x32_bf16 v[140:143], v[244:247], v[164:167], v[140:143]
    v_mfma_f32_16x16x32_bf16 v[136:139], v[244:247], v[160:163], v[136:139]
    s_waitcnt lgkmcnt(0)
    s_waitcnt vmcnt(16)
    v_mfma_f32_16x16x32_bf16 v[88:91], v[248:251], v[208:211], v[88:91]
    ds_read_b64_tr_b16 v[240:241], v24 offset:6144
    v_mfma_f32_16x16x32_bf16 v[92:95], v[248:251], v[212:215], v[92:95]
    ds_read_b64_tr_b16 v[242:243], v24 offset:6656
    v_mfma_f32_16x16x32_bf16 v[96:99], v[248:251], v[216:219], v[96:99]
    ds_read_b64_tr_b16 v[244:245], v24 offset:6152
    v_mfma_f32_16x16x32_bf16 v[100:103], v[248:251], v[220:223], v[100:103]
    ds_read_b64_tr_b16 v[246:247], v24 offset:6664
    v_mfma_f32_16x16x32_bf16 v[104:107], v[248:251], v[224:227], v[104:107]
    s_add_u32 s65, s68, 327680
    v_mfma_f32_16x16x32_bf16 v[108:111], v[248:251], v[228:231], v[108:111]
    s_add_u32 m0, s59, 29704
    v_mfma_f32_16x16x32_bf16 v[156:159], v[252:255], v[228:231], v[156:159]
    buffer_load_dwordx4 v22, s[24:27], s65 offen  lds
    v_mfma_f32_16x16x32_bf16 v[152:155], v[252:255], v[224:227], v[152:155]
    v_mfma_f32_16x16x32_bf16 v[148:151], v[252:255], v[220:223], v[148:151]
    s_add_u32 m0, s67, 5120
    v_mfma_f32_16x16x32_bf16 v[144:147], v[252:255], v[216:219], v[144:147]
    buffer_load_dwordx4 v23, s[24:27], s65 offen  lds
    v_mfma_f32_16x16x32_bf16 v[140:143], v[252:255], v[212:215], v[140:143]
    v_mfma_f32_16x16x32_bf16 v[136:139], v[252:255], v[208:211], v[136:139]
    s_waitcnt lgkmcnt(0)
    s_waitcnt vmcnt(16)
    v_mfma_f32_16x16x32_bf16 v[88:91], v[240:243], v[184:187], v[88:91]
    ds_read_b64_tr_b16 v[248:249], v24 offset:0
    v_mfma_f32_16x16x32_bf16 v[92:95], v[240:243], v[188:191], v[92:95]
    ds_read_b64_tr_b16 v[250:251], v24 offset:512
    v_mfma_f32_16x16x32_bf16 v[96:99], v[240:243], v[192:195], v[96:99]
    ds_read_b64_tr_b16 v[252:253], v24 offset:8
    v_mfma_f32_16x16x32_bf16 v[100:103], v[240:243], v[196:199], v[100:103]
    ds_read_b64_tr_b16 v[254:255], v24 offset:520
    v_mfma_f32_16x16x32_bf16 v[104:107], v[240:243], v[200:203], v[104:107]
    s_add_u32 s65, s68, 360448
    v_mfma_f32_16x16x32_bf16 v[108:111], v[240:243], v[204:207], v[108:111]
    s_add_u32 m0, s59, 30728
    v_mfma_f32_16x16x32_bf16 v[156:159], v[244:247], v[204:207], v[156:159]
    buffer_load_dwordx4 v22, s[24:27], s65 offen  lds
    v_mfma_f32_16x16x32_bf16 v[152:155], v[244:247], v[200:203], v[152:155]
    v_mfma_f32_16x16x32_bf16 v[148:151], v[244:247], v[196:199], v[148:151]
    s_add_u32 m0, s67, 6144
    v_mfma_f32_16x16x32_bf16 v[144:147], v[244:247], v[192:195], v[144:147]
    buffer_load_dwordx4 v23, s[24:27], s65 offen  lds
    v_mfma_f32_16x16x32_bf16 v[140:143], v[244:247], v[188:191], v[140:143]
    v_mfma_f32_16x16x32_bf16 v[136:139], v[244:247], v[184:187], v[136:139]
    s_waitcnt lgkmcnt(0)
    s_waitcnt vmcnt(16)
    v_mfma_f32_16x16x32_bf16 v[88:91], v[248:251], v[232:235], v[88:91]
    ds_read_b64_tr_b16 v[240:241], v24 offset:1024
    v_mfma_f32_16x16x32_bf16 v[92:95], v[248:251], v[236:239], v[92:95]
    ds_read_b64_tr_b16 v[242:243], v24 offset:1536
    v_mfma_f32_16x16x32_bf16 v[96:99], v[248:251], a[0:3], v[96:99]
    ds_read_b64_tr_b16 v[244:245], v24 offset:1032
    v_mfma_f32_16x16x32_bf16 v[100:103], v[248:251], a[4:7], v[100:103]
    ds_read_b64_tr_b16 v[246:247], v24 offset:1544
    v_mfma_f32_16x16x32_bf16 v[104:107], v[248:251], a[8:11], v[104:107]
    s_add_u32 s65, s68, 393216
    v_mfma_f32_16x16x32_bf16 v[108:111], v[248:251], a[12:15], v[108:111]
    s_add_u32 m0, s59, 24584
    v_mfma_f32_16x16x32_bf16 v[156:159], v[252:255], a[12:15], v[156:159]
    buffer_load_dwordx4 v22, s[24:27], s65 offen  lds
    v_mfma_f32_16x16x32_bf16 v[152:155], v[252:255], a[8:11], v[152:155]
    v_mfma_f32_16x16x32_bf16 v[148:151], v[252:255], a[4:7], v[148:151]
    s_add_u32 m0, s67, 0
    v_mfma_f32_16x16x32_bf16 v[144:147], v[252:255], a[0:3], v[144:147]
    buffer_load_dwordx4 v23, s[24:27], s65 offen  lds
    v_mfma_f32_16x16x32_bf16 v[140:143], v[252:255], v[236:239], v[140:143]
    v_mfma_f32_16x16x32_bf16 v[136:139], v[252:255], v[232:235], v[136:139]
    s_waitcnt lgkmcnt(0)
    s_waitcnt vmcnt(10)
    v_mfma_f32_16x16x32_bf16 v[88:91], v[240:243], a[16:19], v[88:91]
    ds_read_b64_tr_b16 v[248:249], v24 offset:2048
    v_mfma_f32_16x16x32_bf16 v[92:95], v[240:243], a[20:23], v[92:95]
    ds_read_b64_tr_b16 v[250:251], v24 offset:2560
    v_mfma_f32_16x16x32_bf16 v[96:99], v[240:243], a[24:27], v[96:99]
    ds_read_b64_tr_b16 v[252:253], v24 offset:2056
    v_mfma_f32_16x16x32_bf16 v[100:103], v[240:243], a[28:31], v[100:103]
    ds_read_b64_tr_b16 v[254:255], v24 offset:2568
    v_mfma_f32_16x16x32_bf16 v[104:107], v[240:243], a[32:35], v[104:107]
    s_add_u32 s65, s68, 425984
    v_mfma_f32_16x16x32_bf16 v[108:111], v[240:243], a[36:39], v[108:111]
    s_add_u32 m0, s59, 25608
    v_mfma_f32_16x16x32_bf16 v[156:159], v[244:247], a[36:39], v[156:159]
    buffer_load_dwordx4 v22, s[24:27], s65 offen  lds
    v_mfma_f32_16x16x32_bf16 v[152:155], v[244:247], a[32:35], v[152:155]
    v_mfma_f32_16x16x32_bf16 v[148:151], v[244:247], a[28:31], v[148:151]
    s_add_u32 m0, s67, 1024
    v_mfma_f32_16x16x32_bf16 v[144:147], v[244:247], a[24:27], v[144:147]
    buffer_load_dwordx4 v23, s[24:27], s65 offen  lds
    v_mfma_f32_16x16x32_bf16 v[140:143], v[244:247], a[20:23], v[140:143]
    v_mfma_f32_16x16x32_bf16 v[136:139], v[244:247], a[16:19], v[136:139]
    s_waitcnt lgkmcnt(0)
    s_waitcnt vmcnt(10)
    v_mfma_f32_16x16x32_bf16 v[88:91], v[248:251], a[40:43], v[88:91]
    ds_read_b64_tr_b16 v[240:241], v24 offset:3072
    v_mfma_f32_16x16x32_bf16 v[92:95], v[248:251], a[44:47], v[92:95]
    ds_read_b64_tr_b16 v[242:243], v24 offset:3584
    v_mfma_f32_16x16x32_bf16 v[96:99], v[248:251], a[48:51], v[96:99]
    ds_read_b64_tr_b16 v[244:245], v24 offset:3080
    v_mfma_f32_16x16x32_bf16 v[100:103], v[248:251], a[52:55], v[100:103]
    ds_read_b64_tr_b16 v[246:247], v24 offset:3592
    v_mfma_f32_16x16x32_bf16 v[104:107], v[248:251], a[56:59], v[104:107]
    s_add_u32 s65, s68, 458752
    v_mfma_f32_16x16x32_bf16 v[108:111], v[248:251], a[60:63], v[108:111]
    s_add_u32 m0, s59, 26632
    v_mfma_f32_16x16x32_bf16 v[156:159], v[252:255], a[60:63], v[156:159]
    buffer_load_dwordx4 v22, s[24:27], s65 offen  lds
    s_mov_b32 s64, 0
    buffer_store_dword v3, v25, s[28:31], s64 offen sc1
    v_mfma_f32_16x16x32_bf16 v[152:155], v[252:255], a[56:59], v[152:155]
    v_mfma_f32_16x16x32_bf16 v[148:151], v[252:255], a[52:55], v[148:151]
    s_add_u32 m0, s67, 2048
    v_mfma_f32_16x16x32_bf16 v[144:147], v[252:255], a[48:51], v[144:147]
    buffer_load_dwordx4 v23, s[24:27], s65 offen  lds
    v_mfma_f32_16x16x32_bf16 v[140:143], v[252:255], a[44:47], v[140:143]
    v_mfma_f32_16x16x32_bf16 v[136:139], v[252:255], a[40:43], v[136:139]
    s_waitcnt lgkmcnt(0)
    s_waitcnt vmcnt(11)
    v_mfma_f32_16x16x32_bf16 v[88:91], v[240:243], a[64:67], v[88:91]
    ds_read_b64_tr_b16 v[248:249], v24 offset:4096
    v_mfma_f32_16x16x32_bf16 v[92:95], v[240:243], a[68:71], v[92:95]
    ds_read_b64_tr_b16 v[250:251], v24 offset:4608
    v_mfma_f32_16x16x32_bf16 v[96:99], v[240:243], a[72:75], v[96:99]
    ds_read_b64_tr_b16 v[252:253], v24 offset:4104
    v_mfma_f32_16x16x32_bf16 v[100:103], v[240:243], a[76:79], v[100:103]
    ds_read_b64_tr_b16 v[254:255], v24 offset:4616
    v_mfma_f32_16x16x32_bf16 v[104:107], v[240:243], a[80:83], v[104:107]
    s_add_u32 s65, s68, 491520
    v_mfma_f32_16x16x32_bf16 v[108:111], v[240:243], a[84:87], v[108:111]
    s_add_u32 m0, s59, 27656
    v_mfma_f32_16x16x32_bf16 v[156:159], v[244:247], a[84:87], v[156:159]
    buffer_load_dwordx4 v22, s[24:27], s65 offen  lds
    v_mfma_f32_16x16x32_bf16 v[152:155], v[244:247], a[80:83], v[152:155]
    v_mfma_f32_16x16x32_bf16 v[148:151], v[244:247], a[76:79], v[148:151]
    s_add_u32 m0, s67, 3072
    v_mfma_f32_16x16x32_bf16 v[144:147], v[244:247], a[72:75], v[144:147]
    buffer_load_dwordx4 v23, s[24:27], s65 offen  lds
    v_mfma_f32_16x16x32_bf16 v[140:143], v[244:247], a[68:71], v[140:143]
    v_mfma_f32_16x16x32_bf16 v[136:139], v[244:247], a[64:67], v[136:139]
    s_waitcnt lgkmcnt(0)
    s_waitcnt vmcnt(11)
    v_mfma_f32_16x16x32_bf16 v[88:91], v[248:251], a[88:91], v[88:91]
    ds_read_b64_tr_b16 v[240:241], v24 offset:5120
    v_mfma_f32_16x16x32_bf16 v[92:95], v[248:251], a[92:95], v[92:95]
    ds_read_b64_tr_b16 v[242:243], v24 offset:5632
    v_mfma_f32_16x16x32_bf16 v[96:99], v[248:251], a[96:99], v[96:99]
    ds_read_b64_tr_b16 v[244:245], v24 offset:5128
    v_mfma_f32_16x16x32_bf16 v[100:103], v[248:251], a[100:103], v[100:103]
    ds_read_b64_tr_b16 v[246:247], v24 offset:5640
    v_mfma_f32_16x16x32_bf16 v[104:107], v[248:251], a[104:107], v[104:107]
    s_add_u32 s68, s72, 2
    s_and_b32 s68, s68, 3
    s_lshl_b32 s68, s68, 8
    s_add_u32 s65, s68, 0
    v_mfma_f32_16x16x32_bf16 v[108:111], v[248:251], a[108:111], v[108:111]
    s_add_u32 m0, s59, 28680
    v_mfma_f32_16x16x32_bf16 v[156:159], v[252:255], a[108:111], v[156:159]
    buffer_load_dwordx4 v22, s[24:27], s65 offen  lds
    v_mfma_f32_16x16x32_bf16 v[152:155], v[252:255], a[104:107], v[152:155]
    v_mfma_f32_16x16x32_bf16 v[148:151], v[252:255], a[100:103], v[148:151]
    s_add_u32 m0, s67, 4096
    v_mfma_f32_16x16x32_bf16 v[144:147], v[252:255], a[96:99], v[144:147]
    buffer_load_dwordx4 v23, s[24:27], s65 offen  lds
    v_mfma_f32_16x16x32_bf16 v[140:143], v[252:255], a[92:95], v[140:143]
    v_mfma_f32_16x16x32_bf16 v[136:139], v[252:255], a[88:91], v[136:139]
    s_waitcnt lgkmcnt(0)
    s_waitcnt vmcnt(11)
    v_mfma_f32_16x16x32_bf16 v[88:91], v[240:243], a[112:115], v[88:91]
    ds_read_b64_tr_b16 v[248:249], v24 offset:6144
    v_mfma_f32_16x16x32_bf16 v[92:95], v[240:243], a[116:119], v[92:95]
    ds_read_b64_tr_b16 v[250:251], v24 offset:6656
    v_mfma_f32_16x16x32_bf16 v[96:99], v[240:243], a[120:123], v[96:99]
    ds_read_b64_tr_b16 v[252:253], v24 offset:6152
    v_mfma_f32_16x16x32_bf16 v[100:103], v[240:243], a[124:127], v[100:103]
    ds_read_b64_tr_b16 v[254:255], v24 offset:6664
    v_mfma_f32_16x16x32_bf16 v[104:107], v[240:243], a[128:131], v[104:107]
    s_add_u32 s65, s68, 32768
    v_mfma_f32_16x16x32_bf16 v[108:111], v[240:243], a[132:135], v[108:111]
    s_add_u32 m0, s59, 29704
    v_mfma_f32_16x16x32_bf16 v[156:159], v[244:247], a[132:135], v[156:159]
    buffer_load_dwordx4 v22, s[24:27], s65 offen  lds
    v_mfma_f32_16x16x32_bf16 v[152:155], v[244:247], a[128:131], v[152:155]
    v_mfma_f32_16x16x32_bf16 v[148:151], v[244:247], a[124:127], v[148:151]
    s_add_u32 m0, s67, 5120
    v_mfma_f32_16x16x32_bf16 v[144:147], v[244:247], a[120:123], v[144:147]
    buffer_load_dwordx4 v23, s[24:27], s65 offen  lds
    v_mfma_f32_16x16x32_bf16 v[140:143], v[244:247], a[116:119], v[140:143]
    v_mfma_f32_16x16x32_bf16 v[136:139], v[244:247], a[112:115], v[136:139]
    s_waitcnt lgkmcnt(0)
    s_waitcnt vmcnt(11)
    v_mfma_f32_16x16x32_bf16 v[88:91], v[248:251], a[136:139], v[88:91]
    ds_read_b64_tr_b16 v[240:241], v24 offset:0
    v_mfma_f32_16x16x32_bf16 v[92:95], v[248:251], a[140:143], v[92:95]
    ds_read_b64_tr_b16 v[242:243], v24 offset:512
    v_mfma_f32_16x16x32_bf16 v[96:99], v[248:251], a[144:147], v[96:99]
    ds_read_b64_tr_b16 v[244:245], v24 offset:8
    v_mfma_f32_16x16x32_bf16 v[100:103], v[248:251], a[148:151], v[100:103]
    ds_read_b64_tr_b16 v[246:247], v24 offset:520
    v_mfma_f32_16x16x32_bf16 v[104:107], v[248:251], a[152:155], v[104:107]
    s_add_u32 s65, s68, 65536
    v_mfma_f32_16x16x32_bf16 v[108:111], v[248:251], a[156:159], v[108:111]
    s_add_u32 m0, s59, 30728
    v_mfma_f32_16x16x32_bf16 v[156:159], v[252:255], a[156:159], v[156:159]
    buffer_load_dwordx4 v22, s[24:27], s65 offen  lds
    v_mfma_f32_16x16x32_bf16 v[152:155], v[252:255], a[152:155], v[152:155]
    v_mfma_f32_16x16x32_bf16 v[148:151], v[252:255], a[148:151], v[148:151]
    s_add_u32 m0, s67, 6144
    v_mfma_f32_16x16x32_bf16 v[144:147], v[252:255], a[144:147], v[144:147]
    buffer_load_dwordx4 v23, s[24:27], s65 offen  lds
    v_mfma_f32_16x16x32_bf16 v[140:143], v[252:255], a[140:143], v[140:143]
    v_mfma_f32_16x16x32_bf16 v[136:139], v[252:255], a[136:139], v[136:139]
    s_waitcnt lgkmcnt(0)
    s_waitcnt vmcnt(11)
    v_mfma_f32_16x16x32_bf16 v[88:91], v[240:243], a[160:163], v[88:91]
    ds_read_b64_tr_b16 v[248:249], v24 offset:1024
    v_mfma_f32_16x16x32_bf16 v[92:95], v[240:243], a[164:167], v[92:95]
    ds_read_b64_tr_b16 v[250:251], v24 offset:1536
    v_mfma_f32_16x16x32_bf16 v[96:99], v[240:243], a[168:171], v[96:99]
    ds_read_b64_tr_b16 v[252:253], v24 offset:1032
    v_mfma_f32_16x16x32_bf16 v[100:103], v[240:243], a[172:175], v[100:103]
    ds_read_b64_tr_b16 v[254:255], v24 offset:1544
    v_mfma_f32_16x16x32_bf16 v[104:107], v[240:243], a[176:179], v[104:107]
    s_add_u32 s65, s68, 98304
    v_mfma_f32_16x16x32_bf16 v[108:111], v[240:243], a[180:183], v[108:111]
    s_add_u32 m0, s59, 24584
    v_mfma_f32_16x16x32_bf16 v[156:159], v[244:247], a[180:183], v[156:159]
    buffer_load_dwordx4 v22, s[24:27], s65 offen  lds
    v_mfma_f32_16x16x32_bf16 v[152:155], v[244:247], a[176:179], v[152:155]
    v_mfma_f32_16x16x32_bf16 v[148:151], v[244:247], a[172:175], v[148:151]
    s_add_u32 m0, s67, 0
    v_mfma_f32_16x16x32_bf16 v[144:147], v[244:247], a[168:171], v[144:147]
    buffer_load_dwordx4 v23, s[24:27], s65 offen  lds
    v_mfma_f32_16x16x32_bf16 v[140:143], v[244:247], a[164:167], v[140:143]
    v_mfma_f32_16x16x32_bf16 v[136:139], v[244:247], a[160:163], v[136:139]
    s_waitcnt lgkmcnt(0)
    s_waitcnt vmcnt(10)
    v_mfma_f32_16x16x32_bf16 v[88:91], v[248:251], a[184:187], v[88:91]
    ds_read_b64_tr_b16 v[240:241], v24 offset:2048
    v_mfma_f32_16x16x32_bf16 v[92:95], v[248:251], a[188:191], v[92:95]
    ds_read_b64_tr_b16 v[242:243], v24 offset:2560
    v_mfma_f32_16x16x32_bf16 v[96:99], v[248:251], a[192:195], v[96:99]
    ds_read_b64_tr_b16 v[244:245], v24 offset:2056
    v_mfma_f32_16x16x32_bf16 v[100:103], v[248:251], a[196:199], v[100:103]
    ds_read_b64_tr_b16 v[246:247], v24 offset:2568
    v_mfma_f32_16x16x32_bf16 v[104:107], v[248:251], a[200:203], v[104:107]
    s_add_u32 s65, s68, 131072
    v_mfma_f32_16x16x32_bf16 v[108:111], v[248:251], a[204:207], v[108:111]
    s_add_u32 m0, s59, 25608
    v_mfma_f32_16x16x32_bf16 v[156:159], v[252:255], a[204:207], v[156:159]
    buffer_load_dwordx4 v22, s[24:27], s65 offen  lds
    v_mfma_f32_16x16x32_bf16 v[152:155], v[252:255], a[200:203], v[152:155]
    v_mfma_f32_16x16x32_bf16 v[148:151], v[252:255], a[196:199], v[148:151]
    s_add_u32 m0, s67, 1024
    v_mfma_f32_16x16x32_bf16 v[144:147], v[252:255], a[192:195], v[144:147]
    buffer_load_dwordx4 v23, s[24:27], s65 offen  lds
    v_mfma_f32_16x16x32_bf16 v[140:143], v[252:255], a[188:191], v[140:143]
    v_mfma_f32_16x16x32_bf16 v[136:139], v[252:255], a[184:187], v[136:139]
    s_waitcnt lgkmcnt(0)
    s_waitcnt vmcnt(10)
    v_mfma_f32_16x16x32_bf16 v[88:91], v[240:243], a[208:211], v[88:91]
    ds_read_b64_tr_b16 v[248:249], v24 offset:3072
    v_mfma_f32_16x16x32_bf16 v[92:95], v[240:243], a[212:215], v[92:95]
    ds_read_b64_tr_b16 v[250:251], v24 offset:3584
    v_mfma_f32_16x16x32_bf16 v[96:99], v[240:243], a[216:219], v[96:99]
    ds_read_b64_tr_b16 v[252:253], v24 offset:3080
    v_mfma_f32_16x16x32_bf16 v[100:103], v[240:243], a[220:223], v[100:103]
    ds_read_b64_tr_b16 v[254:255], v24 offset:3592
    v_mfma_f32_16x16x32_bf16 v[104:107], v[240:243], a[224:227], v[104:107]
    s_add_u32 s65, s68, 163840
    v_mfma_f32_16x16x32_bf16 v[108:111], v[240:243], a[228:231], v[108:111]
    s_add_u32 m0, s59, 26632
    v_mfma_f32_16x16x32_bf16 v[156:159], v[244:247], a[228:231], v[156:159]
    buffer_load_dwordx4 v22, s[24:27], s65 offen  lds
    v_mfma_f32_16x16x32_bf16 v[152:155], v[244:247], a[224:227], v[152:155]
    v_mfma_f32_16x16x32_bf16 v[148:151], v[244:247], a[220:223], v[148:151]
    s_add_u32 m0, s67, 2048
    v_mfma_f32_16x16x32_bf16 v[144:147], v[244:247], a[216:219], v[144:147]
    buffer_load_dwordx4 v23, s[24:27], s65 offen  lds
    v_mfma_f32_16x16x32_bf16 v[140:143], v[244:247], a[212:215], v[140:143]
    v_mfma_f32_16x16x32_bf16 v[136:139], v[244:247], a[208:211], v[136:139]
    s_waitcnt lgkmcnt(0)
    s_waitcnt vmcnt(10)
    v_mfma_f32_16x16x32_bf16 v[88:91], v[248:251], a[232:235], v[88:91]
    ds_read_b64_tr_b16 v[240:241], v24 offset:4096
    v_mfma_f32_16x16x32_bf16 v[92:95], v[248:251], a[236:239], v[92:95]
    ds_read_b64_tr_b16 v[242:243], v24 offset:4608
    v_mfma_f32_16x16x32_bf16 v[96:99], v[248:251], a[240:243], v[96:99]
    ds_read_b64_tr_b16 v[244:245], v24 offset:4104
    v_mfma_f32_16x16x32_bf16 v[100:103], v[248:251], a[244:247], v[100:103]
    ds_read_b64_tr_b16 v[246:247], v24 offset:4616
    v_mfma_f32_16x16x32_bf16 v[104:107], v[248:251], a[248:251], v[104:107]
    s_add_u32 s65, s68, 196608
    v_mfma_f32_16x16x32_bf16 v[108:111], v[248:251], a[252:255], v[108:111]
    s_add_u32 m0, s59, 27656
    v_mfma_f32_16x16x32_bf16 v[156:159], v[252:255], a[252:255], v[156:159]
    buffer_load_dwordx4 v22, s[24:27], s65 offen  lds
    v_mfma_f32_16x16x32_bf16 v[152:155], v[252:255], a[248:251], v[152:155]
    v_mfma_f32_16x16x32_bf16 v[148:151], v[252:255], a[244:247], v[148:151]
    s_add_u32 m0, s67, 3072
    v_mfma_f32_16x16x32_bf16 v[144:147], v[252:255], a[240:243], v[144:147]
    buffer_load_dwordx4 v23, s[24:27], s65 offen  lds
    v_mfma_f32_16x16x32_bf16 v[140:143], v[252:255], a[236:239], v[140:143]
    v_mfma_f32_16x16x32_bf16 v[136:139], v[252:255], a[232:235], v[136:139]
    s_waitcnt lgkmcnt(0)
    s_add_u32 s69, s72, 1
    s_and_b32 s69, s69, 3
    s_mul_i32 s69, s69, 24576
    s_add_u32 s70, s69, 4096
    v_cvt_pk_bf16_f32 v108, v108, v109
    v_cvt_pk_bf16_f32 v109, v110, v111
    v_cvt_pk_bf16_f32 v110, v156, v157
    v_cvt_pk_bf16_f32 v111, v158, v159
    buffer_store_dwordx4 v[108:111], v28, s[28:31], s70 offen offset:1024 sc0 sc1
    v_cvt_pk_bf16_f32 v104, v104, v105
    v_cvt_pk_bf16_f32 v105, v106, v107
    v_cvt_pk_bf16_f32 v106, v152, v153
    v_cvt_pk_bf16_f32 v107, v154, v155
    buffer_store_dwordx4 v[104:107], v28, s[28:31], s70 offen offset:0 sc0 sc1
    v_cvt_pk_bf16_f32 v100, v100, v101
    v_cvt_pk_bf16_f32 v101, v102, v103
    v_cvt_pk_bf16_f32 v102, v148, v149
    v_cvt_pk_bf16_f32 v103, v150, v151
    buffer_store_dwordx4 v[100:103], v28, s[28:31], s69 offen offset:3072 sc0 sc1
    v_cvt_pk_bf16_f32 v96, v96, v97
    v_cvt_pk_bf16_f32 v97, v98, v99
    v_cvt_pk_bf16_f32 v98, v144, v145
    v_cvt_pk_bf16_f32 v99, v146, v147
    buffer_store_dwordx4 v[96:99], v28, s[28:31], s69 offen offset:2048 sc0 sc1
    v_cvt_pk_bf16_f32 v92, v92, v93
    v_cvt_pk_bf16_f32 v93, v94, v95
    v_cvt_pk_bf16_f32 v94, v140, v141
    v_cvt_pk_bf16_f32 v95, v142, v143
    buffer_store_dwordx4 v[92:95], v28, s[28:31], s69 offen offset:1024 sc0 sc1
    v_cvt_pk_bf16_f32 v88, v88, v89
    v_cvt_pk_bf16_f32 v89, v90, v91
    v_cvt_pk_bf16_f32 v90, v136, v137
    v_cvt_pk_bf16_f32 v91, v138, v139
    buffer_store_dwordx4 v[88:91], v28, s[28:31], s69 offen offset:0 sc0 sc1
    s_waitcnt vmcnt(16)
    s_nop 0
    v_mfma_f32_16x16x32_bf16 v[88:91], v[240:243], v[64:67], 0
    ds_read_b64_tr_b16 v[248:249], v24 offset:5120
    v_mfma_f32_16x16x32_bf16 v[92:95], v[240:243], v[68:71], 0
    ds_read_b64_tr_b16 v[250:251], v24 offset:5632
    v_mfma_f32_16x16x32_bf16 v[96:99], v[240:243], v[72:75], 0
    ds_read_b64_tr_b16 v[252:253], v24 offset:5128
    v_mfma_f32_16x16x32_bf16 v[100:103], v[240:243], v[76:79], 0
    ds_read_b64_tr_b16 v[254:255], v24 offset:5640
    v_mfma_f32_16x16x32_bf16 v[104:107], v[240:243], v[80:83], 0
    s_add_u32 s65, s68, 229376
    v_mfma_f32_16x16x32_bf16 v[108:111], v[240:243], v[84:87], 0
    s_add_u32 m0, s59, 28680
    v_mfma_f32_16x16x32_bf16 v[156:159], v[244:247], v[84:87], 0
    buffer_load_dwordx4 v22, s[24:27], s65 offen  lds
    v_mfma_f32_16x16x32_bf16 v[152:155], v[244:247], v[80:83], 0
    v_mfma_f32_16x16x32_bf16 v[148:151], v[244:247], v[76:79], 0
    s_add_u32 m0, s67, 4096
    v_mfma_f32_16x16x32_bf16 v[144:147], v[244:247], v[72:75], 0
    buffer_load_dwordx4 v23, s[24:27], s65 offen  lds
    v_mfma_f32_16x16x32_bf16 v[140:143], v[244:247], v[68:71], 0
    v_mfma_f32_16x16x32_bf16 v[136:139], v[244:247], v[64:67], 0
    s_waitcnt lgkmcnt(0)
    s_waitcnt vmcnt(16)
    v_mfma_f32_16x16x32_bf16 v[88:91], v[248:251], v[112:115], v[88:91]
    ds_read_b64_tr_b16 v[240:241], v24 offset:6144
    v_mfma_f32_16x16x32_bf16 v[92:95], v[248:251], v[116:119], v[92:95]
    ds_read_b64_tr_b16 v[242:243], v24 offset:6656
    v_mfma_f32_16x16x32_bf16 v[96:99], v[248:251], v[120:123], v[96:99]
    ds_read_b64_tr_b16 v[244:245], v24 offset:6152
    v_mfma_f32_16x16x32_bf16 v[100:103], v[248:251], v[124:127], v[100:103]
    ds_read_b64_tr_b16 v[246:247], v24 offset:6664
    v_mfma_f32_16x16x32_bf16 v[104:107], v[248:251], v[128:131], v[104:107]
    s_add_u32 s65, s68, 262144
    v_mfma_f32_16x16x32_bf16 v[108:111], v[248:251], v[132:135], v[108:111]
    s_add_u32 m0, s59, 29704
    v_mfma_f32_16x16x32_bf16 v[156:159], v[252:255], v[132:135], v[156:159]
    buffer_load_dwordx4 v22, s[24:27], s65 offen  lds
    v_mfma_f32_16x16x32_bf16 v[152:155], v[252:255], v[128:131], v[152:155]
    v_mfma_f32_16x16x32_bf16 v[148:151], v[252:255], v[124:127], v[148:151]
    s_add_u32 m0, s67, 5120
    v_mfma_f32_16x16x32_bf16 v[144:147], v[252:255], v[120:123], v[144:147]
    buffer_load_dwordx4 v23, s[24:27], s65 offen  lds
    v_mfma_f32_16x16x32_bf16 v[140:143], v[252:255], v[116:119], v[140:143]
    v_mfma_f32_16x16x32_bf16 v[136:139], v[252:255], v[112:115], v[136:139]
    s_waitcnt lgkmcnt(0)
    s_waitcnt vmcnt(16)
    v_mfma_f32_16x16x32_bf16 v[88:91], v[240:243], v[160:163], v[88:91]
    ds_read_b64_tr_b16 v[248:249], v24 offset:0
    v_mfma_f32_16x16x32_bf16 v[92:95], v[240:243], v[164:167], v[92:95]
    ds_read_b64_tr_b16 v[250:251], v24 offset:512
    v_mfma_f32_16x16x32_bf16 v[96:99], v[240:243], v[168:171], v[96:99]
    ds_read_b64_tr_b16 v[252:253], v24 offset:8
    v_mfma_f32_16x16x32_bf16 v[100:103], v[240:243], v[172:175], v[100:103]
    ds_read_b64_tr_b16 v[254:255], v24 offset:520
    v_mfma_f32_16x16x32_bf16 v[104:107], v[240:243], v[176:179], v[104:107]
    s_add_u32 s65, s68, 294912
    v_mfma_f32_16x16x32_bf16 v[108:111], v[240:243], v[180:183], v[108:111]
    s_add_u32 m0, s59, 30728
    v_mfma_f32_16x16x32_bf16 v[156:159], v[244:247], v[180:183], v[156:159]
    buffer_load_dwordx4 v22, s[24:27], s65 offen  lds
    v_mfma_f32_16x16x32_bf16 v[152:155], v[244:247], v[176:179], v[152:155]
    v_mfma_f32_16x16x32_bf16 v[148:151], v[244:247], v[172:175], v[148:151]
    s_add_u32 m0, s67, 6144
    v_mfma_f32_16x16x32_bf16 v[144:147], v[244:247], v[168:171], v[144:147]
    buffer_load_dwordx4 v23, s[24:27], s65 offen  lds
    v_mfma_f32_16x16x32_bf16 v[140:143], v[244:247], v[164:167], v[140:143]
    v_mfma_f32_16x16x32_bf16 v[136:139], v[244:247], v[160:163], v[136:139]
    s_waitcnt lgkmcnt(0)
    s_waitcnt vmcnt(16)
    v_mfma_f32_16x16x32_bf16 v[88:91], v[248:251], v[208:211], v[88:91]
    ds_read_b64_tr_b16 v[240:241], v24 offset:1024
    v_mfma_f32_16x16x32_bf16 v[92:95], v[248:251], v[212:215], v[92:95]
    ds_read_b64_tr_b16 v[242:243], v24 offset:1536
    v_mfma_f32_16x16x32_bf16 v[96:99], v[248:251], v[216:219], v[96:99]
    ds_read_b64_tr_b16 v[244:245], v24 offset:1032
    v_mfma_f32_16x16x32_bf16 v[100:103], v[248:251], v[220:223], v[100:103]
    ds_read_b64_tr_b16 v[246:247], v24 offset:1544
    v_mfma_f32_16x16x32_bf16 v[104:107], v[248:251], v[224:227], v[104:107]
    s_add_u32 s65, s68, 327680
    v_mfma_f32_16x16x32_bf16 v[108:111], v[248:251], v[228:231], v[108:111]
    s_add_u32 m0, s59, 24584
    v_mfma_f32_16x16x32_bf16 v[156:159], v[252:255], v[228:231], v[156:159]
    buffer_load_dwordx4 v22, s[24:27], s65 offen  lds
    v_mfma_f32_16x16x32_bf16 v[152:155], v[252:255], v[224:227], v[152:155]
    v_mfma_f32_16x16x32_bf16 v[148:151], v[252:255], v[220:223], v[148:151]
    s_add_u32 m0, s67, 0
    v_mfma_f32_16x16x32_bf16 v[144:147], v[252:255], v[216:219], v[144:147]
    buffer_load_dwordx4 v23, s[24:27], s65 offen  lds
    v_mfma_f32_16x16x32_bf16 v[140:143], v[252:255], v[212:215], v[140:143]
    v_mfma_f32_16x16x32_bf16 v[136:139], v[252:255], v[208:211], v[136:139]
    s_waitcnt lgkmcnt(0)
    s_waitcnt vmcnt(16)
    v_mfma_f32_16x16x32_bf16 v[88:91], v[240:243], v[184:187], v[88:91]
    ds_read_b64_tr_b16 v[248:249], v24 offset:2048
    v_mfma_f32_16x16x32_bf16 v[92:95], v[240:243], v[188:191], v[92:95]
    ds_read_b64_tr_b16 v[250:251], v24 offset:2560
    v_mfma_f32_16x16x32_bf16 v[96:99], v[240:243], v[192:195], v[96:99]
    ds_read_b64_tr_b16 v[252:253], v24 offset:2056
    v_mfma_f32_16x16x32_bf16 v[100:103], v[240:243], v[196:199], v[100:103]
    ds_read_b64_tr_b16 v[254:255], v24 offset:2568
    v_mfma_f32_16x16x32_bf16 v[104:107], v[240:243], v[200:203], v[104:107]
    s_add_u32 s65, s68, 360448
    v_mfma_f32_16x16x32_bf16 v[108:111], v[240:243], v[204:207], v[108:111]
    s_add_u32 m0, s59, 25608
    v_mfma_f32_16x16x32_bf16 v[156:159], v[244:247], v[204:207], v[156:159]
    buffer_load_dwordx4 v22, s[24:27], s65 offen  lds
    v_mfma_f32_16x16x32_bf16 v[152:155], v[244:247], v[200:203], v[152:155]
    v_mfma_f32_16x16x32_bf16 v[148:151], v[244:247], v[196:199], v[148:151]
    s_add_u32 m0, s67, 1024
    v_mfma_f32_16x16x32_bf16 v[144:147], v[244:247], v[192:195], v[144:147]
    buffer_load_dwordx4 v23, s[24:27], s65 offen  lds
    v_mfma_f32_16x16x32_bf16 v[140:143], v[244:247], v[188:191], v[140:143]
    v_mfma_f32_16x16x32_bf16 v[136:139], v[244:247], v[184:187], v[136:139]
    s_waitcnt lgkmcnt(0)
    s_waitcnt vmcnt(16)
    v_mfma_f32_16x16x32_bf16 v[88:91], v[248:251], v[232:235], v[88:91]
    ds_read_b64_tr_b16 v[240:241], v24 offset:3072
    v_mfma_f32_16x16x32_bf16 v[92:95], v[248:251], v[236:239], v[92:95]
    ds_read_b64_tr_b16 v[242:243], v24 offset:3584
    v_mfma_f32_16x16x32_bf16 v[96:99], v[248:251], a[0:3], v[96:99]
    ds_read_b64_tr_b16 v[244:245], v24 offset:3080
    v_mfma_f32_16x16x32_bf16 v[100:103], v[248:251], a[4:7], v[100:103]
    ds_read_b64_tr_b16 v[246:247], v24 offset:3592
    v_mfma_f32_16x16x32_bf16 v[104:107], v[248:251], a[8:11], v[104:107]
    s_add_u32 s65, s68, 393216
    v_mfma_f32_16x16x32_bf16 v[108:111], v[248:251], a[12:15], v[108:111]
    s_add_u32 m0, s59, 26632
    v_mfma_f32_16x16x32_bf16 v[156:159], v[252:255], a[12:15], v[156:159]
    buffer_load_dwordx4 v22, s[24:27], s65 offen  lds
    v_mfma_f32_16x16x32_bf16 v[152:155], v[252:255], a[8:11], v[152:155]
    v_mfma_f32_16x16x32_bf16 v[148:151], v[252:255], a[4:7], v[148:151]
    s_add_u32 m0, s67, 2048
    v_mfma_f32_16x16x32_bf16 v[144:147], v[252:255], a[0:3], v[144:147]
    buffer_load_dwordx4 v23, s[24:27], s65 offen  lds
    v_mfma_f32_16x16x32_bf16 v[140:143], v[252:255], v[236:239], v[140:143]
    v_mfma_f32_16x16x32_bf16 v[136:139], v[252:255], v[232:235], v[136:139]
    s_waitcnt lgkmcnt(0)
    s_waitcnt vmcnt(10)
    v_mfma_f32_16x16x32_bf16 v[88:91], v[240:243], a[16:19], v[88:91]
    ds_read_b64_tr_b16 v[248:249], v24 offset:4096
    v_mfma_f32_16x16x32_bf16 v[92:95], v[240:243], a[20:23], v[92:95]
    ds_read_b64_tr_b16 v[250:251], v24 offset:4608
    v_mfma_f32_16x16x32_bf16 v[96:99], v[240:243], a[24:27], v[96:99]
    ds_read_b64_tr_b16 v[252:253], v24 offset:4104
    v_mfma_f32_16x16x32_bf16 v[100:103], v[240:243], a[28:31], v[100:103]
    ds_read_b64_tr_b16 v[254:255], v24 offset:4616
    v_mfma_f32_16x16x32_bf16 v[104:107], v[240:243], a[32:35], v[104:107]
    s_add_u32 s65, s68, 425984
    v_mfma_f32_16x16x32_bf16 v[108:111], v[240:243], a[36:39], v[108:111]
    s_add_u32 m0, s59, 27656
    v_mfma_f32_16x16x32_bf16 v[156:159], v[244:247], a[36:39], v[156:159]
    buffer_load_dwordx4 v22, s[24:27], s65 offen  lds
    v_mfma_f32_16x16x32_bf16 v[152:155], v[244:247], a[32:35], v[152:155]
    v_mfma_f32_16x16x32_bf16 v[148:151], v[244:247], a[28:31], v[148:151]
    s_add_u32 m0, s67, 3072
    v_mfma_f32_16x16x32_bf16 v[144:147], v[244:247], a[24:27], v[144:147]
    buffer_load_dwordx4 v23, s[24:27], s65 offen  lds
    v_mfma_f32_16x16x32_bf16 v[140:143], v[244:247], a[20:23], v[140:143]
    v_mfma_f32_16x16x32_bf16 v[136:139], v[244:247], a[16:19], v[136:139]
    s_waitcnt lgkmcnt(0)
    s_waitcnt vmcnt(10)
    v_mfma_f32_16x16x32_bf16 v[88:91], v[248:251], a[40:43], v[88:91]
    ds_read_b64_tr_b16 v[240:241], v24 offset:5120
    v_mfma_f32_16x16x32_bf16 v[92:95], v[248:251], a[44:47], v[92:95]
    ds_read_b64_tr_b16 v[242:243], v24 offset:5632
    v_mfma_f32_16x16x32_bf16 v[96:99], v[248:251], a[48:51], v[96:99]
    ds_read_b64_tr_b16 v[244:245], v24 offset:5128
    v_mfma_f32_16x16x32_bf16 v[100:103], v[248:251], a[52:55], v[100:103]
    ds_read_b64_tr_b16 v[246:247], v24 offset:5640
    v_mfma_f32_16x16x32_bf16 v[104:107], v[248:251], a[56:59], v[104:107]
    s_add_u32 s65, s68, 458752
    v_mfma_f32_16x16x32_bf16 v[108:111], v[248:251], a[60:63], v[108:111]
    s_add_u32 m0, s59, 28680
    v_mfma_f32_16x16x32_bf16 v[156:159], v[252:255], a[60:63], v[156:159]
    buffer_load_dwordx4 v22, s[24:27], s65 offen  lds
    s_mov_b32 s64, 512
    buffer_store_dword v3, v25, s[28:31], s64 offen sc1
    v_mfma_f32_16x16x32_bf16 v[152:155], v[252:255], a[56:59], v[152:155]
    v_mfma_f32_16x16x32_bf16 v[148:151], v[252:255], a[52:55], v[148:151]
    s_add_u32 m0, s67, 4096
    v_mfma_f32_16x16x32_bf16 v[144:147], v[252:255], a[48:51], v[144:147]
    buffer_load_dwordx4 v23, s[24:27], s65 offen  lds
    v_mfma_f32_16x16x32_bf16 v[140:143], v[252:255], a[44:47], v[140:143]
    v_mfma_f32_16x16x32_bf16 v[136:139], v[252:255], a[40:43], v[136:139]
    s_waitcnt lgkmcnt(0)
    s_waitcnt vmcnt(11)
    v_mfma_f32_16x16x32_bf16 v[88:91], v[240:243], a[64:67], v[88:91]
    ds_read_b64_tr_b16 v[248:249], v24 offset:6144
    v_mfma_f32_16x16x32_bf16 v[92:95], v[240:243], a[68:71], v[92:95]
    ds_read_b64_tr_b16 v[250:251], v24 offset:6656
    v_mfma_f32_16x16x32_bf16 v[96:99], v[240:243], a[72:75], v[96:99]
    ds_read_b64_tr_b16 v[252:253], v24 offset:6152
    v_mfma_f32_16x16x32_bf16 v[100:103], v[240:243], a[76:79], v[100:103]
    ds_read_b64_tr_b16 v[254:255], v24 offset:6664
    v_mfma_f32_16x16x32_bf16 v[104:107], v[240:243], a[80:83], v[104:107]
    s_add_u32 s65, s68, 491520
    v_mfma_f32_16x16x32_bf16 v[108:111], v[240:243], a[84:87], v[108:111]
    s_add_u32 m0, s59, 29704
    v_mfma_f32_16x16x32_bf16 v[156:159], v[244:247], a[84:87], v[156:159]
    buffer_load_dwordx4 v22, s[24:27], s65 offen  lds
    v_mfma_f32_16x16x32_bf16 v[152:155], v[244:247], a[80:83], v[152:155]
    v_mfma_f32_16x16x32_bf16 v[148:151], v[244:247], a[76:79], v[148:151]
    s_add_u32 m0, s67, 5120
    v_mfma_f32_16x16x32_bf16 v[144:147], v[244:247], a[72:75], v[144:147]
    buffer_load_dwordx4 v23, s[24:27], s65 offen  lds
    v_mfma_f32_16x16x32_bf16 v[140:143], v[244:247], a[68:71], v[140:143]
    v_mfma_f32_16x16x32_bf16 v[136:139], v[244:247], a[64:67], v[136:139]
    s_waitcnt lgkmcnt(0)
    s_waitcnt vmcnt(11)
    v_mfma_f32_16x16x32_bf16 v[88:91], v[248:251], a[88:91], v[88:91]
    ds_read_b64_tr_b16 v[240:241], v24 offset:0
    v_mfma_f32_16x16x32_bf16 v[92:95], v[248:251], a[92:95], v[92:95]
    ds_read_b64_tr_b16 v[242:243], v24 offset:512
    v_mfma_f32_16x16x32_bf16 v[96:99], v[248:251], a[96:99], v[96:99]
    ds_read_b64_tr_b16 v[244:245], v24 offset:8
    v_mfma_f32_16x16x32_bf16 v[100:103], v[248:251], a[100:103], v[100:103]
    ds_read_b64_tr_b16 v[246:247], v24 offset:520
    v_mfma_f32_16x16x32_bf16 v[104:107], v[248:251], a[104:107], v[104:107]
    s_add_u32 s68, s72, 3
    s_and_b32 s68, s68, 3
    s_lshl_b32 s68, s68, 8
    s_add_u32 s65, s68, 0
    v_mfma_f32_16x16x32_bf16 v[108:111], v[248:251], a[108:111], v[108:111]
    s_add_u32 m0, s59, 30728
    v_mfma_f32_16x16x32_bf16 v[156:159], v[252:255], a[108:111], v[156:159]
    buffer_load_dwordx4 v22, s[24:27], s65 offen  lds
    v_mfma_f32_16x16x32_bf16 v[152:155], v[252:255], a[104:107], v[152:155]
    v_mfma_f32_16x16x32_bf16 v[148:151], v[252:255], a[100:103], v[148:151]
    s_add_u32 m0, s67, 6144
    v_mfma_f32_16x16x32_bf16 v[144:147], v[252:255], a[96:99], v[144:147]
    buffer_load_dwordx4 v23, s[24:27], s65 offen  lds
    v_mfma_f32_16x16x32_bf16 v[140:143], v[252:255], a[92:95], v[140:143]
    v_mfma_f32_16x16x32_bf16 v[136:139], v[252:255], a[88:91], v[136:139]
    s_waitcnt lgkmcnt(0)
    s_waitcnt vmcnt(11)
    v_mfma_f32_16x16x32_bf16 v[88:91], v[240:243], a[112:115], v[88:91]
    ds_read_b64_tr_b16 v[248:249], v24 offset:1024
    v_mfma_f32_16x16x32_bf16 v[92:95], v[240:243], a[116:119], v[92:95]
    ds_read_b64_tr_b16 v[250:251], v24 offset:1536
    v_mfma_f32_16x16x32_bf16 v[96:99], v[240:243], a[120:123], v[96:99]
    ds_read_b64_tr_b16 v[252:253], v24 offset:1032
    v_mfma_f32_16x16x32_bf16 v[100:103], v[240:243], a[124:127], v[100:103]
    ds_read_b64_tr_b16 v[254:255], v24 offset:1544
    v_mfma_f32_16x16x32_bf16 v[104:107], v[240:243], a[128:131], v[104:107]
    s_add_u32 s65, s68, 32768
    v_mfma_f32_16x16x32_bf16 v[108:111], v[240:243], a[132:135], v[108:111]
    s_add_u32 m0, s59, 24584
    v_mfma_f32_16x16x32_bf16 v[156:159], v[244:247], a[132:135], v[156:159]
    buffer_load_dwordx4 v22, s[24:27], s65 offen  lds
    v_mfma_f32_16x16x32_bf16 v[152:155], v[244:247], a[128:131], v[152:155]
    v_mfma_f32_16x16x32_bf16 v[148:151], v[244:247], a[124:127], v[148:151]
    s_add_u32 m0, s67, 0
    v_mfma_f32_16x16x32_bf16 v[144:147], v[244:247], a[120:123], v[144:147]
    buffer_load_dwordx4 v23, s[24:27], s65 offen  lds
    v_mfma_f32_16x16x32_bf16 v[140:143], v[244:247], a[116:119], v[140:143]
    v_mfma_f32_16x16x32_bf16 v[136:139], v[244:247], a[112:115], v[136:139]
    s_waitcnt lgkmcnt(0)
    s_waitcnt vmcnt(11)
    v_mfma_f32_16x16x32_bf16 v[88:91], v[248:251], a[136:139], v[88:91]
    ds_read_b64_tr_b16 v[240:241], v24 offset:2048
    v_mfma_f32_16x16x32_bf16 v[92:95], v[248:251], a[140:143], v[92:95]
    ds_read_b64_tr_b16 v[242:243], v24 offset:2560
    v_mfma_f32_16x16x32_bf16 v[96:99], v[248:251], a[144:147], v[96:99]
    ds_read_b64_tr_b16 v[244:245], v24 offset:2056
    v_mfma_f32_16x16x32_bf16 v[100:103], v[248:251], a[148:151], v[100:103]
    ds_read_b64_tr_b16 v[246:247], v24 offset:2568
    v_mfma_f32_16x16x32_bf16 v[104:107], v[248:251], a[152:155], v[104:107]
    s_add_u32 s65, s68, 65536
    v_mfma_f32_16x16x32_bf16 v[108:111], v[248:251], a[156:159], v[108:111]
    s_add_u32 m0, s59, 25608
    v_mfma_f32_16x16x32_bf16 v[156:159], v[252:255], a[156:159], v[156:159]
    buffer_load_dwordx4 v22, s[24:27], s65 offen  lds
    v_mfma_f32_16x16x32_bf16 v[152:155], v[252:255], a[152:155], v[152:155]
    v_mfma_f32_16x16x32_bf16 v[148:151], v[252:255], a[148:151], v[148:151]
    s_add_u32 m0, s67, 1024
    v_mfma_f32_16x16x32_bf16 v[144:147], v[252:255], a[144:147], v[144:147]
    buffer_load_dwordx4 v23, s[24:27], s65 offen  lds
    v_mfma_f32_16x16x32_bf16 v[140:143], v[252:255], a[140:143], v[140:143]
    v_mfma_f32_16x16x32_bf16 v[136:139], v[252:255], a[136:139], v[136:139]
    s_waitcnt lgkmcnt(0)
    s_waitcnt vmcnt(11)
    v_mfma_f32_16x16x32_bf16 v[88:91], v[240:243], a[160:163], v[88:91]
    ds_read_b64_tr_b16 v[248:249], v24 offset:3072
    v_mfma_f32_16x16x32_bf16 v[92:95], v[240:243], a[164:167], v[92:95]
    ds_read_b64_tr_b16 v[250:251], v24 offset:3584
    v_mfma_f32_16x16x32_bf16 v[96:99], v[240:243], a[168:171], v[96:99]
    ds_read_b64_tr_b16 v[252:253], v24 offset:3080
    v_mfma_f32_16x16x32_bf16 v[100:103], v[240:243], a[172:175], v[100:103]
    ds_read_b64_tr_b16 v[254:255], v24 offset:3592
    v_mfma_f32_16x16x32_bf16 v[104:107], v[240:243], a[176:179], v[104:107]
    s_add_u32 s65, s68, 98304
    v_mfma_f32_16x16x32_bf16 v[108:111], v[240:243], a[180:183], v[108:111]
    s_add_u32 m0, s59, 26632
    v_mfma_f32_16x16x32_bf16 v[156:159], v[244:247], a[180:183], v[156:159]
    buffer_load_dwordx4 v22, s[24:27], s65 offen  lds
    v_mfma_f32_16x16x32_bf16 v[152:155], v[244:247], a[176:179], v[152:155]
    v_mfma_f32_16x16x32_bf16 v[148:151], v[244:247], a[172:175], v[148:151]
    s_add_u32 m0, s67, 2048
    v_mfma_f32_16x16x32_bf16 v[144:147], v[244:247], a[168:171], v[144:147]
    buffer_load_dwordx4 v23, s[24:27], s65 offen  lds
    v_mfma_f32_16x16x32_bf16 v[140:143], v[244:247], a[164:167], v[140:143]
    v_mfma_f32_16x16x32_bf16 v[136:139], v[244:247], a[160:163], v[136:139]
    s_waitcnt lgkmcnt(0)
    s_waitcnt vmcnt(10)
    v_mfma_f32_16x16x32_bf16 v[88:91], v[248:251], a[184:187], v[88:91]
    ds_read_b64_tr_b16 v[240:241], v24 offset:4096
    v_mfma_f32_16x16x32_bf16 v[92:95], v[248:251], a[188:191], v[92:95]
    ds_read_b64_tr_b16 v[242:243], v24 offset:4608
    v_mfma_f32_16x16x32_bf16 v[96:99], v[248:251], a[192:195], v[96:99]
    ds_read_b64_tr_b16 v[244:245], v24 offset:4104
    v_mfma_f32_16x16x32_bf16 v[100:103], v[248:251], a[196:199], v[100:103]
    ds_read_b64_tr_b16 v[246:247], v24 offset:4616
    v_mfma_f32_16x16x32_bf16 v[104:107], v[248:251], a[200:203], v[104:107]
    s_add_u32 s65, s68, 131072
    v_mfma_f32_16x16x32_bf16 v[108:111], v[248:251], a[204:207], v[108:111]
    s_add_u32 m0, s59, 27656
    v_mfma_f32_16x16x32_bf16 v[156:159], v[252:255], a[204:207], v[156:159]
    buffer_load_dwordx4 v22, s[24:27], s65 offen  lds
    v_mfma_f32_16x16x32_bf16 v[152:155], v[252:255], a[200:203], v[152:155]
    v_mfma_f32_16x16x32_bf16 v[148:151], v[252:255], a[196:199], v[148:151]
    s_add_u32 m0, s67, 3072
    v_mfma_f32_16x16x32_bf16 v[144:147], v[252:255], a[192:195], v[144:147]
    buffer_load_dwordx4 v23, s[24:27], s65 offen  lds
    v_mfma_f32_16x16x32_bf16 v[140:143], v[252:255], a[188:191], v[140:143]
    v_mfma_f32_16x16x32_bf16 v[136:139], v[252:255], a[184:187], v[136:139]
    s_waitcnt lgkmcnt(0)
    s_waitcnt vmcnt(10)
    v_mfma_f32_16x16x32_bf16 v[88:91], v[240:243], a[208:211], v[88:91]
    ds_read_b64_tr_b16 v[248:249], v24 offset:5120
    v_mfma_f32_16x16x32_bf16 v[92:95], v[240:243], a[212:215], v[92:95]
    ds_read_b64_tr_b16 v[250:251], v24 offset:5632
    v_mfma_f32_16x16x32_bf16 v[96:99], v[240:243], a[216:219], v[96:99]
    ds_read_b64_tr_b16 v[252:253], v24 offset:5128
    v_mfma_f32_16x16x32_bf16 v[100:103], v[240:243], a[220:223], v[100:103]
    ds_read_b64_tr_b16 v[254:255], v24 offset:5640
    v_mfma_f32_16x16x32_bf16 v[104:107], v[240:243], a[224:227], v[104:107]
    s_add_u32 s65, s68, 163840
    v_mfma_f32_16x16x32_bf16 v[108:111], v[240:243], a[228:231], v[108:111]
    s_add_u32 m0, s59, 28680
    v_mfma_f32_16x16x32_bf16 v[156:159], v[244:247], a[228:231], v[156:159]
    buffer_load_dwordx4 v22, s[24:27], s65 offen  lds
    v_mfma_f32_16x16x32_bf16 v[152:155], v[244:247], a[224:227], v[152:155]
    v_mfma_f32_16x16x32_bf16 v[148:151], v[244:247], a[220:223], v[148:151]
    s_add_u32 m0, s67, 4096
    v_mfma_f32_16x16x32_bf16 v[144:147], v[244:247], a[216:219], v[144:147]
    buffer_load_dwordx4 v23, s[24:27], s65 offen  lds
    v_mfma_f32_16x16x32_bf16 v[140:143], v[244:247], a[212:215], v[140:143]
    v_mfma_f32_16x16x32_bf16 v[136:139], v[244:247], a[208:211], v[136:139]
    s_waitcnt lgkmcnt(0)
    s_waitcnt vmcnt(10)
    v_mfma_f32_16x16x32_bf16 v[88:91], v[248:251], a[232:235], v[88:91]
    ds_read_b64_tr_b16 v[240:241], v24 offset:6144
    v_mfma_f32_16x16x32_bf16 v[92:95], v[248:251], a[236:239], v[92:95]
    ds_read_b64_tr_b16 v[242:243], v24 offset:6656
    v_mfma_f32_16x16x32_bf16 v[96:99], v[248:251], a[240:243], v[96:99]
    ds_read_b64_tr_b16 v[244:245], v24 offset:6152
    v_mfma_f32_16x16x32_bf16 v[100:103], v[248:251], a[244:247], v[100:103]
    ds_read_b64_tr_b16 v[246:247], v24 offset:6664
    v_mfma_f32_16x16x32_bf16 v[104:107], v[248:251], a[248:251], v[104:107]
    s_add_u32 s65, s68, 196608
    v_mfma_f32_16x16x32_bf16 v[108:111], v[248:251], a[252:255], v[108:111]
    s_add_u32 m0, s59, 29704
    v_mfma_f32_16x16x32_bf16 v[156:159], v[252:255], a[252:255], v[156:159]
    buffer_load_dwordx4 v22, s[24:27], s65 offen  lds
    v_mfma_f32_16x16x32_bf16 v[152:155], v[252:255], a[248:251], v[152:155]
    v_mfma_f32_16x16x32_bf16 v[148:151], v[252:255], a[244:247], v[148:151]
    s_add_u32 m0, s67, 5120
    v_mfma_f32_16x16x32_bf16 v[144:147], v[252:255], a[240:243], v[144:147]
    buffer_load_dwordx4 v23, s[24:27], s65 offen  lds
    v_mfma_f32_16x16x32_bf16 v[140:143], v[252:255], a[236:239], v[140:143]
    v_mfma_f32_16x16x32_bf16 v[136:139], v[252:255], a[232:235], v[136:139]
    s_waitcnt lgkmcnt(0)
    s_add_u32 s69, s72, 2
    s_and_b32 s69, s69, 3
    s_mul_i32 s69, s69, 24576
    s_add_u32 s70, s69, 4096
    v_cvt_pk_bf16_f32 v108, v108, v109
    v_cvt_pk_bf16_f32 v109, v110, v111
    v_cvt_pk_bf16_f32 v110, v156, v157
    v_cvt_pk_bf16_f32 v111, v158, v159
    buffer_store_dwordx4 v[108:111], v28, s[28:31], s70 offen offset:1024 sc0 sc1
    v_cvt_pk_bf16_f32 v104, v104, v105
    v_cvt_pk_bf16_f32 v105, v106, v107
    v_cvt_pk_bf16_f32 v106, v152, v153
    v_cvt_pk_bf16_f32 v107, v154, v155
    buffer_store_dwordx4 v[104:107], v28, s[28:31], s70 offen offset:0 sc0 sc1
    v_cvt_pk_bf16_f32 v100, v100, v101
    v_cvt_pk_bf16_f32 v101, v102, v103
    v_cvt_pk_bf16_f32 v102, v148, v149
    v_cvt_pk_bf16_f32 v103, v150, v151
    buffer_store_dwordx4 v[100:103], v28, s[28:31], s69 offen offset:3072 sc0 sc1
    v_cvt_pk_bf16_f32 v96, v96, v97
    v_cvt_pk_bf16_f32 v97, v98, v99
    v_cvt_pk_bf16_f32 v98, v144, v145
    v_cvt_pk_bf16_f32 v99, v146, v147
    buffer_store_dwordx4 v[96:99], v28, s[28:31], s69 offen offset:2048 sc0 sc1
    v_cvt_pk_bf16_f32 v92, v92, v93
    v_cvt_pk_bf16_f32 v93, v94, v95
    v_cvt_pk_bf16_f32 v94, v140, v141
    v_cvt_pk_bf16_f32 v95, v142, v143
    buffer_store_dwordx4 v[92:95], v28, s[28:31], s69 offen offset:1024 sc0 sc1
    v_cvt_pk_bf16_f32 v88, v88, v89
    v_cvt_pk_bf16_f32 v89, v90, v91
    v_cvt_pk_bf16_f32 v90, v136, v137
    v_cvt_pk_bf16_f32 v91, v138, v139
    buffer_store_dwordx4 v[88:91], v28, s[28:31], s69 offen offset:0 sc0 sc1
    s_waitcnt vmcnt(16)
    s_nop 0
    v_mfma_f32_16x16x32_bf16 v[88:91], v[240:243], v[64:67], 0
    ds_read_b64_tr_b16 v[248:249], v24 offset:0
    v_mfma_f32_16x16x32_bf16 v[92:95], v[240:243], v[68:71], 0
    ds_read_b64_tr_b16 v[250:251], v24 offset:512
    v_mfma_f32_16x16x32_bf16 v[96:99], v[240:243], v[72:75], 0
    ds_read_b64_tr_b16 v[252:253], v24 offset:8
    v_mfma_f32_16x16x32_bf16 v[100:103], v[240:243], v[76:79], 0
    ds_read_b64_tr_b16 v[254:255], v24 offset:520
    v_mfma_f32_16x16x32_bf16 v[104:107], v[240:243], v[80:83], 0
    s_add_u32 s65, s68, 229376
    v_mfma_f32_16x16x32_bf16 v[108:111], v[240:243], v[84:87], 0
    s_add_u32 m0, s59, 30728
    v_mfma_f32_16x16x32_bf16 v[156:159], v[244:247], v[84:87], 0
    buffer_load_dwordx4 v22, s[24:27], s65 offen  lds
    v_mfma_f32_16x16x32_bf16 v[152:155], v[244:247], v[80:83], 0
    v_mfma_f32_16x16x32_bf16 v[148:151], v[244:247], v[76:79], 0
    s_add_u32 m0, s67, 6144
    v_mfma_f32_16x16x32_bf16 v[144:147], v[244:247], v[72:75], 0
    buffer_load_dwordx4 v23, s[24:27], s65 offen  lds
    v_mfma_f32_16x16x32_bf16 v[140:143], v[244:247], v[68:71], 0
    v_mfma_f32_16x16x32_bf16 v[136:139], v[244:247], v[64:67], 0
    s_waitcnt lgkmcnt(0)
    s_waitcnt vmcnt(16)
    v_mfma_f32_16x16x32_bf16 v[88:91], v[248:251], v[112:115], v[88:91]
    ds_read_b64_tr_b16 v[240:241], v24 offset:1024
    v_mfma_f32_16x16x32_bf16 v[92:95], v[248:251], v[116:119], v[92:95]
    ds_read_b64_tr_b16 v[242:243], v24 offset:1536
    v_mfma_f32_16x16x32_bf16 v[96:99], v[248:251], v[120:123], v[96:99]
    ds_read_b64_tr_b16 v[244:245], v24 offset:1032
    v_mfma_f32_16x16x32_bf16 v[100:103], v[248:251], v[124:127], v[100:103]
    ds_read_b64_tr_b16 v[246:247], v24 offset:1544
    v_mfma_f32_16x16x32_bf16 v[104:107], v[248:251], v[128:131], v[104:107]
    s_add_u32 s65, s68, 262144
    v_mfma_f32_16x16x32_bf16 v[108:111], v[248:251], v[132:135], v[108:111]
    s_add_u32 m0, s59, 24584
    v_mfma_f32_16x16x32_bf16 v[156:159], v[252:255], v[132:135], v[156:159]
    buffer_load_dwordx4 v22, s[24:27], s65 offen  lds
    v_mfma_f32_16x16x32_bf16 v[152:155], v[252:255], v[128:131], v[152:155]
    v_mfma_f32_16x16x32_bf16 v[148:151], v[252:255], v[124:127], v[148:151]
    s_add_u32 m0, s67, 0
    v_mfma_f32_16x16x32_bf16 v[144:147], v[252:255], v[120:123], v[144:147]
    buffer_load_dwordx4 v23, s[24:27], s65 offen  lds
    v_mfma_f32_16x16x32_bf16 v[140:143], v[252:255], v[116:119], v[140:143]
    v_mfma_f32_16x16x32_bf16 v[136:139], v[252:255], v[112:115], v[136:139]
    s_waitcnt lgkmcnt(0)
    s_waitcnt vmcnt(16)
    v_mfma_f32_16x16x32_bf16 v[88:91], v[240:243], v[160:163], v[88:91]
    ds_read_b64_tr_b16 v[248:249], v24 offset:2048
    v_mfma_f32_16x16x32_bf16 v[92:95], v[240:243], v[164:167], v[92:95]
    ds_read_b64_tr_b16 v[250:251], v24 offset:2560
    v_mfma_f32_16x16x32_bf16 v[96:99], v[240:243], v[168:171], v[96:99]
    ds_read_b64_tr_b16 v[252:253], v24 offset:2056
    v_mfma_f32_16x16x32_bf16 v[100:103], v[240:243], v[172:175], v[100:103]
    ds_read_b64_tr_b16 v[254:255], v24 offset:2568
    v_mfma_f32_16x16x32_bf16 v[104:107], v[240:243], v[176:179], v[104:107]
    s_add_u32 s65, s68, 294912
    v_mfma_f32_16x16x32_bf16 v[108:111], v[240:243], v[180:183], v[108:111]
    s_add_u32 m0, s59, 25608
    v_mfma_f32_16x16x32_bf16 v[156:159], v[244:247], v[180:183], v[156:159]
    buffer_load_dwordx4 v22, s[24:27], s65 offen  lds
    v_mfma_f32_16x16x32_bf16 v[152:155], v[244:247], v[176:179], v[152:155]
    v_mfma_f32_16x16x32_bf16 v[148:151], v[244:247], v[172:175], v[148:151]
    s_add_u32 m0, s67, 1024
    v_mfma_f32_16x16x32_bf16 v[144:147], v[244:247], v[168:171], v[144:147]
    buffer_load_dwordx4 v23, s[24:27], s65 offen  lds
    v_mfma_f32_16x16x32_bf16 v[140:143], v[244:247], v[164:167], v[140:143]
    v_mfma_f32_16x16x32_bf16 v[136:139], v[244:247], v[160:163], v[136:139]
    s_waitcnt lgkmcnt(0)
    s_waitcnt vmcnt(16)
    v_mfma_f32_16x16x32_bf16 v[88:91], v[248:251], v[208:211], v[88:91]
    ds_read_b64_tr_b16 v[240:241], v24 offset:3072
    v_mfma_f32_16x16x32_bf16 v[92:95], v[248:251], v[212:215], v[92:95]
    ds_read_b64_tr_b16 v[242:243], v24 offset:3584
    v_mfma_f32_16x16x32_bf16 v[96:99], v[248:251], v[216:219], v[96:99]
    ds_read_b64_tr_b16 v[244:245], v24 offset:3080
    v_mfma_f32_16x16x32_bf16 v[100:103], v[248:251], v[220:223], v[100:103]
    ds_read_b64_tr_b16 v[246:247], v24 offset:3592
    v_mfma_f32_16x16x32_bf16 v[104:107], v[248:251], v[224:227], v[104:107]
    s_add_u32 s65, s68, 327680
    v_mfma_f32_16x16x32_bf16 v[108:111], v[248:251], v[228:231], v[108:111]
    s_add_u32 m0, s59, 26632
    v_mfma_f32_16x16x32_bf16 v[156:159], v[252:255], v[228:231], v[156:159]
    buffer_load_dwordx4 v22, s[24:27], s65 offen  lds
    v_mfma_f32_16x16x32_bf16 v[152:155], v[252:255], v[224:227], v[152:155]
    v_mfma_f32_16x16x32_bf16 v[148:151], v[252:255], v[220:223], v[148:151]
    s_add_u32 m0, s67, 2048
    v_mfma_f32_16x16x32_bf16 v[144:147], v[252:255], v[216:219], v[144:147]
    buffer_load_dwordx4 v23, s[24:27], s65 offen  lds
    v_mfma_f32_16x16x32_bf16 v[140:143], v[252:255], v[212:215], v[140:143]
    v_mfma_f32_16x16x32_bf16 v[136:139], v[252:255], v[208:211], v[136:139]
    s_waitcnt lgkmcnt(0)
    s_waitcnt vmcnt(16)
    v_mfma_f32_16x16x32_bf16 v[88:91], v[240:243], v[184:187], v[88:91]
    ds_read_b64_tr_b16 v[248:249], v24 offset:4096
    v_mfma_f32_16x16x32_bf16 v[92:95], v[240:243], v[188:191], v[92:95]
    ds_read_b64_tr_b16 v[250:251], v24 offset:4608
    v_mfma_f32_16x16x32_bf16 v[96:99], v[240:243], v[192:195], v[96:99]
    ds_read_b64_tr_b16 v[252:253], v24 offset:4104
    v_mfma_f32_16x16x32_bf16 v[100:103], v[240:243], v[196:199], v[100:103]
    ds_read_b64_tr_b16 v[254:255], v24 offset:4616
    v_mfma_f32_16x16x32_bf16 v[104:107], v[240:243], v[200:203], v[104:107]
    s_add_u32 s65, s68, 360448
    v_mfma_f32_16x16x32_bf16 v[108:111], v[240:243], v[204:207], v[108:111]
    s_add_u32 m0, s59, 27656
    v_mfma_f32_16x16x32_bf16 v[156:159], v[244:247], v[204:207], v[156:159]
    buffer_load_dwordx4 v22, s[24:27], s65 offen  lds
    v_mfma_f32_16x16x32_bf16 v[152:155], v[244:247], v[200:203], v[152:155]
    v_mfma_f32_16x16x32_bf16 v[148:151], v[244:247], v[196:199], v[148:151]
    s_add_u32 m0, s67, 3072
    v_mfma_f32_16x16x32_bf16 v[144:147], v[244:247], v[192:195], v[144:147]
    buffer_load_dwordx4 v23, s[24:27], s65 offen  lds
    v_mfma_f32_16x16x32_bf16 v[140:143], v[244:247], v[188:191], v[140:143]
    v_mfma_f32_16x16x32_bf16 v[136:139], v[244:247], v[184:187], v[136:139]
    s_waitcnt lgkmcnt(0)
    s_waitcnt vmcnt(16)
    v_mfma_f32_16x16x32_bf16 v[88:91], v[248:251], v[232:235], v[88:91]
    ds_read_b64_tr_b16 v[240:241], v24 offset:5120
    v_mfma_f32_16x16x32_bf16 v[92:95], v[248:251], v[236:239], v[92:95]
    ds_read_b64_tr_b16 v[242:243], v24 offset:5632
    v_mfma_f32_16x16x32_bf16 v[96:99], v[248:251], a[0:3], v[96:99]
    ds_read_b64_tr_b16 v[244:245], v24 offset:5128
    v_mfma_f32_16x16x32_bf16 v[100:103], v[248:251], a[4:7], v[100:103]
    ds_read_b64_tr_b16 v[246:247], v24 offset:5640
    v_mfma_f32_16x16x32_bf16 v[104:107], v[248:251], a[8:11], v[104:107]
    s_add_u32 s65, s68, 393216
    v_mfma_f32_16x16x32_bf16 v[108:111], v[248:251], a[12:15], v[108:111]
    s_add_u32 m0, s59, 28680
    v_mfma_f32_16x16x32_bf16 v[156:159], v[252:255], a[12:15], v[156:159]
    buffer_load_dwordx4 v22, s[24:27], s65 offen  lds
    v_mfma_f32_16x16x32_bf16 v[152:155], v[252:255], a[8:11], v[152:155]
    v_mfma_f32_16x16x32_bf16 v[148:151], v[252:255], a[4:7], v[148:151]
    s_add_u32 m0, s67, 4096
    v_mfma_f32_16x16x32_bf16 v[144:147], v[252:255], a[0:3], v[144:147]
    buffer_load_dwordx4 v23, s[24:27], s65 offen  lds
    v_mfma_f32_16x16x32_bf16 v[140:143], v[252:255], v[236:239], v[140:143]
    buffer_load_dword v4, v26, s[28:31], 0 offen sc1
    v_mfma_f32_16x16x32_bf16 v[136:139], v[252:255], v[232:235], v[136:139]
    s_waitcnt lgkmcnt(0)
    s_waitcnt vmcnt(11)
    v_mfma_f32_16x16x32_bf16 v[88:91], v[240:243], a[16:19], v[88:91]
    ds_read_b64_tr_b16 v[248:249], v24 offset:6144
    v_mfma_f32_16x16x32_bf16 v[92:95], v[240:243], a[20:23], v[92:95]
    ds_read_b64_tr_b16 v[250:251], v24 offset:6656
    v_mfma_f32_16x16x32_bf16 v[96:99], v[240:243], a[24:27], v[96:99]
    ds_read_b64_tr_b16 v[252:253], v24 offset:6152
    v_mfma_f32_16x16x32_bf16 v[100:103], v[240:243], a[28:31], v[100:103]
    ds_read_b64_tr_b16 v[254:255], v24 offset:6664
    v_mfma_f32_16x16x32_bf16 v[104:107], v[240:243], a[32:35], v[104:107]
    s_add_u32 s65, s68, 425984
    v_mfma_f32_16x16x32_bf16 v[108:111], v[240:243], a[36:39], v[108:111]
    s_add_u32 m0, s59, 29704
    v_mfma_f32_16x16x32_bf16 v[156:159], v[244:247], a[36:39], v[156:159]
    buffer_load_dwordx4 v22, s[24:27], s65 offen  lds
    v_mfma_f32_16x16x32_bf16 v[152:155], v[244:247], a[32:35], v[152:155]
    v_mfma_f32_16x16x32_bf16 v[148:151], v[244:247], a[28:31], v[148:151]
    s_add_u32 m0, s67, 5120
    v_mfma_f32_16x16x32_bf16 v[144:147], v[244:247], a[24:27], v[144:147]
    buffer_load_dwordx4 v23, s[24:27], s65 offen  lds
    v_mfma_f32_16x16x32_bf16 v[140:143], v[244:247], a[20:23], v[140:143]
    v_mfma_f32_16x16x32_bf16 v[136:139], v[244:247], a[16:19], v[136:139]
    s_waitcnt lgkmcnt(0)
    s_waitcnt vmcnt(11)
    v_mfma_f32_16x16x32_bf16 v[88:91], v[248:251], a[40:43], v[88:91]
    ds_read_b64_tr_b16 v[240:241], v24 offset:0
    v_mfma_f32_16x16x32_bf16 v[92:95], v[248:251], a[44:47], v[92:95]
    ds_read_b64_tr_b16 v[242:243], v24 offset:512
    v_mfma_f32_16x16x32_bf16 v[96:99], v[248:251], a[48:51], v[96:99]
    ds_read_b64_tr_b16 v[244:245], v24 offset:8
    v_mfma_f32_16x16x32_bf16 v[100:103], v[248:251], a[52:55], v[100:103]
    ds_read_b64_tr_b16 v[246:247], v24 offset:520
    v_mfma_f32_16x16x32_bf16 v[104:107], v[248:251], a[56:59], v[104:107]
    s_add_u32 s65, s68, 458752
    v_mfma_f32_16x16x32_bf16 v[108:111], v[248:251], a[60:63], v[108:111]
    s_add_u32 m0, s59, 30728
    v_mfma_f32_16x16x32_bf16 v[156:159], v[252:255], a[60:63], v[156:159]
    buffer_load_dwordx4 v22, s[24:27], s65 offen  lds
    s_mov_b32 s64, 1024
    buffer_store_dword v3, v25, s[28:31], s64 offen sc1
    v_mfma_f32_16x16x32_bf16 v[152:155], v[252:255], a[56:59], v[152:155]
    v_mfma_f32_16x16x32_bf16 v[148:151], v[252:255], a[52:55], v[148:151]
    s_add_u32 m0, s67, 6144
    v_mfma_f32_16x16x32_bf16 v[144:147], v[252:255], a[48:51], v[144:147]
    buffer_load_dwordx4 v23, s[24:27], s65 offen  lds
    v_mfma_f32_16x16x32_bf16 v[140:143], v[252:255], a[44:47], v[140:143]
    v_mfma_f32_16x16x32_bf16 v[136:139], v[252:255], a[40:43], v[136:139]
    s_waitcnt lgkmcnt(0)
    s_waitcnt vmcnt(12)
    v_mfma_f32_16x16x32_bf16 v[88:91], v[240:243], a[64:67], v[88:91]
    ds_read_b64_tr_b16 v[248:249], v24 offset:1024
    v_mfma_f32_16x16x32_bf16 v[92:95], v[240:243], a[68:71], v[92:95]
    ds_read_b64_tr_b16 v[250:251], v24 offset:1536
    v_mfma_f32_16x16x32_bf16 v[96:99], v[240:243], a[72:75], v[96:99]
    ds_read_b64_tr_b16 v[252:253], v24 offset:1032
    v_mfma_f32_16x16x32_bf16 v[100:103], v[240:243], a[76:79], v[100:103]
    ds_read_b64_tr_b16 v[254:255], v24 offset:1544
    v_mfma_f32_16x16x32_bf16 v[104:107], v[240:243], a[80:83], v[104:107]
    s_add_u32 s65, s68, 491520
    v_mfma_f32_16x16x32_bf16 v[108:111], v[240:243], a[84:87], v[108:111]
    s_add_u32 m0, s59, 24584
    v_mfma_f32_16x16x32_bf16 v[156:159], v[244:247], a[84:87], v[156:159]
    buffer_load_dwordx4 v22, s[24:27], s65 offen  lds
    v_mfma_f32_16x16x32_bf16 v[152:155], v[244:247], a[80:83], v[152:155]
    v_mfma_f32_16x16x32_bf16 v[148:151], v[244:247], a[76:79], v[148:151]
    s_add_u32 m0, s67, 0
    v_mfma_f32_16x16x32_bf16 v[144:147], v[244:247], a[72:75], v[144:147]
    buffer_load_dwordx4 v23, s[24:27], s65 offen  lds
    v_mfma_f32_16x16x32_bf16 v[140:143], v[244:247], a[68:71], v[140:143]
    v_mfma_f32_16x16x32_bf16 v[136:139], v[244:247], a[64:67], v[136:139]
    s_waitcnt lgkmcnt(0)
    s_waitcnt vmcnt(12)
    v_mfma_f32_16x16x32_bf16 v[88:91], v[248:251], a[88:91], v[88:91]
    ds_read_b64_tr_b16 v[240:241], v24 offset:2048
    v_mfma_f32_16x16x32_bf16 v[92:95], v[248:251], a[92:95], v[92:95]
    ds_read_b64_tr_b16 v[242:243], v24 offset:2560
    v_mfma_f32_16x16x32_bf16 v[96:99], v[248:251], a[96:99], v[96:99]
    ds_read_b64_tr_b16 v[244:245], v24 offset:2056
    v_mfma_f32_16x16x32_bf16 v[100:103], v[248:251], a[100:103], v[100:103]
    ds_read_b64_tr_b16 v[246:247], v24 offset:2568
    v_mfma_f32_16x16x32_bf16 v[104:107], v[248:251], a[104:107], v[104:107]
    v_mfma_f32_16x16x32_bf16 v[108:111], v[248:251], a[108:111], v[108:111]
    v_mfma_f32_16x16x32_bf16 v[156:159], v[252:255], a[108:111], v[156:159]
    v_mfma_f32_16x16x32_bf16 v[152:155], v[252:255], a[104:107], v[152:155]
    v_mfma_f32_16x16x32_bf16 v[148:151], v[252:255], a[100:103], v[148:151]
    v_mfma_f32_16x16x32_bf16 v[144:147], v[252:255], a[96:99], v[144:147]
    v_mfma_f32_16x16x32_bf16 v[140:143], v[252:255], a[92:95], v[140:143]
    v_mfma_f32_16x16x32_bf16 v[136:139], v[252:255], a[88:91], v[136:139]
    s_waitcnt lgkmcnt(0)
    s_waitcnt vmcnt(10)
    s_waitcnt vmcnt(7)
    v_cmp_ne_u32 vcc, 1, v4
    s_nop 1
    s_and_b32 s3, vcc_lo, 0xffff
    s_cbranch_scc0 L_fl_c01_ok
    s_mov_b32 s43, 0
L_fl_c01:
    buffer_load_dword v4, v26, s[28:31], 0 offen sc1
    s_waitcnt vmcnt(0)
    v_cmp_ne_u32 vcc, 1, v4
    s_nop 1
    s_and_b32 s3, vcc_lo, 0xffff
    s_cbranch_scc0 L_fl_c01_ok
    s_add_u32 s43, s43, 1
    s_cmp_ge_u32 s43, 200000
    s_cbranch_scc1 L_fl_c01_ok
    s_branch L_fl_c01
L_fl_c01_ok:
    v_mfma_f32_16x16x32_bf16 v[88:91], v[240:243], a[112:115], v[88:91]
    ds_read_b64_tr_b16 v[248:249], v24 offset:3072
    v_mfma_f32_16x16x32_bf16 v[92:95], v[240:243], a[116:119], v[92:95]
    ds_read_b64_tr_b16 v[250:251], v24 offset:3584
    s_add_u32 s42, s72, 0
    s_and_b32 s42, s42, 3
    s_mul_i32 s42, s42, 24576
    buffer_load_dwordx4 v[64:67], v27, s[28:31], s42 offen sc0 sc1
    v_mfma_f32_16x16x32_bf16 v[96:99], v[240:243], a[120:123], v[96:99]
    ds_read_b64_tr_b16 v[252:253], v24 offset:3080
    s_add_u32 s42, s42, 98304
    buffer_load_dwordx4 v[68:71], v27, s[28:31], s42 offen sc0 sc1
    v_mfma_f32_16x16x32_bf16 v[100:103], v[240:243], a[124:127], v[100:103]
    ds_read_b64_tr_b16 v[254:255], v24 offset:3592
    s_add_u32 s42, s42, 98304
    buffer_load_dwordx4 v[72:75], v27, s[28:31], s42 offen sc0 sc1
    v_mfma_f32_16x16x32_bf16 v[104:107], v[240:243], a[128:131], v[104:107]
    s_add_u32 s42, s42, 98304
    buffer_load_dwordx4 v[76:79], v27, s[28:31], s42 offen sc0 sc1
    v_mfma_f32_16x16x32_bf16 v[108:111], v[240:243], a[132:135], v[108:111]
    v_mfma_f32_16x16x32_bf16 v[156:159], v[244:247], a[132:135], v[156:159]
    s_add_u32 s42, s42, 98304
    buffer_load_dwordx4 v[80:83], v27, s[28:31], s42 offen sc0 sc1
    v_mfma_f32_16x16x32_bf16 v[152:155], v[244:247], a[128:131], v[152:155]
    s_add_u32 s42, s42, 98304
    buffer_load_dwordx4 v[84:87], v27, s[28:31], s42 offen sc0 sc1
    v_mfma_f32_16x16x32_bf16 v[148:151], v[244:247], a[124:127], v[148:151]
    s_add_u32 s42, s42, 98304
    buffer_load_dwordx4 v[112:115], v27, s[28:31], s42 offen sc0 sc1
    v_mfma_f32_16x16x32_bf16 v[144:147], v[244:247], a[120:123], v[144:147]
    s_add_u32 s42, s42, 98304
    buffer_load_dwordx4 v[116:119], v27, s[28:31], s42 offen sc0 sc1
    v_mfma_f32_16x16x32_bf16 v[140:143], v[244:247], a[116:119], v[140:143]
    v_mfma_f32_16x16x32_bf16 v[136:139], v[244:247], a[112:115], v[136:139]
    s_waitcnt lgkmcnt(0)
    v_mfma_f32_16x16x32_bf16 v[88:91], v[248:251], a[136:139], v[88:91]
    ds_read_b64_tr_b16 v[240:241], v24 offset:4096
    v_mfma_f32_16x16x32_bf16 v[92:95], v[248:251], a[140:143], v[92:95]
    ds_read_b64_tr_b16 v[242:243], v24 offset:4608
    v_mfma_f32_16x16x32_bf16 v[96:99], v[248:251], a[144:147], v[96:99]
    ds_read_b64_tr_b16 v[244:245], v24 offset:4104
    v_mfma_f32_16x16x32_bf16 v[100:103], v[248:251], a[148:151], v[100:103]
    ds_read_b64_tr_b16 v[246:247], v24 offset:4616
    v_mfma_f32_16x16x32_bf16 v[104:107], v[248:251], a[152:155], v[104:107]
    v_mfma_f32_16x16x32_bf16 v[108:111], v[248:251], a[156:159], v[108:111]
    v_mfma_f32_16x16x32_bf16 v[156:159], v[252:255], a[156:159], v[156:159]
    v_mfma_f32_16x16x32_bf16 v[152:155], v[252:255], a[152:155], v[152:155]
    v_mfma_f32_16x16x32_bf16 v[148:151], v[252:255], a[148:151], v[148:151]
    v_mfma_f32_16x16x32_bf16 v[144:147], v[252:255], a[144:147], v[144:147]
    v_mfma_f32_16x16x32_bf16 v[140:143], v[252:255], a[140:143], v[140:143]
    v_mfma_f32_16x16x32_bf16 v[136:139], v[252:255], a[136:139], v[136:139]
    s_waitcnt lgkmcnt(0)
    s_waitcnt vmcnt(13)
    v_mfma_f32_16x16x32_bf16 v[88:91], v[240:243], a[160:163], v[88:91]
    ds_read_b64_tr_b16 v[248:249], v24 offset:5120
    v_mfma_f32_16x16x32_bf16 v[92:95], v[240:243], a[164:167], v[92:95]
    ds_read_b64_tr_b16 v[250:251], v24 offset:5632
    v_mfma_f32_16x16x32_bf16 v[96:99], v[240:243], a[168:171], v[96:99]
    ds_read_b64_tr_b16 v[252:253], v24 offset:5128
    v_mfma_f32_16x16x32_bf16 v[100:103], v[240:243], a[172:175], v[100:103]
    ds_read_b64_tr_b16 v[254:255], v24 offset:5640
    v_mfma_f32_16x16x32_bf16 v[104:107], v[240:243], a[176:179], v[104:107]
    v_mfma_f32_16x16x32_bf16 v[108:111], v[240:243], a[180:183], v[108:111]
    v_mfma_f32_16x16x32_bf16 v[156:159], v[244:247], a[180:183], v[156:159]
    v_mfma_f32_16x16x32_bf16 v[152:155], v[244:247], a[176:179], v[152:155]
    v_mfma_f32_16x16x32_bf16 v[148:151], v[244:247], a[172:175], v[148:151]
    v_mfma_f32_16x16x32_bf16 v[144:147], v[244:247], a[168:171], v[144:147]
    v_mfma_f32_16x16x32_bf16 v[140:143], v[244:247], a[164:167], v[140:143]
    v_mfma_f32_16x16x32_bf16 v[136:139], v[244:247], a[160:163], v[136:139]
    s_waitcnt lgkmcnt(0)
    s_waitcnt vmcnt(10)
    v_mfma_f32_16x16x32_bf16 v[88:91], v[248:251], a[184:187], v[88:91]
    ds_read_b64_tr_b16 v[240:241], v24 offset:6144
    v_mfma_f32_16x16x32_bf16 v[92:95], v[248:251], a[188:191], v[92:95]
    ds_read_b64_tr_b16 v[242:243], v24 offset:6656
    v_mfma_f32_16x16x32_bf16 v[96:99], v[248:251], a[192:195], v[96:99]
    ds_read_b64_tr_b16 v[244:245], v24 offset:6152
    v_mfma_f32_16x16x32_bf16 v[100:103], v[248:251], a[196:199], v[100:103]
    ds_read_b64_tr_b16 v[246:247], v24 offset:6664
    v_mfma_f32_16x16x32_bf16 v[104:107], v[248:251], a[200:203], v[104:107]
    v_mfma_f32_16x16x32_bf16 v[108:111], v[248:251], a[204:207], v[108:111]
    v_mfma_f32_16x16x32_bf16 v[156:159], v[252:255], a[204:207], v[156:159]
    v_mfma_f32_16x16x32_bf16 v[152:155], v[252:255], a[200:203], v[152:155]
    v_mfma_f32_16x16x32_bf16 v[148:151], v[252:255], a[196:199], v[148:151]
    v_mfma_f32_16x16x32_bf16 v[144:147], v[252:255], a[192:195], v[144:147]
    v_mfma_f32_16x16x32_bf16 v[140:143], v[252:255], a[188:191], v[140:143]
    buffer_load_dword v4, v26, s[28:31], 0 offen sc1
    v_mfma_f32_16x16x32_bf16 v[136:139], v[252:255], a[184:187], v[136:139]
    s_waitcnt lgkmcnt(0)
    s_waitcnt vmcnt(9)
    v_mfma_f32_16x16x32_bf16 v[88:91], v[240:243], a[208:211], v[88:91]
    ds_read_b64_tr_b16 v[248:249], v24 offset:0
    v_mfma_f32_16x16x32_bf16 v[92:95], v[240:243], a[212:215], v[92:95]
    ds_read_b64_tr_b16 v[250:251], v24 offset:512
    v_mfma_f32_16x16x32_bf16 v[96:99], v[240:243], a[216:219], v[96:99]
    ds_read_b64_tr_b16 v[252:253], v24 offset:8
    v_mfma_f32_16x16x32_bf16 v[100:103], v[240:243], a[220:223], v[100:103]
    ds_read_b64_tr_b16 v[254:255], v24 offset:520
    v_mfma_f32_16x16x32_bf16 v[104:107], v[240:243], a[224:227], v[104:107]
    v_mfma_f32_16x16x32_bf16 v[108:111], v[240:243], a[228:231], v[108:111]
    v_mfma_f32_16x16x32_bf16 v[156:159], v[244:247], a[228:231], v[156:159]
    v_mfma_f32_16x16x32_bf16 v[152:155], v[244:247], a[224:227], v[152:155]
    v_mfma_f32_16x16x32_bf16 v[148:151], v[244:247], a[220:223], v[148:151]
    v_mfma_f32_16x16x32_bf16 v[144:147], v[244:247], a[216:219], v[144:147]
    v_mfma_f32_16x16x32_bf16 v[140:143], v[244:247], a[212:215], v[140:143]
    v_mfma_f32_16x16x32_bf16 v[136:139], v[244:247], a[208:211], v[136:139]
    s_waitcnt lgkmcnt(0)
    v_mfma_f32_16x16x32_bf16 v[88:91], v[248:251], a[232:235], v[88:91]
    v_mfma_f32_16x16x32_bf16 v[92:95], v[248:251], a[236:239], v[92:95]
    v_mfma_f32_16x16x32_bf16 v[96:99], v[248:251], a[240:243], v[96:99]
    v_mfma_f32_16x16x32_bf16 v[100:103], v[248:251], a[244:247], v[100:103]
    v_mfma_f32_16x16x32_bf16 v[104:107], v[248:251], a[248:251], v[104:107]
    v_mfma_f32_16x16x32_bf16 v[108:111], v[248:251], a[252:255], v[108:111]
    v_mfma_f32_16x16x32_bf16 v[156:159], v[252:255], a[252:255], v[156:159]
    v_mfma_f32_16x16x32_bf16 v[152:155], v[252:255], a[248:251], v[152:155]
    v_mfma_f32_16x16x32_bf16 v[148:151], v[252:255], a[244:247], v[148:151]
    v_mfma_f32_16x16x32_bf16 v[144:147], v[252:255], a[240:243], v[144:147]
    v_mfma_f32_16x16x32_bf16 v[140:143], v[252:255], a[236:239], v[140:143]
    v_mfma_f32_16x16x32_bf16 v[136:139], v[252:255], a[232:235], v[136:139]
    s_add_u32 s69, s72, 3
    s_and_b32 s69, s69, 3
    s_mul_i32 s69, s69, 24576
    s_add_u32 s70, s69, 4096
    v_cvt_pk_bf16_f32 v108, v108, v109
    v_cvt_pk_bf16_f32 v109, v110, v111
    v_cvt_pk_bf16_f32 v110, v156, v157
    v_cvt_pk_bf16_f32 v111, v158, v159
    buffer_store_dwordx4 v[108:111], v28, s[28:31], s70 offen offset:1024 sc0 sc1
    v_cvt_pk_bf16_f32 v104, v104, v105
    v_cvt_pk_bf16_f32 v105, v106, v107
    v_cvt_pk_bf16_f32 v106, v152, v153
    v_cvt_pk_bf16_f32 v107, v154, v155
    buffer_store_dwordx4 v[104:107], v28, s[28:31], s70 offen offset:0 sc0 sc1
    v_cvt_pk_bf16_f32 v100, v100, v101
    v_cvt_pk_bf16_f32 v101, v102, v103
    v_cvt_pk_bf16_f32 v102, v148, v149
    v_cvt_pk_bf16_f32 v103, v150, v151
    buffer_store_dwordx4 v[100:103], v28, s[28:31], s69 offen offset:3072 sc0 sc1
    v_cvt_pk_bf16_f32 v96, v96, v97
    v_cvt_pk_bf16_f32 v97, v98, v99
    v_cvt_pk_bf16_f32 v98, v144, v145
    v_cvt_pk_bf16_f32 v99, v146, v147
    buffer_store_dwordx4 v[96:99], v28, s[28:31], s69 offen offset:2048 sc0 sc1
    v_cvt_pk_bf16_f32 v92, v92, v93
    v_cvt_pk_bf16_f32 v93, v94, v95
    v_cvt_pk_bf16_f32 v94, v140, v141
    v_cvt_pk_bf16_f32 v95, v142, v143
    buffer_store_dwordx4 v[92:95], v28, s[28:31], s69 offen offset:1024 sc0 sc1
    v_cvt_pk_bf16_f32 v88, v88, v89
    v_cvt_pk_bf16_f32 v89, v90, v91
    v_cvt_pk_bf16_f32 v90, v136, v137
    v_cvt_pk_bf16_f32 v91, v138, v139
    buffer_store_dwordx4 v[88:91], v28, s[28:31], s69 offen offset:0 sc0 sc1
    s_waitcnt vmcnt(6)
    v_cmp_ne_u32 vcc, 1, v4
    s_nop 1
    s_and_b32 s3, vcc_lo, 0xff0000
    s_cbranch_scc0 L_fl_c2_ok
    s_mov_b32 s43, 0
L_fl_c2:
    buffer_load_dword v4, v26, s[28:31], 0 offen sc1
    s_waitcnt vmcnt(0)
    v_cmp_ne_u32 vcc, 1, v4
    s_nop 1
    s_and_b32 s3, vcc_lo, 0xff0000
    s_cbranch_scc0 L_fl_c2_ok
    s_add_u32 s43, s43, 1
    s_cmp_ge_u32 s43, 200000
    s_cbranch_scc1 L_fl_c2_ok
    s_branch L_fl_c2
L_fl_c2_ok:
    s_add_u32 s42, s72, 1
    s_and_b32 s42, s42, 3
    s_mul_i32 s42, s42, 24576
    buffer_load_dwordx4 v[120:123], v27, s[28:31], s42 offen sc0 sc1
    s_add_u32 s42, s42, 98304
    buffer_load_dwordx4 v[124:127], v27, s[28:31], s42 offen sc0 sc1
    s_add_u32 s42, s42, 98304
    buffer_load_dwordx4 v[128:131], v27, s[28:31], s42 offen sc0 sc1
    s_add_u32 s42, s42, 98304
    buffer_load_dwordx4 v[132:135], v27, s[28:31], s42 offen sc0 sc1
    s_add_u32 s42, s42, 98304
    buffer_load_dwordx4 v[160:163], v27, s[28:31], s42 offen sc0 sc1
    s_add_u32 s42, s42, 98304
    buffer_load_dwordx4 v[164:167], v27, s[28:31], s42 offen sc0 sc1
    s_add_u32 s42, s42, 98304
    buffer_load_dwordx4 v[168:171], v27, s[28:31], s42 offen sc0 sc1
    s_add_u32 s42, s42, 98304
    buffer_load_dwordx4 v[172:175], v27, s[28:31], s42 offen sc0 sc1
    v_lshlrev_b32 v5, 16, v64
    v_and_b32 v6, s44, v64
    v_lshlrev_b32 v7, 16, v65
    v_and_b32 v8, s44, v65
    v_lshlrev_b32 v9, 16, v66
    v_and_b32 v10, s44, v66
    v_lshlrev_b32 v11, 16, v67
    v_and_b32 v12, s44, v67
    v_lshlrev_b32 v29, 16, v68
    v_and_b32 v18, s44, v68
    v_add_f32 v5, v5, v29
    v_add_f32 v6, v6, v18
    v_lshlrev_b32 v30, 16, v69
    v_and_b32 v19, s44, v69
    v_add_f32 v7, v7, v30
    v_add_f32 v8, v8, v19
    v_lshlrev_b32 v29, 16, v70
    v_and_b32 v18, s44, v70
    v_add_f32 v9, v9, v29
    v_add_f32 v10, v10, v18
    v_lshlrev_b32 v30, 16, v71
    v_and_b32 v19, s44, v71
    v_add_f32 v11, v11, v30
    v_add_f32 v12, v12, v19
    v_lshlrev_b32 v29, 16, v72
    v_and_b32 v18, s44, v72
    v_add_f32 v5, v5, v29
    v_add_f32 v6, v6, v18
    v_lshlrev_b32 v30, 16, v73
    v_and_b32 v19, s44, v73
    v_add_f32 v7, v7, v30
    v_add_f32 v8, v8, v19
    v_lshlrev_b32 v29, 16, v74
    v_and_b32 v18, s44, v74
    v_add_f32 v9, v9, v29
    v_add_f32 v10, v10, v18
    v_lshlrev_b32 v30, 16, v75
    v_and_b32 v19, s44, v75
    v_add_f32 v11, v11, v30
    v_add_f32 v12, v12, v19
    v_lshlrev_b32 v29, 16, v76
    v_and_b32 v18, s44, v76
    v_add_f32 v5, v5, v29
    v_add_f32 v6, v6, v18
    v_lshlrev_b32 v30, 16, v77
    v_and_b32 v19, s44, v77
    v_add_f32 v7, v7, v30
    v_add_f32 v8, v8, v19
    v_lshlrev_b32 v29, 16, v78
    v_and_b32 v18, s44, v78
    v_add_f32 v9, v9, v29
    v_add_f32 v10, v10, v18
    v_lshlrev_b32 v30, 16, v79
    v_and_b32 v19, s44, v79
    v_add_f32 v11, v11, v30
    v_add_f32 v12, v12, v19
    v_lshlrev_b32 v29, 16, v80
    v_and_b32 v18, s44, v80
    v_add_f32 v5, v5, v29
    v_add_f32 v6, v6, v18
    v_lshlrev_b32 v30, 16, v81
    v_and_b32 v19, s44, v81
    v_add_f32 v7, v7, v30
    v_add_f32 v8, v8, v19
    v_lshlrev_b32 v29, 16, v82
    v_and_b32 v18, s44, v82
    v_add_f32 v9, v9, v29
    v_add_f32 v10, v10, v18
    v_lshlrev_b32 v30, 16, v83
    v_and_b32 v19, s44, v83
    v_add_f32 v11, v11, v30
    v_add_f32 v12, v12, v19
    v_lshlrev_b32 v29, 16, v84
    v_and_b32 v18, s44, v84
    v_add_f32 v5, v5, v29
    v_add_f32 v6, v6, v18
    v_lshlrev_b32 v30, 16, v85
    v_and_b32 v19, s44, v85
    v_add_f32 v7, v7, v30
    v_add_f32 v8, v8, v19
    v_lshlrev_b32 v29, 16, v86
    v_and_b32 v18, s44, v86
    v_add_f32 v9, v9, v29
    v_add_f32 v10, v10, v18
    v_lshlrev_b32 v30, 16, v87
    v_and_b32 v19, s44, v87
    v_add_f32 v11, v11, v30
    v_add_f32 v12, v12, v19
    v_lshlrev_b32 v29, 16, v112
    v_and_b32 v18, s44, v112
    v_add_f32 v5, v5, v29
    v_add_f32 v6, v6, v18
    v_lshlrev_b32 v30, 16, v113
    v_and_b32 v19, s44, v113
    v_add_f32 v7, v7, v30
    v_add_f32 v8, v8, v19
    v_lshlrev_b32 v29, 16, v114
    v_and_b32 v18, s44, v114
    v_add_f32 v9, v9, v29
    v_add_f32 v10, v10, v18
    v_lshlrev_b32 v30, 16, v115
    v_and_b32 v19, s44, v115
    v_add_f32 v11, v11, v30
    v_add_f32 v12, v12, v19
    v_lshlrev_b32 v29, 16, v116
    v_and_b32 v18, s44, v116
    v_add_f32 v5, v5, v29
    v_add_f32 v6, v6, v18
    v_lshlrev_b32 v30, 16, v117
    v_and_b32 v19, s44, v117
    v_add_f32 v7, v7, v30
    v_add_f32 v8, v8, v19
    v_lshlrev_b32 v29, 16, v118
    v_and_b32 v18, s44, v118
    v_add_f32 v9, v9, v29
    v_add_f32 v10, v10, v18
    v_lshlrev_b32 v30, 16, v119
    v_and_b32 v19, s44, v119
    v_add_f32 v11, v11, v30
    v_add_f32 v12, v12, v19
    v_cvt_pk_bf16_f32 v14, v5, v6
    v_cvt_pk_bf16_f32 v15, v7, v8
    v_cvt_pk_bf16_f32 v16, v9, v10
    v_cvt_pk_bf16_f32 v17, v11, v12
    s_add_u32 s45, s72, 0
    s_and_b32 s45, s45, 3
    s_lshl_b32 s45, s45, 8
    buffer_store_dwordx4 v[14:17], v2, s[32:35], s45 offen nt
    s_add_u32 s42, s72, 2
    s_and_b32 s42, s42, 3
    s_mul_i32 s42, s42, 24576
    buffer_load_dwordx4 v[176:179], v27, s[28:31], s42 offen sc0 sc1
    s_add_u32 s42, s42, 98304
    buffer_load_dwordx4 v[180:183], v27, s[28:31], s42 offen sc0 sc1
    s_add_u32 s42, s42, 98304
    buffer_load_dwordx4 v[208:211], v27, s[28:31], s42 offen sc0 sc1
    s_add_u32 s42, s42, 98304
    buffer_load_dwordx4 v[212:215], v27, s[28:31], s42 offen sc0 sc1
    s_add_u32 s42, s42, 98304
    buffer_load_dwordx4 v[216:219], v27, s[28:31], s42 offen sc0 sc1
    s_add_u32 s42, s42, 98304
    buffer_load_dwordx4 v[220:223], v27, s[28:31], s42 offen sc0 sc1
    s_add_u32 s42, s42, 98304
    buffer_load_dwordx4 v[224:227], v27, s[28:31], s42 offen sc0 sc1
    s_add_u32 s42, s42, 98304
    buffer_load_dwordx4 v[228:231], v27, s[28:31], s42 offen sc0 sc1
    s_waitcnt vmcnt(17)
    s_mov_b32 s64, 1536
    buffer_store_dword v3, v25, s[28:31], s64 offen sc1
    s_waitcnt vmcnt(17)
    v_lshlrev_b32 v5, 16, v120
    v_and_b32 v6, s44, v120
    v_lshlrev_b32 v7, 16, v121
    v_and_b32 v8, s44, v121
    v_lshlrev_b32 v9, 16, v122
    v_and_b32 v10, s44, v122
    v_lshlrev_b32 v11, 16, v123
    v_and_b32 v12, s44, v123
    s_waitcnt vmcnt(16)
    v_lshlrev_b32 v29, 16, v124
    v_and_b32 v18, s44, v124
    v_add_f32 v5, v5, v29
    v_add_f32 v6, v6, v18
    v_lshlrev_b32 v30, 16, v125
    v_and_b32 v19, s44, v125
    v_add_f32 v7, v7, v30
    v_add_f32 v8, v8, v19
    v_lshlrev_b32 v29, 16, v126
    v_and_b32 v18, s44, v126
    v_add_f32 v9, v9, v29
    v_add_f32 v10, v10, v18
    v_lshlrev_b32 v30, 16, v127
    v_and_b32 v19, s44, v127
    v_add_f32 v11, v11, v30
    v_add_f32 v12, v12, v19
    s_waitcnt vmcnt(15)
    v_lshlrev_b32 v29, 16, v128
    v_and_b32 v18, s44, v128
    v_add_f32 v5, v5, v29
    v_add_f32 v6, v6, v18
    v_lshlrev_b32 v30, 16, v129
    v_and_b32 v19, s44, v129
    v_add_f32 v7, v7, v30
    v_add_f32 v8, v8, v19
    v_lshlrev_b32 v29, 16, v130
    v_and_b32 v18, s44, v130
    v_add_f32 v9, v9, v29
    v_add_f32 v10, v10, v18
    v_lshlrev_b32 v30, 16, v131
    v_and_b32 v19, s44, v131
    v_add_f32 v11, v11, v30
    v_add_f32 v12, v12, v19
    s_waitcnt vmcnt(14)
    v_lshlrev_b32 v29, 16, v132
    v_and_b32 v18, s44, v132
    v_add_f32 v5, v5, v29
    v_add_f32 v6, v6, v18
    v_lshlrev_b32 v30, 16, v133
    v_and_b32 v19, s44, v133
    v_add_f32 v7, v7, v30
    v_add_f32 v8, v8, v19
    v_lshlrev_b32 v29, 16, v134
    v_and_b32 v18, s44, v134
    v_add_f32 v9, v9, v29
    v_add_f32 v10, v10, v18
    v_lshlrev_b32 v30, 16, v135
    v_and_b32 v19, s44, v135
    v_add_f32 v11, v11, v30
    v_add_f32 v12, v12, v19
    s_waitcnt vmcnt(13)
    v_lshlrev_b32 v29, 16, v160
    v_and_b32 v18, s44, v160
    v_add_f32 v5, v5, v29
    v_add_f32 v6, v6, v18
    v_lshlrev_b32 v30, 16, v161
    v_and_b32 v19, s44, v161
    v_add_f32 v7, v7, v30
    v_add_f32 v8, v8, v19
    v_lshlrev_b32 v29, 16, v162
    v_and_b32 v18, s44, v162
    v_add_f32 v9, v9, v29
    v_add_f32 v10, v10, v18
    v_lshlrev_b32 v30, 16, v163
    v_and_b32 v19, s44, v163
    v_add_f32 v11, v11, v30
    v_add_f32 v12, v12, v19
    s_waitcnt vmcnt(12)
    v_lshlrev_b32 v29, 16, v164
    v_and_b32 v18, s44, v164
    v_add_f32 v5, v5, v29
    v_add_f32 v6, v6, v18
    v_lshlrev_b32 v30, 16, v165
    v_and_b32 v19, s44, v165
    v_add_f32 v7, v7, v30
    v_add_f32 v8, v8, v19
    v_lshlrev_b32 v29, 16, v166
    v_and_b32 v18, s44, v166
    v_add_f32 v9, v9, v29
    v_add_f32 v10, v10, v18
    v_lshlrev_b32 v30, 16, v167
    v_and_b32 v19, s44, v167
    v_add_f32 v11, v11, v30
    v_add_f32 v12, v12, v19
    s_waitcnt vmcnt(11)
    v_lshlrev_b32 v29, 16, v168
    v_and_b32 v18, s44, v168
    v_add_f32 v5, v5, v29
    v_add_f32 v6, v6, v18
    v_lshlrev_b32 v30, 16, v169
    v_and_b32 v19, s44, v169
    v_add_f32 v7, v7, v30
    v_add_f32 v8, v8, v19
    v_lshlrev_b32 v29, 16, v170
    v_and_b32 v18, s44, v170
    v_add_f32 v9, v9, v29
    v_add_f32 v10, v10, v18
    v_lshlrev_b32 v30, 16, v171
    v_and_b32 v19, s44, v171
    v_add_f32 v11, v11, v30
    v_add_f32 v12, v12, v19
    s_waitcnt vmcnt(10)
    v_lshlrev_b32 v29, 16, v172
    v_and_b32 v18, s44, v172
    v_add_f32 v5, v5, v29
    v_add_f32 v6, v6, v18
    v_lshlrev_b32 v30, 16, v173
    v_and_b32 v19, s44, v173
    v_add_f32 v7, v7, v30
    v_add_f32 v8, v8, v19
    v_lshlrev_b32 v29, 16, v174
    v_and_b32 v18, s44, v174
    v_add_f32 v9, v9, v29
    v_add_f32 v10, v10, v18
    v_lshlrev_b32 v30, 16, v175
    v_and_b32 v19, s44, v175
    v_add_f32 v11, v11, v30
    v_add_f32 v12, v12, v19
    v_cvt_pk_bf16_f32 v14, v5, v6
    v_cvt_pk_bf16_f32 v15, v7, v8
    v_cvt_pk_bf16_f32 v16, v9, v10
    v_cvt_pk_bf16_f32 v17, v11, v12
    s_add_u32 s45, s72, 1
    s_and_b32 s45, s45, 3
    s_lshl_b32 s45, s45, 8
    buffer_store_dwordx4 v[14:17], v2, s[32:35], s45 offen nt
    s_mov_b32 s43, 0
L_fl_c3:
    buffer_load_dword v4, v26, s[28:31], 0 offen sc1
    s_waitcnt vmcnt(0)
    v_cmp_ne_u32 vcc, 1, v4
    s_nop 1
    s_and_b32 s3, vcc_lo, 0xff000000
    s_cbranch_scc0 L_fl_c3_ok
    s_add_u32 s43, s43, 1
    s_cmp_ge_u32 s43, 200000
    s_cbranch_scc1 L_fl_c3_ok
    s_branch L_fl_c3
L_fl_c3_ok:
    s_add_u32 s42, s72, 3
    s_and_b32 s42, s42, 3
    s_mul_i32 s42, s42, 24576
    buffer_load_dwordx4 v[184:187], v27, s[28:31], s42 offen sc0 sc1
    s_add_u32 s42, s42, 98304
    buffer_load_dwordx4 v[188:191], v27, s[28:31], s42 offen sc0 sc1
    s_add_u32 s42, s42, 98304
    buffer_load_dwordx4 v[192:195], v27, s[28:31], s42 offen sc0 sc1
    s_add_u32 s42, s42, 98304
    buffer_load_dwordx4 v[196:199], v27, s[28:31], s42 offen sc0 sc1
    s_add_u32 s42, s42, 98304
    buffer_load_dwordx4 v[200:203], v27, s[28:31], s42 offen sc0 sc1
    s_add_u32 s42, s42, 98304
    buffer_load_dwordx4 v[204:207], v27, s[28:31], s42 offen sc0 sc1
    s_add_u32 s42, s42, 98304
    buffer_load_dwordx4 v[32:35], v27, s[28:31], s42 offen sc0 sc1
    s_add_u32 s42, s42, 98304
    buffer_load_dwordx4 v[36:39], v27, s[28:31], s42 offen sc0 sc1
    s_waitcnt vmcnt(17)
    v_lshlrev_b32 v5, 16, v176
    v_and_b32 v6, s44, v176
    v_lshlrev_b32 v7, 16, v177
    v_and_b32 v8, s44, v177
    v_lshlrev_b32 v9, 16, v178
    v_and_b32 v10, s44, v178
    v_lshlrev_b32 v11, 16, v179
    v_and_b32 v12, s44, v179
    s_waitcnt vmcnt(16)
    v_lshlrev_b32 v29, 16, v180
    v_and_b32 v18, s44, v180
    v_add_f32 v5, v5, v29
    v_add_f32 v6, v6, v18
    v_lshlrev_b32 v30, 16, v181
    v_and_b32 v19, s44, v181
    v_add_f32 v7, v7, v30
    v_add_f32 v8, v8, v19
    v_lshlrev_b32 v29, 16, v182
    v_and_b32 v18, s44, v182
    v_add_f32 v9, v9, v29
    v_add_f32 v10, v10, v18
    v_lshlrev_b32 v30, 16, v183
    v_and_b32 v19, s44, v183
    v_add_f32 v11, v11, v30
    v_add_f32 v12, v12, v19
    s_waitcnt vmcnt(15)
    v_lshlrev_b32 v29, 16, v208
    v_and_b32 v18, s44, v208
    v_add_f32 v5, v5, v29
    v_add_f32 v6, v6, v18
    v_lshlrev_b32 v30, 16, v209
    v_and_b32 v19, s44, v209
    v_add_f32 v7, v7, v30
    v_add_f32 v8, v8, v19
    v_lshlrev_b32 v29, 16, v210
    v_and_b32 v18, s44, v210
    v_add_f32 v9, v9, v29
    v_add_f32 v10, v10, v18
    v_lshlrev_b32 v30, 16, v211
    v_and_b32 v19, s44, v211
    v_add_f32 v11, v11, v30
    v_add_f32 v12, v12, v19
    s_waitcnt vmcnt(14)
    v_lshlrev_b32 v29, 16, v212
    v_and_b32 v18, s44, v212
    v_add_f32 v5, v5, v29
    v_add_f32 v6, v6, v18
    v_lshlrev_b32 v30, 16, v213
    v_and_b32 v19, s44, v213
    v_add_f32 v7, v7, v30
    v_add_f32 v8, v8, v19
    v_lshlrev_b32 v29, 16, v214
    v_and_b32 v18, s44, v214
    v_add_f32 v9, v9, v29
    v_add_f32 v10, v10, v18
    v_lshlrev_b32 v30, 16, v215
    v_and_b32 v19, s44, v215
    v_add_f32 v11, v11, v30
    v_add_f32 v12, v12, v19
    s_waitcnt vmcnt(13)
    v_lshlrev_b32 v29, 16, v216
    v_and_b32 v18, s44, v216
    v_add_f32 v5, v5, v29
    v_add_f32 v6, v6, v18
    v_lshlrev_b32 v30, 16, v217
    v_and_b32 v19, s44, v217
    v_add_f32 v7, v7, v30
    v_add_f32 v8, v8, v19
    v_lshlrev_b32 v29, 16, v218
    v_and_b32 v18, s44, v218
    v_add_f32 v9, v9, v29
    v_add_f32 v10, v10, v18
    v_lshlrev_b32 v30, 16, v219
    v_and_b32 v19, s44, v219
    v_add_f32 v11, v11, v30
    v_add_f32 v12, v12, v19
    s_waitcnt vmcnt(12)
    v_lshlrev_b32 v29, 16, v220
    v_and_b32 v18, s44, v220
    v_add_f32 v5, v5, v29
    v_add_f32 v6, v6, v18
    v_lshlrev_b32 v30, 16, v221
    v_and_b32 v19, s44, v221
    v_add_f32 v7, v7, v30
    v_add_f32 v8, v8, v19
    v_lshlrev_b32 v29, 16, v222
    v_and_b32 v18, s44, v222
    v_add_f32 v9, v9, v29
    v_add_f32 v10, v10, v18
    v_lshlrev_b32 v30, 16, v223
    v_and_b32 v19, s44, v223
    v_add_f32 v11, v11, v30
    v_add_f32 v12, v12, v19
    s_waitcnt vmcnt(11)
    v_lshlrev_b32 v29, 16, v224
    v_and_b32 v18, s44, v224
    v_add_f32 v5, v5, v29
    v_add_f32 v6, v6, v18
    v_lshlrev_b32 v30, 16, v225
    v_and_b32 v19, s44, v225
    v_add_f32 v7, v7, v30
    v_add_f32 v8, v8, v19
    v_lshlrev_b32 v29, 16, v226
    v_and_b32 v18, s44, v226
    v_add_f32 v9, v9, v29
    v_add_f32 v10, v10, v18
    v_lshlrev_b32 v30, 16, v227
    v_and_b32 v19, s44, v227
    v_add_f32 v11, v11, v30
    v_add_f32 v12, v12, v19
    s_waitcnt vmcnt(10)
    v_lshlrev_b32 v29, 16, v228
    v_and_b32 v18, s44, v228
    v_add_f32 v5, v5, v29
    v_add_f32 v6, v6, v18
    v_lshlrev_b32 v30, 16, v229
    v_and_b32 v19, s44, v229
    v_add_f32 v7, v7, v30
    v_add_f32 v8, v8, v19
    v_lshlrev_b32 v29, 16, v230
    v_and_b32 v18, s44, v230
    v_add_f32 v9, v9, v29
    v_add_f32 v10, v10, v18
    v_lshlrev_b32 v30, 16, v231
    v_and_b32 v19, s44, v231
    v_add_f32 v11, v11, v30
    v_add_f32 v12, v12, v19
    v_cvt_pk_bf16_f32 v14, v5, v6
    v_cvt_pk_bf16_f32 v15, v7, v8
    v_cvt_pk_bf16_f32 v16, v9, v10
    v_cvt_pk_bf16_f32 v17, v11, v12
    s_add_u32 s45, s72, 2
    s_and_b32 s45, s45, 3
    s_lshl_b32 s45, s45, 8
    buffer_store_dwordx4 v[14:17], v2, s[32:35], s45 offen nt
    s_waitcnt vmcnt(8)
    v_lshlrev_b32 v5, 16, v184
    v_and_b32 v6, s44, v184
    v_lshlrev_b32 v7, 16, v185
    v_and_b32 v8, s44, v185
    v_lshlrev_b32 v9, 16, v186
    v_and_b32 v10, s44, v186
    v_lshlrev_b32 v11, 16, v187
    v_and_b32 v12, s44, v187
    s_waitcnt vmcnt(7)
    v_lshlrev_b32 v29, 16, v188
    v_and_b32 v18, s44, v188
    v_add_f32 v5, v5, v29
    v_add_f32 v6, v6, v18
    v_lshlrev_b32 v30, 16, v189
    v_and_b32 v19, s44, v189
    v_add_f32 v7, v7, v30
    v_add_f32 v8, v8, v19
    v_lshlrev_b32 v29, 16, v190
    v_and_b32 v18, s44, v190
    v_add_f32 v9, v9, v29
    v_add_f32 v10, v10, v18
    v_lshlrev_b32 v30, 16, v191
    v_and_b32 v19, s44, v191
    v_add_f32 v11, v11, v30
    v_add_f32 v12, v12, v19
    s_waitcnt vmcnt(6)
    v_lshlrev_b32 v29, 16, v192
    v_and_b32 v18, s44, v192
    v_add_f32 v5, v5, v29
    v_add_f32 v6, v6, v18
    v_lshlrev_b32 v30, 16, v193
    v_and_b32 v19, s44, v193
    v_add_f32 v7, v7, v30
    v_add_f32 v8, v8, v19
    v_lshlrev_b32 v29, 16, v194
    v_and_b32 v18, s44, v194
    v_add_f32 v9, v9, v29
    v_add_f32 v10, v10, v18
    v_lshlrev_b32 v30, 16, v195
    v_and_b32 v19, s44, v195
    v_add_f32 v11, v11, v30
    v_add_f32 v12, v12, v19
    s_waitcnt vmcnt(5)
    v_lshlrev_b32 v29, 16, v196
    v_and_b32 v18, s44, v196
    v_add_f32 v5, v5, v29
    v_add_f32 v6, v6, v18
    v_lshlrev_b32 v30, 16, v197
    v_and_b32 v19, s44, v197
    v_add_f32 v7, v7, v30
    v_add_f32 v8, v8, v19
    v_lshlrev_b32 v29, 16, v198
    v_and_b32 v18, s44, v198
    v_add_f32 v9, v9, v29
    v_add_f32 v10, v10, v18
    v_lshlrev_b32 v30, 16, v199
    v_and_b32 v19, s44, v199
    v_add_f32 v11, v11, v30
    v_add_f32 v12, v12, v19
    s_waitcnt vmcnt(4)
    v_lshlrev_b32 v29, 16, v200
    v_and_b32 v18, s44, v200
    v_add_f32 v5, v5, v29
    v_add_f32 v6, v6, v18
    v_lshlrev_b32 v30, 16, v201
    v_and_b32 v19, s44, v201
    v_add_f32 v7, v7, v30
    v_add_f32 v8, v8, v19
    v_lshlrev_b32 v29, 16, v202
    v_and_b32 v18, s44, v202
    v_add_f32 v9, v9, v29
    v_add_f32 v10, v10, v18
    v_lshlrev_b32 v30, 16, v203
    v_and_b32 v19, s44, v203
    v_add_f32 v11, v11, v30
    v_add_f32 v12, v12, v19
    s_waitcnt vmcnt(3)
    v_lshlrev_b32 v29, 16, v204
    v_and_b32 v18, s44, v204
    v_add_f32 v5, v5, v29
    v_add_f32 v6, v6, v18
    v_lshlrev_b32 v30, 16, v205
    v_and_b32 v19, s44, v205
    v_add_f32 v7, v7, v30
    v_add_f32 v8, v8, v19
    v_lshlrev_b32 v29, 16, v206
    v_and_b32 v18, s44, v206
    v_add_f32 v9, v9, v29
    v_add_f32 v10, v10, v18
    v_lshlrev_b32 v30, 16, v207
    v_and_b32 v19, s44, v207
    v_add_f32 v11, v11, v30
    v_add_f32 v12, v12, v19
    s_waitcnt vmcnt(2)
    v_lshlrev_b32 v29, 16, v32
    v_and_b32 v18, s44, v32
    v_add_f32 v5, v5, v29
    v_add_f32 v6, v6, v18
    v_lshlrev_b32 v30, 16, v33
    v_and_b32 v19, s44, v33
    v_add_f32 v7, v7, v30
    v_add_f32 v8, v8, v19
    v_lshlrev_b32 v29, 16, v34
    v_and_b32 v18, s44, v34
    v_add_f32 v9, v9, v29
    v_add_f32 v10, v10, v18
    v_lshlrev_b32 v30, 16, v35
    v_and_b32 v19, s44, v35
    v_add_f32 v11, v11, v30
    v_add_f32 v12, v12, v19
    s_waitcnt vmcnt(1)
    v_lshlrev_b32 v29, 16, v36
    v_and_b32 v18, s44, v36
    v_add_f32 v5, v5, v29
    v_add_f32 v6, v6, v18
    v_lshlrev_b32 v30, 16, v37
    v_and_b32 v19, s44, v37
    v_add_f32 v7, v7, v30
    v_add_f32 v8, v8, v19
    v_lshlrev_b32 v29, 16, v38
    v_and_b32 v18, s44, v38
    v_add_f32 v9, v9, v29
    v_add_f32 v10, v10, v18
    v_lshlrev_b32 v30, 16, v39
    v_and_b32 v19, s44, v39
    v_add_f32 v11, v11, v30
    v_add_f32 v12, v12, v19
    v_cvt_pk_bf16_f32 v14, v5, v6
    v_cvt_pk_bf16_f32 v15, v7, v8
    v_cvt_pk_bf16_f32 v16, v9, v10
    v_cvt_pk_bf16_f32 v17, v11, v12
    s_add_u32 s45, s72, 3
    s_and_b32 s45, s45, 3
    s_lshl_b32 s45, s45, 8
    buffer_store_dwordx4 v[14:17], v2, s[32:35], s45 offen nt
L_main_end:
    s_endpgm
L_code_end:
.set CODE_BYTES, L_code_end-concat_heads__mha_block_cached__mha_block_cached__near_ridge_kernel
.section .rodata,"a"
.p2align 6
.amdhsa_kernel concat_heads__mha_block_cached__mha_block_cached__near_ridge_kernel
  .amdhsa_next_free_vgpr 512
  .amdhsa_next_free_sgpr 102
  .amdhsa_accum_offset 256
  .amdhsa_group_segment_fixed_size 0
  .amdhsa_kernarg_size 104
  .amdhsa_user_sgpr_count 2
  .amdhsa_user_sgpr_kernarg_segment_ptr 1
  .amdhsa_system_sgpr_workgroup_id_x 1
.end_amdhsa_kernel
```
